```python
import torch

def _softmax(x, axis=-1):
    return torch.softmax(x, dim=axis)
def _gelu(x):
    return torch.nn.functional.gelu(x, approximate="tanh")
def _silu(x):
    return torch.nn.functional.silu(x)
def _sigmoid(x):
    return torch.sigmoid(x)
def _layernorm(x, axis=-1, eps=1e-5):
    m = x.mean(dim=axis, keepdim=True)
    v = x.var(dim=axis, keepdim=True, unbiased=False)
    return (x - m) / torch.sqrt(v + eps)
def _scatter_add(tgt, idx, src, axis=0):
    return tgt.clone().index_add_(axis, idx, src)
def _segment_sum(src, seg, n):
    out = torch.zeros((n,) + src.shape[1:], dtype=src.dtype)
    return out.index_add_(0, seg, src)
def _pad(x, pw):
    flat = tuple(v for pair in reversed(pw) for v in pair)
    return torch.nn.functional.pad(x, flat)

kernel_name = 'standalone__gqa_softmax__near_ridge'

def setup_inputs():

    _w = (lambda a: (lambda t: t.to(torch.bfloat16) if t.is_floating_point() else t)(torch.as_tensor(a)))
    B, Hq, Hkv, Sq, Sk, D = 16, 32, 32, 384, 384, 128
    return {
        "q": _w((lambda *s: torch.randn(*s, dtype=torch.bfloat16) * 0.8)(B, Hq, Sq, D)),
        "k": _w((lambda *s: torch.randn(*s, dtype=torch.bfloat16) * 0.8)(B, Hkv, Sk, D)),
        "v": _w((lambda *s: torch.randn(*s, dtype=torch.bfloat16) * 0.05)(B, Hkv, Sk, D)),
    }

def reference(q, k, v):
    B, Hq, Sq, D = q.shape
    Hkv = k.shape[1]
    rep = Hq // Hkv
    k = (lambda x, n, axis: torch.repeat_interleave(x, n, dim=axis))(k, rep, axis=1)
    v = (lambda x, n, axis: torch.repeat_interleave(x, n, dim=axis))(v, rep, axis=1)
    scale = D ** -0.5
    scores = torch.einsum("bhqd,bhkd->bhqk", q, k) * scale
    p = _softmax(scores, axis=-1)
    return torch.einsum("bhqk,bhkd->bhqd", p, v)
```

```asm
; @launch grid=(256,1,1) block=(256,1,1) lds=152064
.amdgcn_target "amdgcn-amd-amdhsa--gfx950"
.text
.globl standalone__gqa_softmax__near_ridge_kernel
.p2align 8
.type standalone__gqa_softmax__near_ridge_kernel,@function
standalone__gqa_softmax__near_ridge_kernel:
    s_cmp_ge_u32 s2, 256
    s_cbranch_scc1 Lend
    s_load_dwordx4 s[36:39], s[0:1], 0
    s_load_dwordx4 s[64:67], s[0:1], 16
    v_lshrrev_b32 v1, 6, v0
    v_and_b32 v2, 63, v0
    v_readfirstlane_b32 s20, v1
    v_lshlrev_b32 v248, 4, v2
    v_and_b32 v3, 15, v2
    v_lshrrev_b32 v4, 4, v2
    s_getpc_b64 s[70:71]
Lpc:
    s_add_u32 s70, s70, Lmain-Lpc
    s_addc_u32 s71, s71, 0
    s_lshr_b32 s72, s2, 1
    s_and_b32 s72, s72, 60
    s_add_u32 s72, s72, s20
    s_min_u32 s72, s72, (Lend-Lmain)>>10
    s_lshl_b32 s72, s72, 10
    v_add_u32 v5, s72, v248
    global_load_dwordx4 a[252:255], v5, s[70:71]
    s_mul_i32 s27, s20, 4224
    s_mul_i32 s28, s20, 24576
    s_and_b32 s24, s20, 1
    s_lshl_b32 s24, s24, 12
    s_mul_i32 s73, s2, 196608
    s_mov_b32 s10, 196608
    s_mov_b32 s11, 0x20000
    s_mov_b32 s6, 196608
    s_mov_b32 s7, 0x20000
    s_mov_b32 s14, 196608
    s_mov_b32 s15, 0x20000
    s_mov_b32 s18, 196608
    s_mov_b32 s19, 0x20000
    s_mov_b32 s25, s28
    s_add_u32 s26, s28, 98304
    s_cmp_lt_u32 s20, 2
    s_waitcnt lgkmcnt(0)
    s_cselect_b64 s[8:9], s[38:39], s[64:65]
    s_add_u32 s8, s8, s73
    s_addc_u32 s9, s9, 0
    s_add_u32 s4, s36, s73
    s_addc_u32 s5, s37, 0
    s_add_u32 s16, s66, s73
    s_addc_u32 s17, s67, 0
    s_add_u32 s12, s64, s73
    s_addc_u32 s13, s65, 0
    s_mov_b32 m0, s27
    s_nop 0
    buffer_load_dwordx4 v248, s[8:11], s24 offen nt lds
    s_add_u32 m0, s27, 32
    s_nop 0
    buffer_load_dwordx4 v248, s[8:11], s24 offen offset:1024 nt lds
    s_add_u32 m0, s27, 64
    s_nop 0
    buffer_load_dwordx4 v248, s[8:11], s24 offen offset:2048 nt lds
    s_add_u32 m0, s27, 96
    s_nop 0
    buffer_load_dwordx4 v248, s[8:11], s24 offen offset:3072 nt lds
    s_add_u32 s24, s24, 8192
    s_add_u32 m0, s27, 50688
    s_nop 0
    buffer_load_dwordx4 v248, s[4:7], s28 offen nt lds
    s_add_u32 m0, s27, 50720
    s_nop 0
    buffer_load_dwordx4 v248, s[4:7], s28 offen offset:1024 nt lds
    s_add_u32 m0, s27, 50752
    s_nop 0
    buffer_load_dwordx4 v248, s[4:7], s28 offen offset:2048 nt lds
    s_add_u32 m0, s27, 50784
    s_nop 0
    buffer_load_dwordx4 v248, s[4:7], s28 offen offset:3072 nt lds
    s_add_u32 s28, s28, 4096
    s_add_u32 m0, s27, 67584
    s_nop 0
    buffer_load_dwordx4 v248, s[4:7], s28 offen nt lds
    s_add_u32 m0, s27, 67616
    s_nop 0
    buffer_load_dwordx4 v248, s[4:7], s28 offen offset:1024 nt lds
    s_add_u32 m0, s27, 67648
    s_nop 0
    buffer_load_dwordx4 v248, s[4:7], s28 offen offset:2048 nt lds
    s_add_u32 m0, s27, 67680
    s_nop 0
    buffer_load_dwordx4 v248, s[4:7], s28 offen offset:3072 nt lds
    s_add_u32 s28, s28, 4096
    v_and_b32 v5, 7, v3
    v_lshrrev_b32 v6, 3, v3
    v_mul_u32_u24 v246, 1056, v5
    v_lshl_add_u32 v246, v6, 8, v246
    v_lshl_add_u32 v246, v4, 4, v246
    v_and_b32 v5, 1, v4
    v_lshrrev_b32 v6, 2, v3
    v_lshl_add_u32 v5, v5, 2, v6
    v_mul_u32_u24 v247, 1056, v5
    v_lshrrev_b32 v5, 1, v4
    v_lshl_add_u32 v247, v5, 8, v247
    v_lshlrev_b32 v249, 8, v6
    v_and_b32 v5, 1, v6
    v_xor_b32 v5, v5, v4
    v_and_b32 v6, 3, v3
    v_lshl_add_u32 v247, v6, 4, v247
    s_add_u32 s84, s27, 50688
    v_mul_u32_u24 v6, 1056, v6
    v_add3_u32 v249, v249, v6, s84
    v_lshl_add_u32 v250, v5, 4, v249
    v_lshl_add_u32 v249, v4, 4, v249
    v_and_b32 v5, 1, v4
    v_lshlrev_b32 v5, 4, v5
    v_xor_b32 v251, v5, v248
    v_add_u32 v251, s84, v251
    s_mov_b32 s21, 0x3e0293ee
    s_mov_b32 s35, 0xbe0293ee
    s_mov_b32 s32, s21
    s_mov_b32 s33, s21
    s_mov_b32 s22, 0x5b800000
    s_mov_b32 s34, 0x4f800000
    s_mov_b64 s[76:77], 0
    s_mov_b64 s[78:79], 0
    v_mov_b32 v1, 0x3f803f80
    v_accvgpr_write_b32 a224, v1
    v_accvgpr_write_b32 a225, v1
    v_accvgpr_write_b32 a226, v1
    v_accvgpr_write_b32 a227, v1
    s_mov_b64 exec, 0
    s_cmp_eq_u32 s20, 0
    s_cbranch_scc1 Lhop0
    s_cmp_eq_u32 s20, 1
    s_cbranch_scc1 Lhop1
    s_cmp_eq_u32 s20, 2
    s_cbranch_scc1 Lhop2
    s_branch Lhop3
.p2align 12
Lmain:
Lret0:
    s_mov_b64 exec, -1
    s_add_u32 m0, s27, 16896
    s_nop 0
    buffer_load_dwordx4 v248, s[8:11], s24 offen nt lds
    s_add_u32 m0, s27, 16928
    s_nop 0
    buffer_load_dwordx4 v248, s[8:11], s24 offen offset:1024 nt lds
    s_add_u32 m0, s27, 16960
    s_nop 0
    buffer_load_dwordx4 v248, s[8:11], s24 offen offset:2048 nt lds
    s_add_u32 m0, s27, 16992
    s_nop 0
    buffer_load_dwordx4 v248, s[8:11], s24 offen offset:3072 nt lds
    s_add_u32 s24, s24, 8192
    s_waitcnt vmcnt(12)
    s_barrier
    ds_read_b128 a[96:99], v246 offset:0
    ds_read_b128 a[100:103], v246 offset:64
    ds_read_b128 a[104:107], v246 offset:128
    ds_read_b128 a[108:111], v246 offset:192
    ds_read_b128 a[124:127], v246 offset:704
    ds_read_b128 a[120:123], v246 offset:640
    ds_read_b128 a[116:119], v246 offset:576
    ds_read_b128 a[112:115], v246 offset:512
    ds_read_b64_tr_b16 a[160:161], v247 offset:8448
    ds_read_b64_tr_b16 a[162:163], v247 offset:8960
    ds_read_b64_tr_b16 a[164:165], v247 offset:8456
    ds_read_b64_tr_b16 a[166:167], v247 offset:8968
    ds_read_b64_tr_b16 a[168:169], v247 offset:8512
    ds_read_b64_tr_b16 a[170:171], v247 offset:9024
    ds_read_b64_tr_b16 a[172:173], v247 offset:8520
    ds_read_b64_tr_b16 a[174:175], v247 offset:9032
    ds_read_b64_tr_b16 a[176:177], v247 offset:8576
    ds_read_b64_tr_b16 a[178:179], v247 offset:9088
    ds_read_b64_tr_b16 a[180:181], v247 offset:8584
    ds_read_b64_tr_b16 a[182:183], v247 offset:9096
    ds_read_b64_tr_b16 a[184:185], v247 offset:8640
    ds_read_b64_tr_b16 a[186:187], v247 offset:9152
    ds_read_b64_tr_b16 a[188:189], v247 offset:8648
    ds_read_b64_tr_b16 a[190:191], v247 offset:9160
    s_waitcnt vmcnt(8)
    ds_read_b128 v[0:3], v249 offset:0
    ds_read_b128 v[4:7], v249 offset:64
    ds_read_b128 v[8:11], v249 offset:128
    ds_read_b128 v[12:15], v249 offset:192
    s_add_u32 m0, s27, 84480
    s_nop 0
    buffer_load_dwordx4 v248, s[4:7], s28 offen nt lds
    s_add_u32 m0, s27, 84512
    s_nop 0
    buffer_load_dwordx4 v248, s[4:7], s28 offen offset:1024 nt lds
    s_add_u32 m0, s27, 84544
    s_nop 0
    buffer_load_dwordx4 v248, s[4:7], s28 offen offset:2048 nt lds
    s_add_u32 m0, s27, 84576
    s_nop 0
    buffer_load_dwordx4 v248, s[4:7], s28 offen offset:3072 nt lds
    s_add_u32 s28, s28, 4096
    s_waitcnt lgkmcnt(0)
    v_lshlrev_b32 v16, 16, v0
    v_lshlrev_b32 v18, 16, v1
    v_lshlrev_b32 v20, 16, v2
    v_lshlrev_b32 v22, 16, v3
    v_and_b32 v17, 0xffff0000, v0
    v_and_b32 v19, 0xffff0000, v1
    v_and_b32 v21, 0xffff0000, v2
    v_and_b32 v23, 0xffff0000, v3
    v_pk_mul_f32 v[16:17], v[16:17], s[32:33]
    v_pk_mul_f32 v[18:19], v[18:19], s[32:33]
    v_pk_mul_f32 v[20:21], v[20:21], s[32:33]
    v_pk_mul_f32 v[22:23], v[22:23], s[32:33]
    v_cvt_pk_bf16_f32 v0, v16, v17
    v_cvt_pk_bf16_f32 v1, v18, v19
    v_cvt_pk_bf16_f32 v2, v20, v21
    v_cvt_pk_bf16_f32 v3, v22, v23
    v_accvgpr_write_b32 a0, v0
    v_accvgpr_write_b32 a1, v1
    v_accvgpr_write_b32 a2, v2
    v_accvgpr_write_b32 a3, v3
    v_lshlrev_b32 v24, 16, v4
    v_lshlrev_b32 v26, 16, v5
    v_lshlrev_b32 v28, 16, v6
    v_lshlrev_b32 v30, 16, v7
    v_and_b32 v25, 0xffff0000, v4
    v_and_b32 v27, 0xffff0000, v5
    v_and_b32 v29, 0xffff0000, v6
    v_and_b32 v31, 0xffff0000, v7
    v_pk_mul_f32 v[24:25], v[24:25], s[32:33]
    v_pk_mul_f32 v[26:27], v[26:27], s[32:33]
    v_pk_mul_f32 v[28:29], v[28:29], s[32:33]
    v_pk_mul_f32 v[30:31], v[30:31], s[32:33]
    v_cvt_pk_bf16_f32 v4, v24, v25
    v_cvt_pk_bf16_f32 v5, v26, v27
    v_cvt_pk_bf16_f32 v6, v28, v29
    v_cvt_pk_bf16_f32 v7, v30, v31
    v_accvgpr_write_b32 a4, v4
    v_accvgpr_write_b32 a5, v5
    v_accvgpr_write_b32 a6, v6
    v_accvgpr_write_b32 a7, v7
    v_lshlrev_b32 v16, 16, v8
    v_lshlrev_b32 v18, 16, v9
    v_lshlrev_b32 v20, 16, v10
    v_lshlrev_b32 v22, 16, v11
    v_and_b32 v17, 0xffff0000, v8
    v_and_b32 v19, 0xffff0000, v9
    v_and_b32 v21, 0xffff0000, v10
    v_and_b32 v23, 0xffff0000, v11
    v_pk_mul_f32 v[16:17], v[16:17], s[32:33]
    v_pk_mul_f32 v[18:19], v[18:19], s[32:33]
    v_pk_mul_f32 v[20:21], v[20:21], s[32:33]
    v_pk_mul_f32 v[22:23], v[22:23], s[32:33]
    v_cvt_pk_bf16_f32 v8, v16, v17
    v_cvt_pk_bf16_f32 v9, v18, v19
    v_cvt_pk_bf16_f32 v10, v20, v21
    v_cvt_pk_bf16_f32 v11, v22, v23
    v_accvgpr_write_b32 a8, v8
    v_accvgpr_write_b32 a9, v9
    v_accvgpr_write_b32 a10, v10
    v_accvgpr_write_b32 a11, v11
    v_lshlrev_b32 v24, 16, v12
    v_lshlrev_b32 v26, 16, v13
    v_lshlrev_b32 v28, 16, v14
    v_lshlrev_b32 v30, 16, v15
    v_and_b32 v25, 0xffff0000, v12
    v_and_b32 v27, 0xffff0000, v13
    v_and_b32 v29, 0xffff0000, v14
    v_and_b32 v31, 0xffff0000, v15
    v_pk_mul_f32 v[24:25], v[24:25], s[32:33]
    v_pk_mul_f32 v[26:27], v[26:27], s[32:33]
    v_pk_mul_f32 v[28:29], v[28:29], s[32:33]
    v_pk_mul_f32 v[30:31], v[30:31], s[32:33]
    v_cvt_pk_bf16_f32 v12, v24, v25
    v_cvt_pk_bf16_f32 v13, v26, v27
    v_cvt_pk_bf16_f32 v14, v28, v29
    v_cvt_pk_bf16_f32 v15, v30, v31
    v_accvgpr_write_b32 a12, v12
    v_accvgpr_write_b32 a13, v13
    v_accvgpr_write_b32 a14, v14
    v_accvgpr_write_b32 a15, v15
    s_nop 1
    v_mfma_f32_16x16x32_bf16 v[192:195], a[96:99], a[0:3], 0
    v_mfma_f32_16x16x32_bf16 v[192:195], a[100:103], a[4:7], v[192:195]
    v_mfma_f32_16x16x32_bf16 v[192:195], a[104:107], a[8:11], v[192:195]
    v_mfma_f32_16x16x32_bf16 v[192:195], a[108:111], a[12:15], v[192:195]
    v_mfma_f32_16x16x32_bf16 v[196:199], a[124:127], a[12:15], 0
    v_mfma_f32_16x16x32_bf16 v[196:199], a[120:123], a[8:11], v[196:199]
    v_mfma_f32_16x16x32_bf16 v[196:199], a[116:119], a[4:7], v[196:199]
    v_mfma_f32_16x16x32_bf16 v[196:199], a[112:115], a[0:3], v[196:199]
    s_nop 3
    v_max3_f32 v244, v192, v193, v194
    s_nop 2
    v_max3_f32 v244, v244, v195, v196
    v_max3_f32 v244, v244, v197, v198
    v_max_f32 v245, v244, v199
    v_max_f32 v244, v244, v199
    s_nop 1
    v_permlane16_swap_b32 v244, v245
    v_max_f32 v244, v244, v245
    v_mov_b32 v245, v244
    s_nop 1
    v_permlane32_swap_b32 v244, v245
    v_max_f32 v244, v244, v245
    v_sub_f32 v216, 0x41c00000, v244
    v_add_f32 v192, v192, v216
    v_exp_f32 v192, v192
    v_add_f32 v193, v193, v216
    v_exp_f32 v193, v193
    s_nop 0
    v_cvt_pk_bf16_f32 v208, v192, v193
    v_add_f32 v194, v194, v216
    v_exp_f32 v194, v194
    v_add_f32 v195, v195, v216
    v_exp_f32 v195, v195
    s_nop 0
    v_cvt_pk_bf16_f32 v209, v194, v195
    v_add_f32 v196, v196, v216
    v_exp_f32 v196, v196
    v_add_f32 v197, v197, v216
    v_exp_f32 v197, v197
    s_nop 0
    v_cvt_pk_bf16_f32 v210, v196, v197
    v_add_f32 v198, v198, v216
    v_exp_f32 v198, v198
    v_add_f32 v199, v199, v216
    v_exp_f32 v199, v199
    s_nop 0
    v_cvt_pk_bf16_f32 v211, v198, v199
    s_nop 1
    v_mfma_f32_16x16x32_bf16 a[228:231], a[224:227], v[208:211], 0
    v_mov_b32 v217, v216
    v_mov_b32 v218, v216
    v_mfma_f32_16x16x32_bf16 v[0:3], a[160:163], v[208:211], 0
    v_mov_b32 v219, v216
    v_mfma_f32_16x16x32_bf16 v[4:7], a[164:167], v[208:211], 0
    v_mfma_f32_16x16x32_bf16 v[8:11], a[168:171], v[208:211], 0
    v_mfma_f32_16x16x32_bf16 v[12:15], a[172:175], v[208:211], 0
    v_mfma_f32_16x16x32_bf16 v[16:19], a[176:179], v[208:211], 0
    v_mfma_f32_16x16x32_bf16 v[20:23], a[180:183], v[208:211], 0
    v_mfma_f32_16x16x32_bf16 v[24:27], a[184:187], v[208:211], 0
    v_mfma_f32_16x16x32_bf16 v[28:31], a[188:191], v[208:211], 0
    s_mov_b64 exec, 0
    s_cmp_eq_u32 s20, 0
    s_cbranch_scc1 Lhop4
    s_cmp_eq_u32 s20, 1
    s_cbranch_scc1 Lhop5
    s_cmp_eq_u32 s20, 2
    s_cbranch_scc1 Lhop6
    s_branch Lhop7
Lret1:
    s_mov_b64 exec, -1
    s_waitcnt vmcnt(8)
    ds_read_b128 v[32:35], v249 offset:16896
    ds_read_b128 v[36:39], v249 offset:16960
    ds_read_b128 v[40:43], v249 offset:17024
    ds_read_b128 v[44:47], v249 offset:17088
    s_add_u32 m0, s27, 101376
    s_nop 0
    buffer_load_dwordx4 v248, s[4:7], s28 offen nt lds
    s_add_u32 m0, s27, 101408
    s_nop 0
    buffer_load_dwordx4 v248, s[4:7], s28 offen offset:1024 nt lds
    s_add_u32 m0, s27, 101440
    s_nop 0
    buffer_load_dwordx4 v248, s[4:7], s28 offen offset:2048 nt lds
    s_add_u32 m0, s27, 101472
    s_nop 0
    buffer_load_dwordx4 v248, s[4:7], s28 offen offset:3072 nt lds
    s_add_u32 s28, s28, 4096
    s_waitcnt lgkmcnt(0)
    v_lshlrev_b32 v48, 16, v32
    v_lshlrev_b32 v50, 16, v33
    v_lshlrev_b32 v52, 16, v34
    v_lshlrev_b32 v54, 16, v35
    v_and_b32 v49, 0xffff0000, v32
    v_and_b32 v51, 0xffff0000, v33
    v_and_b32 v53, 0xffff0000, v34
    v_and_b32 v55, 0xffff0000, v35
    v_pk_mul_f32 v[48:49], v[48:49], s[32:33]
    v_pk_mul_f32 v[50:51], v[50:51], s[32:33]
    v_pk_mul_f32 v[52:53], v[52:53], s[32:33]
    v_pk_mul_f32 v[54:55], v[54:55], s[32:33]
    v_cvt_pk_bf16_f32 v32, v48, v49
    v_cvt_pk_bf16_f32 v33, v50, v51
    v_cvt_pk_bf16_f32 v34, v52, v53
    v_cvt_pk_bf16_f32 v35, v54, v55
    v_accvgpr_write_b32 a16, v32
    v_accvgpr_write_b32 a17, v33
    v_accvgpr_write_b32 a18, v34
    v_accvgpr_write_b32 a19, v35
    v_lshlrev_b32 v56, 16, v36
    v_lshlrev_b32 v58, 16, v37
    v_lshlrev_b32 v60, 16, v38
    v_lshlrev_b32 v62, 16, v39
    v_and_b32 v57, 0xffff0000, v36
    v_and_b32 v59, 0xffff0000, v37
    v_and_b32 v61, 0xffff0000, v38
    v_and_b32 v63, 0xffff0000, v39
    v_pk_mul_f32 v[56:57], v[56:57], s[32:33]
    v_pk_mul_f32 v[58:59], v[58:59], s[32:33]
    v_pk_mul_f32 v[60:61], v[60:61], s[32:33]
    v_pk_mul_f32 v[62:63], v[62:63], s[32:33]
    v_cvt_pk_bf16_f32 v36, v56, v57
    v_cvt_pk_bf16_f32 v37, v58, v59
    v_cvt_pk_bf16_f32 v38, v60, v61
    v_cvt_pk_bf16_f32 v39, v62, v63
    v_accvgpr_write_b32 a20, v36
    v_accvgpr_write_b32 a21, v37
    v_accvgpr_write_b32 a22, v38
    v_accvgpr_write_b32 a23, v39
    v_lshlrev_b32 v48, 16, v40
    v_lshlrev_b32 v50, 16, v41
    v_lshlrev_b32 v52, 16, v42
    v_lshlrev_b32 v54, 16, v43
    v_and_b32 v49, 0xffff0000, v40
    v_and_b32 v51, 0xffff0000, v41
    v_and_b32 v53, 0xffff0000, v42
    v_and_b32 v55, 0xffff0000, v43
    v_pk_mul_f32 v[48:49], v[48:49], s[32:33]
    v_pk_mul_f32 v[50:51], v[50:51], s[32:33]
    v_pk_mul_f32 v[52:53], v[52:53], s[32:33]
    v_pk_mul_f32 v[54:55], v[54:55], s[32:33]
    v_cvt_pk_bf16_f32 v40, v48, v49
    v_cvt_pk_bf16_f32 v41, v50, v51
    v_cvt_pk_bf16_f32 v42, v52, v53
    v_cvt_pk_bf16_f32 v43, v54, v55
    v_accvgpr_write_b32 a24, v40
    v_accvgpr_write_b32 a25, v41
    v_accvgpr_write_b32 a26, v42
    v_accvgpr_write_b32 a27, v43
    v_lshlrev_b32 v56, 16, v44
    v_lshlrev_b32 v58, 16, v45
    v_lshlrev_b32 v60, 16, v46
    v_lshlrev_b32 v62, 16, v47
    v_and_b32 v57, 0xffff0000, v44
    v_and_b32 v59, 0xffff0000, v45
    v_and_b32 v61, 0xffff0000, v46
    v_and_b32 v63, 0xffff0000, v47
    v_pk_mul_f32 v[56:57], v[56:57], s[32:33]
    v_pk_mul_f32 v[58:59], v[58:59], s[32:33]
    v_pk_mul_f32 v[60:61], v[60:61], s[32:33]
    v_pk_mul_f32 v[62:63], v[62:63], s[32:33]
    v_cvt_pk_bf16_f32 v44, v56, v57
    v_cvt_pk_bf16_f32 v45, v58, v59
    v_cvt_pk_bf16_f32 v46, v60, v61
    v_cvt_pk_bf16_f32 v47, v62, v63
    v_accvgpr_write_b32 a28, v44
    v_accvgpr_write_b32 a29, v45
    v_accvgpr_write_b32 a30, v46
    v_accvgpr_write_b32 a31, v47
    s_nop 1
    v_mfma_f32_16x16x32_bf16 v[192:195], a[96:99], a[16:19], 0
    v_mfma_f32_16x16x32_bf16 v[192:195], a[100:103], a[20:23], v[192:195]
    v_mfma_f32_16x16x32_bf16 v[192:195], a[104:107], a[24:27], v[192:195]
    v_mfma_f32_16x16x32_bf16 v[192:195], a[108:111], a[28:31], v[192:195]
    v_mfma_f32_16x16x32_bf16 v[196:199], a[124:127], a[28:31], 0
    v_mfma_f32_16x16x32_bf16 v[196:199], a[120:123], a[24:27], v[196:199]
    v_mfma_f32_16x16x32_bf16 v[196:199], a[116:119], a[20:23], v[196:199]
    v_mfma_f32_16x16x32_bf16 v[196:199], a[112:115], a[16:19], v[196:199]
    s_nop 3
    v_max3_f32 v244, v192, v193, v194
    s_nop 2
    v_max3_f32 v244, v244, v195, v196
    v_max3_f32 v244, v244, v197, v198
    v_max_f32 v245, v244, v199
    v_max_f32 v244, v244, v199
    s_nop 1
    v_permlane16_swap_b32 v244, v245
    v_max_f32 v244, v244, v245
    v_mov_b32 v245, v244
    s_nop 1
    v_permlane32_swap_b32 v244, v245
    v_max_f32 v244, v244, v245
    v_sub_f32 v220, 0x41c00000, v244
    v_add_f32 v192, v192, v220
    v_exp_f32 v192, v192
    v_add_f32 v193, v193, v220
    v_exp_f32 v193, v193
    s_nop 0
    v_cvt_pk_bf16_f32 v208, v192, v193
    v_add_f32 v194, v194, v220
    v_exp_f32 v194, v194
    v_add_f32 v195, v195, v220
    v_exp_f32 v195, v195
    s_nop 0
    v_cvt_pk_bf16_f32 v209, v194, v195
    v_add_f32 v196, v196, v220
    v_exp_f32 v196, v196
    v_add_f32 v197, v197, v220
    v_exp_f32 v197, v197
    s_nop 0
    v_cvt_pk_bf16_f32 v210, v196, v197
    v_add_f32 v198, v198, v220
    v_exp_f32 v198, v198
    v_add_f32 v199, v199, v220
    v_exp_f32 v199, v199
    s_nop 0
    v_cvt_pk_bf16_f32 v211, v198, v199
    s_nop 1
    v_mfma_f32_16x16x32_bf16 a[232:235], a[224:227], v[208:211], 0
    v_mov_b32 v221, v220
    v_mov_b32 v222, v220
    v_mfma_f32_16x16x32_bf16 v[32:35], a[160:163], v[208:211], 0
    v_mov_b32 v223, v220
    v_mfma_f32_16x16x32_bf16 v[36:39], a[164:167], v[208:211], 0
    v_mfma_f32_16x16x32_bf16 v[40:43], a[168:171], v[208:211], 0
    v_mfma_f32_16x16x32_bf16 v[44:47], a[172:175], v[208:211], 0
    v_mfma_f32_16x16x32_bf16 v[48:51], a[176:179], v[208:211], 0
    v_mfma_f32_16x16x32_bf16 v[52:55], a[180:183], v[208:211], 0
    v_mfma_f32_16x16x32_bf16 v[56:59], a[184:187], v[208:211], 0
    v_mfma_f32_16x16x32_bf16 v[60:63], a[188:191], v[208:211], 0
    s_mov_b64 exec, 0
    s_cmp_eq_u32 s20, 0
    s_cbranch_scc1 Lhop8
    s_cmp_eq_u32 s20, 1
    s_cbranch_scc1 Lhop9
    s_cmp_eq_u32 s20, 2
    s_cbranch_scc1 Lhop10
    s_branch Lhop11
Lret2:
    s_mov_b64 exec, -1
    s_waitcnt vmcnt(8)
    s_barrier
    ds_read_b128 a[128:131], v246 offset:16896
    ds_read_b128 a[132:135], v246 offset:16960
    ds_read_b128 a[136:139], v246 offset:17024
    ds_read_b128 a[140:143], v246 offset:17088
    ds_read_b128 a[156:159], v246 offset:17600
    ds_read_b128 a[152:155], v246 offset:17536
    ds_read_b128 a[148:151], v246 offset:17472
    ds_read_b128 a[144:147], v246 offset:17408
    ds_read_b64_tr_b16 a[192:193], v247 offset:25344
    ds_read_b64_tr_b16 a[194:195], v247 offset:25856
    ds_read_b64_tr_b16 a[196:197], v247 offset:25352
    ds_read_b64_tr_b16 a[198:199], v247 offset:25864
    ds_read_b64_tr_b16 a[200:201], v247 offset:25408
    ds_read_b64_tr_b16 a[202:203], v247 offset:25920
    ds_read_b64_tr_b16 a[204:205], v247 offset:25416
    ds_read_b64_tr_b16 a[206:207], v247 offset:25928
    ds_read_b64_tr_b16 a[208:209], v247 offset:25472
    ds_read_b64_tr_b16 a[210:211], v247 offset:25984
    ds_read_b64_tr_b16 a[212:213], v247 offset:25480
    ds_read_b64_tr_b16 a[214:215], v247 offset:25992
    ds_read_b64_tr_b16 a[216:217], v247 offset:25536
    ds_read_b64_tr_b16 a[218:219], v247 offset:26048
    ds_read_b64_tr_b16 a[220:221], v247 offset:25544
    ds_read_b64_tr_b16 a[222:223], v247 offset:26056
    s_add_u32 m0, s27, 118272
    s_nop 0
    buffer_load_dwordx4 v248, s[4:7], s28 offen nt lds
    s_add_u32 m0, s27, 118304
    s_nop 0
    buffer_load_dwordx4 v248, s[4:7], s28 offen offset:1024 nt lds
    s_add_u32 m0, s27, 118336
    s_nop 0
    buffer_load_dwordx4 v248, s[4:7], s28 offen offset:2048 nt lds
    s_add_u32 m0, s27, 118368
    s_nop 0
    buffer_load_dwordx4 v248, s[4:7], s28 offen offset:3072 nt lds
    s_add_u32 s28, s28, 4096
    s_waitcnt lgkmcnt(15)
    v_mfma_f32_16x16x32_bf16 v[192:195], a[128:131], a[0:3], v[216:219]
    s_waitcnt lgkmcnt(0)
    v_mfma_f32_16x16x32_bf16 v[192:195], a[132:135], a[4:7], v[192:195]
    v_mfma_f32_16x16x32_bf16 v[192:195], a[136:139], a[8:11], v[192:195]
    v_mfma_f32_16x16x32_bf16 v[192:195], a[140:143], a[12:15], v[192:195]
    v_mfma_f32_16x16x32_bf16 v[196:199], a[156:159], a[12:15], v[216:219]
    v_mfma_f32_16x16x32_bf16 v[196:199], a[152:155], a[8:11], v[196:199]
    v_mfma_f32_16x16x32_bf16 v[196:199], a[148:151], a[4:7], v[196:199]
    v_mfma_f32_16x16x32_bf16 v[196:199], a[144:147], a[0:3], v[196:199]
    v_mfma_f32_16x16x32_bf16 v[200:203], a[128:131], a[16:19], v[220:223]
    v_mfma_f32_16x16x32_bf16 v[200:203], a[132:135], a[20:23], v[200:203]
    v_mfma_f32_16x16x32_bf16 v[200:203], a[136:139], a[24:27], v[200:203]
    v_mfma_f32_16x16x32_bf16 v[200:203], a[140:143], a[28:31], v[200:203]
    v_exp_f32 v192, v192
    v_mfma_f32_16x16x32_bf16 v[204:207], a[156:159], a[28:31], v[220:223]
    v_exp_f32 v193, v193
    v_mfma_f32_16x16x32_bf16 v[204:207], a[152:155], a[24:27], v[204:207]
    v_exp_f32 v194, v194
    v_exp_f32 v195, v195
    v_exp_f32 v196, v196
    v_exp_f32 v197, v197
    v_exp_f32 v198, v198
    v_exp_f32 v199, v199
    v_mfma_f32_16x16x32_bf16 v[204:207], a[148:151], a[20:23], v[204:207]
    v_cvt_pk_bf16_f32 v208, v192, v193
    v_cvt_pk_bf16_f32 v209, v194, v195
    v_cvt_pk_bf16_f32 v210, v196, v197
    v_cvt_pk_bf16_f32 v211, v198, v199
    v_mfma_f32_16x16x32_bf16 v[204:207], a[144:147], a[16:19], v[204:207]
    v_exp_f32 v200, v200
    v_mfma_f32_16x16x32_bf16 a[228:231], a[224:227], v[208:211], a[228:231]
    v_exp_f32 v201, v201
    v_mfma_f32_16x16x32_bf16 v[0:3], a[192:195], v[208:211], v[0:3]
    v_exp_f32 v202, v202
    v_mfma_f32_16x16x32_bf16 v[4:7], a[196:199], v[208:211], v[4:7]
    v_exp_f32 v203, v203
    v_mfma_f32_16x16x32_bf16 v[8:11], a[200:203], v[208:211], v[8:11]
    v_exp_f32 v204, v204
    v_mfma_f32_16x16x32_bf16 v[12:15], a[204:207], v[208:211], v[12:15]
    v_exp_f32 v205, v205
    v_mfma_f32_16x16x32_bf16 v[16:19], a[208:211], v[208:211], v[16:19]
    v_exp_f32 v206, v206
    v_mfma_f32_16x16x32_bf16 v[20:23], a[212:215], v[208:211], v[20:23]
    v_exp_f32 v207, v207
    v_mfma_f32_16x16x32_bf16 v[24:27], a[216:219], v[208:211], v[24:27]
    v_cvt_pk_bf16_f32 v212, v200, v201
    v_cvt_pk_bf16_f32 v213, v202, v203
    v_cvt_pk_bf16_f32 v214, v204, v205
    v_cvt_pk_bf16_f32 v215, v206, v207
    v_mfma_f32_16x16x32_bf16 v[28:31], a[220:223], v[208:211], v[28:31]
    s_nop 0
    v_mfma_f32_16x16x32_bf16 a[232:235], a[224:227], v[212:215], a[232:235]
    v_mfma_f32_16x16x32_bf16 v[32:35], a[192:195], v[212:215], v[32:35]
    v_mfma_f32_16x16x32_bf16 v[36:39], a[196:199], v[212:215], v[36:39]
    v_mfma_f32_16x16x32_bf16 v[40:43], a[200:203], v[212:215], v[40:43]
    v_mfma_f32_16x16x32_bf16 v[44:47], a[204:207], v[212:215], v[44:47]
    v_mfma_f32_16x16x32_bf16 v[48:51], a[208:211], v[212:215], v[48:51]
    v_mfma_f32_16x16x32_bf16 v[52:55], a[212:215], v[212:215], v[52:55]
    v_mfma_f32_16x16x32_bf16 v[56:59], a[216:219], v[212:215], v[56:59]
    v_mfma_f32_16x16x32_bf16 v[60:63], a[220:223], v[212:215], v[60:63]
    s_waitcnt vmcnt(8)
    ds_read_b128 v[64:67], v249 offset:33792
    ds_read_b128 v[68:71], v249 offset:33856
    ds_read_b128 v[72:75], v249 offset:33920
    ds_read_b128 v[76:79], v249 offset:33984
    s_add_u32 m0, s27, 135168
    s_nop 0
    buffer_load_dwordx4 v248, s[4:7], s28 offen nt lds
    s_add_u32 m0, s27, 135200
    s_nop 0
    buffer_load_dwordx4 v248, s[4:7], s28 offen offset:1024 nt lds
    s_add_u32 m0, s27, 135232
    s_nop 0
    buffer_load_dwordx4 v248, s[4:7], s28 offen offset:2048 nt lds
    s_add_u32 m0, s27, 135264
    s_nop 0
    buffer_load_dwordx4 v248, s[4:7], s28 offen offset:3072 nt lds
    s_add_u32 s28, s28, 77824
    s_waitcnt lgkmcnt(0)
    v_lshlrev_b32 v80, 16, v64
    v_lshlrev_b32 v82, 16, v65
    v_lshlrev_b32 v84, 16, v66
    v_lshlrev_b32 v86, 16, v67
    v_and_b32 v81, 0xffff0000, v64
    v_and_b32 v83, 0xffff0000, v65
    v_and_b32 v85, 0xffff0000, v66
    v_and_b32 v87, 0xffff0000, v67
    v_pk_mul_f32 v[80:81], v[80:81], s[32:33]
    v_pk_mul_f32 v[82:83], v[82:83], s[32:33]
    v_pk_mul_f32 v[84:85], v[84:85], s[32:33]
    v_pk_mul_f32 v[86:87], v[86:87], s[32:33]
    v_cvt_pk_bf16_f32 v64, v80, v81
    v_cvt_pk_bf16_f32 v65, v82, v83
    v_cvt_pk_bf16_f32 v66, v84, v85
    v_cvt_pk_bf16_f32 v67, v86, v87
    v_accvgpr_write_b32 a32, v64
    v_accvgpr_write_b32 a33, v65
    v_accvgpr_write_b32 a34, v66
    v_accvgpr_write_b32 a35, v67
    v_lshlrev_b32 v88, 16, v68
    v_lshlrev_b32 v90, 16, v69
    v_lshlrev_b32 v92, 16, v70
    v_lshlrev_b32 v94, 16, v71
    v_and_b32 v89, 0xffff0000, v68
    v_and_b32 v91, 0xffff0000, v69
    v_and_b32 v93, 0xffff0000, v70
    v_and_b32 v95, 0xffff0000, v71
    v_pk_mul_f32 v[88:89], v[88:89], s[32:33]
    v_pk_mul_f32 v[90:91], v[90:91], s[32:33]
    v_pk_mul_f32 v[92:93], v[92:93], s[32:33]
    v_pk_mul_f32 v[94:95], v[94:95], s[32:33]
    v_cvt_pk_bf16_f32 v68, v88, v89
    v_cvt_pk_bf16_f32 v69, v90, v91
    v_cvt_pk_bf16_f32 v70, v92, v93
    v_cvt_pk_bf16_f32 v71, v94, v95
    v_accvgpr_write_b32 a36, v68
    v_accvgpr_write_b32 a37, v69
    v_accvgpr_write_b32 a38, v70
    v_accvgpr_write_b32 a39, v71
    v_lshlrev_b32 v80, 16, v72
    v_lshlrev_b32 v82, 16, v73
    v_lshlrev_b32 v84, 16, v74
    v_lshlrev_b32 v86, 16, v75
    v_and_b32 v81, 0xffff0000, v72
    v_and_b32 v83, 0xffff0000, v73
    v_and_b32 v85, 0xffff0000, v74
    v_and_b32 v87, 0xffff0000, v75
    v_pk_mul_f32 v[80:81], v[80:81], s[32:33]
    v_pk_mul_f32 v[82:83], v[82:83], s[32:33]
    v_pk_mul_f32 v[84:85], v[84:85], s[32:33]
    v_pk_mul_f32 v[86:87], v[86:87], s[32:33]
    v_cvt_pk_bf16_f32 v72, v80, v81
    v_cvt_pk_bf16_f32 v73, v82, v83
    v_cvt_pk_bf16_f32 v74, v84, v85
    v_cvt_pk_bf16_f32 v75, v86, v87
    v_accvgpr_write_b32 a40, v72
    v_accvgpr_write_b32 a41, v73
    v_accvgpr_write_b32 a42, v74
    v_accvgpr_write_b32 a43, v75
    v_lshlrev_b32 v88, 16, v76
    v_lshlrev_b32 v90, 16, v77
    v_lshlrev_b32 v92, 16, v78
    v_lshlrev_b32 v94, 16, v79
    v_and_b32 v89, 0xffff0000, v76
    v_and_b32 v91, 0xffff0000, v77
    v_and_b32 v93, 0xffff0000, v78
    v_and_b32 v95, 0xffff0000, v79
    v_pk_mul_f32 v[88:89], v[88:89], s[32:33]
    v_pk_mul_f32 v[90:91], v[90:91], s[32:33]
    v_pk_mul_f32 v[92:93], v[92:93], s[32:33]
    v_pk_mul_f32 v[94:95], v[94:95], s[32:33]
    v_cvt_pk_bf16_f32 v76, v88, v89
    v_cvt_pk_bf16_f32 v77, v90, v91
    v_cvt_pk_bf16_f32 v78, v92, v93
    v_cvt_pk_bf16_f32 v79, v94, v95
    v_accvgpr_write_b32 a44, v76
    v_accvgpr_write_b32 a45, v77
    v_accvgpr_write_b32 a46, v78
    v_accvgpr_write_b32 a47, v79
    s_nop 1
    v_mfma_f32_16x16x32_bf16 v[192:195], a[96:99], a[32:35], 0
    v_mfma_f32_16x16x32_bf16 v[192:195], a[100:103], a[36:39], v[192:195]
    v_mfma_f32_16x16x32_bf16 v[192:195], a[104:107], a[40:43], v[192:195]
    v_mfma_f32_16x16x32_bf16 v[192:195], a[108:111], a[44:47], v[192:195]
    v_mfma_f32_16x16x32_bf16 v[196:199], a[124:127], a[44:47], 0
    v_mfma_f32_16x16x32_bf16 v[196:199], a[120:123], a[40:43], v[196:199]
    v_mfma_f32_16x16x32_bf16 v[196:199], a[116:119], a[36:39], v[196:199]
    v_mfma_f32_16x16x32_bf16 v[196:199], a[112:115], a[32:35], v[196:199]
    v_mfma_f32_16x16x32_bf16 v[200:203], a[128:131], a[32:35], 0
    v_mfma_f32_16x16x32_bf16 v[200:203], a[132:135], a[36:39], v[200:203]
    v_mfma_f32_16x16x32_bf16 v[200:203], a[136:139], a[40:43], v[200:203]
    v_mfma_f32_16x16x32_bf16 v[200:203], a[140:143], a[44:47], v[200:203]
    v_max3_f32 v244, v192, v193, v194
    v_mfma_f32_16x16x32_bf16 v[204:207], a[156:159], a[44:47], 0
    v_mfma_f32_16x16x32_bf16 v[204:207], a[152:155], a[40:43], v[204:207]
    v_mfma_f32_16x16x32_bf16 v[204:207], a[148:151], a[36:39], v[204:207]
    v_max3_f32 v244, v244, v195, v196
    v_max3_f32 v244, v244, v197, v198
    v_max_f32 v245, v244, v199
    v_max_f32 v244, v244, v199
    v_mfma_f32_16x16x32_bf16 v[204:207], a[144:147], a[32:35], v[204:207]
    s_nop 0
    v_permlane16_swap_b32 v244, v245
    v_max_f32 v244, v244, v245
    v_mov_b32 v245, v244
    s_nop 1
    v_permlane32_swap_b32 v244, v245
    v_max_f32 v244, v244, v245
    v_sub_f32 v224, 0x41c00000, v244
    v_add_f32 v192, v192, v224
    v_exp_f32 v192, v192
    v_add_f32 v193, v193, v224
    v_exp_f32 v193, v193
    s_nop 0
    v_cvt_pk_bf16_f32 v208, v192, v193
    v_add_f32 v194, v194, v224
    v_exp_f32 v194, v194
    v_add_f32 v195, v195, v224
    v_exp_f32 v195, v195
    s_nop 0
    v_cvt_pk_bf16_f32 v209, v194, v195
    v_add_f32 v196, v196, v224
    v_exp_f32 v196, v196
    v_add_f32 v197, v197, v224
    v_exp_f32 v197, v197
Lhop0:
    s_cbranch_execz Lret0
    s_nop 0
    v_cvt_pk_bf16_f32 v210, v196, v197
    v_add_f32 v198, v198, v224
    v_exp_f32 v198, v198
    v_add_f32 v199, v199, v224
    v_exp_f32 v199, v199
    s_nop 0
    v_cvt_pk_bf16_f32 v211, v198, v199
    s_nop 1
    v_mfma_f32_16x16x32_bf16 a[236:239], a[224:227], v[208:211], 0
    v_add_f32 v200, v200, v224
    v_add_f32 v201, v201, v224
    v_add_f32 v202, v202, v224
    v_add_f32 v203, v203, v224
    v_add_f32 v204, v204, v224
    v_add_f32 v205, v205, v224
    v_add_f32 v206, v206, v224
    v_add_f32 v207, v207, v224
    v_exp_f32 v200, v200
    v_exp_f32 v201, v201
    v_exp_f32 v202, v202
    v_exp_f32 v203, v203
    v_exp_f32 v204, v204
    v_exp_f32 v205, v205
    v_exp_f32 v206, v206
    v_exp_f32 v207, v207
    v_cvt_pk_bf16_f32 v212, v200, v201
    v_cvt_pk_bf16_f32 v213, v202, v203
    v_cvt_pk_bf16_f32 v214, v204, v205
    v_cvt_pk_bf16_f32 v215, v206, v207
    s_nop 1
    v_mfma_f32_16x16x32_bf16 a[236:239], a[224:227], v[212:215], a[236:239]
    v_mov_b32 v225, v224
    v_mov_b32 v226, v224
    v_mfma_f32_16x16x32_bf16 v[64:67], a[192:195], v[212:215], 0
    v_mov_b32 v227, v224
    v_mfma_f32_16x16x32_bf16 v[64:67], a[160:163], v[208:211], v[64:67]
    v_mfma_f32_16x16x32_bf16 v[68:71], a[164:167], v[208:211], 0
    v_mfma_f32_16x16x32_bf16 v[68:71], a[196:199], v[212:215], v[68:71]
    v_mfma_f32_16x16x32_bf16 v[72:75], a[200:203], v[212:215], 0
    v_mfma_f32_16x16x32_bf16 v[72:75], a[168:171], v[208:211], v[72:75]
    v_mfma_f32_16x16x32_bf16 v[76:79], a[172:175], v[208:211], 0
    v_mfma_f32_16x16x32_bf16 v[76:79], a[204:207], v[212:215], v[76:79]
    v_mfma_f32_16x16x32_bf16 v[80:83], a[208:211], v[212:215], 0
    v_mfma_f32_16x16x32_bf16 v[80:83], a[176:179], v[208:211], v[80:83]
    v_mfma_f32_16x16x32_bf16 v[84:87], a[180:183], v[208:211], 0
    v_mfma_f32_16x16x32_bf16 v[84:87], a[212:215], v[212:215], v[84:87]
    v_mfma_f32_16x16x32_bf16 v[88:91], a[216:219], v[212:215], 0
    v_mfma_f32_16x16x32_bf16 v[88:91], a[184:187], v[208:211], v[88:91]
    v_mfma_f32_16x16x32_bf16 v[92:95], a[188:191], v[208:211], 0
    v_mfma_f32_16x16x32_bf16 v[92:95], a[220:223], v[212:215], v[92:95]
    s_waitcnt vmcnt(8)
    ds_read_b128 v[96:99], v249 offset:50688
    ds_read_b128 v[100:103], v249 offset:50752
    ds_read_b128 v[104:107], v249 offset:50816
    ds_read_b128 v[108:111], v249 offset:50880
    s_add_u32 m0, s27, 33792
    s_nop 0
    buffer_load_dwordx4 v248, s[8:11], s24 offen nt lds
    s_add_u32 m0, s27, 33824
    s_nop 0
    buffer_load_dwordx4 v248, s[8:11], s24 offen offset:1024 nt lds
    s_add_u32 m0, s27, 33856
    s_nop 0
    buffer_load_dwordx4 v248, s[8:11], s24 offen offset:2048 nt lds
    s_add_u32 m0, s27, 33888
    s_nop 0
    buffer_load_dwordx4 v248, s[8:11], s24 offen offset:3072 nt lds
    s_add_u32 s24, s24, 8192
    s_waitcnt lgkmcnt(0)
    v_lshlrev_b32 v112, 16, v96
    v_lshlrev_b32 v114, 16, v97
    v_lshlrev_b32 v116, 16, v98
    v_lshlrev_b32 v118, 16, v99
    v_and_b32 v113, 0xffff0000, v96
    v_and_b32 v115, 0xffff0000, v97
    v_and_b32 v117, 0xffff0000, v98
    v_and_b32 v119, 0xffff0000, v99
    v_pk_mul_f32 v[112:113], v[112:113], s[32:33]
    v_pk_mul_f32 v[114:115], v[114:115], s[32:33]
    v_pk_mul_f32 v[116:117], v[116:117], s[32:33]
    v_pk_mul_f32 v[118:119], v[118:119], s[32:33]
    v_cvt_pk_bf16_f32 v96, v112, v113
    v_cvt_pk_bf16_f32 v97, v114, v115
    v_cvt_pk_bf16_f32 v98, v116, v117
    v_cvt_pk_bf16_f32 v99, v118, v119
    v_accvgpr_write_b32 a48, v96
    v_accvgpr_write_b32 a49, v97
    v_accvgpr_write_b32 a50, v98
    v_accvgpr_write_b32 a51, v99
    v_lshlrev_b32 v120, 16, v100
    v_lshlrev_b32 v122, 16, v101
    v_lshlrev_b32 v124, 16, v102
    v_lshlrev_b32 v126, 16, v103
    v_and_b32 v121, 0xffff0000, v100
    v_and_b32 v123, 0xffff0000, v101
    v_and_b32 v125, 0xffff0000, v102
    v_and_b32 v127, 0xffff0000, v103
    v_pk_mul_f32 v[120:121], v[120:121], s[32:33]
    v_pk_mul_f32 v[122:123], v[122:123], s[32:33]
    v_pk_mul_f32 v[124:125], v[124:125], s[32:33]
    v_pk_mul_f32 v[126:127], v[126:127], s[32:33]
    v_cvt_pk_bf16_f32 v100, v120, v121
    v_cvt_pk_bf16_f32 v101, v122, v123
    v_cvt_pk_bf16_f32 v102, v124, v125
    v_cvt_pk_bf16_f32 v103, v126, v127
    v_accvgpr_write_b32 a52, v100
    v_accvgpr_write_b32 a53, v101
    v_accvgpr_write_b32 a54, v102
    v_accvgpr_write_b32 a55, v103
    v_lshlrev_b32 v112, 16, v104
    v_lshlrev_b32 v114, 16, v105
    v_lshlrev_b32 v116, 16, v106
    v_lshlrev_b32 v118, 16, v107
    v_and_b32 v113, 0xffff0000, v104
    v_and_b32 v115, 0xffff0000, v105
    v_and_b32 v117, 0xffff0000, v106
    v_and_b32 v119, 0xffff0000, v107
    v_pk_mul_f32 v[112:113], v[112:113], s[32:33]
    v_pk_mul_f32 v[114:115], v[114:115], s[32:33]
    v_pk_mul_f32 v[116:117], v[116:117], s[32:33]
    v_pk_mul_f32 v[118:119], v[118:119], s[32:33]
    v_cvt_pk_bf16_f32 v104, v112, v113
    v_cvt_pk_bf16_f32 v105, v114, v115
    v_cvt_pk_bf16_f32 v106, v116, v117
    v_cvt_pk_bf16_f32 v107, v118, v119
    v_accvgpr_write_b32 a56, v104
    v_accvgpr_write_b32 a57, v105
    v_accvgpr_write_b32 a58, v106
    v_accvgpr_write_b32 a59, v107
    v_lshlrev_b32 v120, 16, v108
    v_lshlrev_b32 v122, 16, v109
    v_lshlrev_b32 v124, 16, v110
    v_lshlrev_b32 v126, 16, v111
    v_and_b32 v121, 0xffff0000, v108
    v_and_b32 v123, 0xffff0000, v109
    v_and_b32 v125, 0xffff0000, v110
    v_and_b32 v127, 0xffff0000, v111
    v_pk_mul_f32 v[120:121], v[120:121], s[32:33]
    v_pk_mul_f32 v[122:123], v[122:123], s[32:33]
    v_pk_mul_f32 v[124:125], v[124:125], s[32:33]
    v_pk_mul_f32 v[126:127], v[126:127], s[32:33]
    v_cvt_pk_bf16_f32 v108, v120, v121
    v_cvt_pk_bf16_f32 v109, v122, v123
    v_cvt_pk_bf16_f32 v110, v124, v125
    v_cvt_pk_bf16_f32 v111, v126, v127
    v_accvgpr_write_b32 a60, v108
    v_accvgpr_write_b32 a61, v109
    v_accvgpr_write_b32 a62, v110
    v_accvgpr_write_b32 a63, v111
    s_nop 1
    v_mfma_f32_16x16x32_bf16 v[192:195], a[96:99], a[48:51], 0
    v_add_u32 v249, 33792, v249
    v_mfma_f32_16x16x32_bf16 v[192:195], a[100:103], a[52:55], v[192:195]
    v_mfma_f32_16x16x32_bf16 v[192:195], a[104:107], a[56:59], v[192:195]
    v_mfma_f32_16x16x32_bf16 v[192:195], a[108:111], a[60:63], v[192:195]
    v_mfma_f32_16x16x32_bf16 v[196:199], a[124:127], a[60:63], 0
    v_mfma_f32_16x16x32_bf16 v[196:199], a[120:123], a[56:59], v[196:199]
    v_mfma_f32_16x16x32_bf16 v[196:199], a[116:119], a[52:55], v[196:199]
    s_add_u32 m0, s27, 50688
    v_mfma_f32_16x16x32_bf16 v[196:199], a[112:115], a[48:51], v[196:199]
    buffer_load_dwordx4 v248, s[8:11], s24 offen nt lds
    v_mfma_f32_16x16x32_bf16 v[200:203], a[128:131], a[48:51], 0
    s_add_u32 m0, s27, 50720
    v_max3_f32 v244, v192, v193, v194
    v_mfma_f32_16x16x32_bf16 v[200:203], a[132:135], a[52:55], v[200:203]
    buffer_load_dwordx4 v248, s[8:11], s24 offen offset:1024 nt lds
    v_mfma_f32_16x16x32_bf16 v[200:203], a[136:139], a[56:59], v[200:203]
    s_waitcnt vmcnt(10)
    ds_read_b128 v[128:131], v249 offset:33792
    ds_read_b128 v[132:135], v249 offset:33856
    ds_read_b128 v[136:139], v249 offset:33920
    ds_read_b128 v[140:143], v249 offset:33984
    v_max3_f32 v244, v244, v195, v196
    v_max3_f32 v244, v244, v197, v198
    v_max_f32 v245, v244, v199
    v_max_f32 v244, v244, v199
    v_mfma_f32_16x16x32_bf16 v[200:203], a[140:143], a[60:63], v[200:203]
    s_add_u32 m0, s27, 50752
    v_permlane16_swap_b32 v244, v245
    v_max_f32 v244, v244, v245
    v_mov_b32 v245, v244
    v_mfma_f32_16x16x32_bf16 v[204:207], a[156:159], a[60:63], 0
    buffer_load_dwordx4 v248, s[8:11], s24 offen offset:2048 nt lds
    v_permlane32_swap_b32 v244, v245
    v_max_f32 v244, v244, v245
    v_sub_f32 v228, 0x41c00000, v244
    v_mfma_f32_16x16x32_bf16 v[204:207], a[152:155], a[56:59], v[204:207]
    s_waitcnt lgkmcnt(0)
    v_add_f32 v192, v192, v228
    v_add_f32 v193, v193, v228
    v_add_f32 v194, v194, v228
    v_add_f32 v195, v195, v228
    v_lshlrev_b32 v144, 16, v128
    v_lshlrev_b32 v146, 16, v129
    v_lshlrev_b32 v148, 16, v130
    v_lshlrev_b32 v150, 16, v131
    v_and_b32 v145, 0xffff0000, v128
    v_and_b32 v147, 0xffff0000, v129
    v_and_b32 v149, 0xffff0000, v130
    v_and_b32 v151, 0xffff0000, v131
    v_pk_mul_f32 v[144:145], v[144:145], s[32:33]
    v_pk_mul_f32 v[146:147], v[146:147], s[32:33]
    v_pk_mul_f32 v[148:149], v[148:149], s[32:33]
    v_pk_mul_f32 v[150:151], v[150:151], s[32:33]
    v_cvt_pk_bf16_f32 v128, v144, v145
    v_cvt_pk_bf16_f32 v129, v146, v147
    v_cvt_pk_bf16_f32 v130, v148, v149
    v_cvt_pk_bf16_f32 v131, v150, v151
    v_accvgpr_write_b32 a64, v128
    v_accvgpr_write_b32 a65, v129
    v_accvgpr_write_b32 a66, v130
    v_accvgpr_write_b32 a67, v131
    v_lshlrev_b32 v152, 16, v132
    v_lshlrev_b32 v154, 16, v133
    v_lshlrev_b32 v156, 16, v134
    v_lshlrev_b32 v158, 16, v135
    v_and_b32 v153, 0xffff0000, v132
    v_and_b32 v155, 0xffff0000, v133
    v_and_b32 v157, 0xffff0000, v134
    v_and_b32 v159, 0xffff0000, v135
    v_pk_mul_f32 v[152:153], v[152:153], s[32:33]
    v_pk_mul_f32 v[154:155], v[154:155], s[32:33]
    v_pk_mul_f32 v[156:157], v[156:157], s[32:33]
    v_pk_mul_f32 v[158:159], v[158:159], s[32:33]
    v_cvt_pk_bf16_f32 v132, v152, v153
    v_cvt_pk_bf16_f32 v133, v154, v155
    v_cvt_pk_bf16_f32 v134, v156, v157
    v_cvt_pk_bf16_f32 v135, v158, v159
    v_accvgpr_write_b32 a68, v132
    v_accvgpr_write_b32 a69, v133
    v_accvgpr_write_b32 a70, v134
    v_accvgpr_write_b32 a71, v135
    v_lshlrev_b32 v144, 16, v136
    v_lshlrev_b32 v146, 16, v137
    v_lshlrev_b32 v148, 16, v138
    v_lshlrev_b32 v150, 16, v139
    v_and_b32 v145, 0xffff0000, v136
    v_and_b32 v147, 0xffff0000, v137
    v_and_b32 v149, 0xffff0000, v138
    v_and_b32 v151, 0xffff0000, v139
    v_pk_mul_f32 v[144:145], v[144:145], s[32:33]
    v_pk_mul_f32 v[146:147], v[146:147], s[32:33]
    v_pk_mul_f32 v[148:149], v[148:149], s[32:33]
    v_pk_mul_f32 v[150:151], v[150:151], s[32:33]
    v_cvt_pk_bf16_f32 v136, v144, v145
    v_cvt_pk_bf16_f32 v137, v146, v147
    v_cvt_pk_bf16_f32 v138, v148, v149
    v_cvt_pk_bf16_f32 v139, v150, v151
    v_accvgpr_write_b32 a72, v136
    v_accvgpr_write_b32 a73, v137
    v_accvgpr_write_b32 a74, v138
    v_accvgpr_write_b32 a75, v139
    v_lshlrev_b32 v152, 16, v140
    v_lshlrev_b32 v154, 16, v141
    v_lshlrev_b32 v156, 16, v142
    v_lshlrev_b32 v158, 16, v143
    v_and_b32 v153, 0xffff0000, v140
    v_and_b32 v155, 0xffff0000, v141
    v_and_b32 v157, 0xffff0000, v142
    v_and_b32 v159, 0xffff0000, v143
    v_pk_mul_f32 v[152:153], v[152:153], s[32:33]
    v_pk_mul_f32 v[154:155], v[154:155], s[32:33]
    v_pk_mul_f32 v[156:157], v[156:157], s[32:33]
    v_pk_mul_f32 v[158:159], v[158:159], s[32:33]
    v_cvt_pk_bf16_f32 v140, v152, v153
    v_cvt_pk_bf16_f32 v141, v154, v155
    v_cvt_pk_bf16_f32 v142, v156, v157
    v_cvt_pk_bf16_f32 v143, v158, v159
    v_accvgpr_write_b32 a76, v140
    v_accvgpr_write_b32 a77, v141
    v_accvgpr_write_b32 a78, v142
    v_accvgpr_write_b32 a79, v143
    v_mfma_f32_16x16x32_bf16 v[204:207], a[148:151], a[52:55], v[204:207]
    s_add_u32 m0, s27, 50784
    v_exp_f32 v192, v192
    v_exp_f32 v193, v193
    v_exp_f32 v194, v194
    v_exp_f32 v195, v195
    v_mfma_f32_16x16x32_bf16 v[204:207], a[144:147], a[48:51], v[204:207]
    s_waitcnt vmcnt(7)
    ds_read_b128 v[160:163], v249 offset:50688
    v_cvt_pk_bf16_f32 v208, v192, v193
    v_cvt_pk_bf16_f32 v209, v194, v195
    v_mfma_f32_16x16x32_bf16 v[192:195], a[96:99], a[64:67], 0
    v_add_f32 v196, v196, v228
    v_add_f32 v197, v197, v228
    v_mfma_f32_16x16x32_bf16 v[192:195], a[100:103], a[68:71], v[192:195]
    ds_read_b128 v[164:167], v249 offset:50752
    v_add_f32 v198, v198, v228
    v_add_f32 v199, v199, v228
    v_mfma_f32_16x16x32_bf16 v[192:195], a[104:107], a[72:75], v[192:195]
    v_exp_f32 v196, v196
    v_exp_f32 v197, v197
    v_exp_f32 v198, v198
    v_exp_f32 v199, v199
    v_mfma_f32_16x16x32_bf16 v[192:195], a[108:111], a[76:79], v[192:195]
    ds_read_b128 v[168:171], v249 offset:50816
    v_cvt_pk_bf16_f32 v210, v196, v197
    v_cvt_pk_bf16_f32 v211, v198, v199
    v_mfma_f32_16x16x32_bf16 v[196:199], a[124:127], a[76:79], 0
    v_add_f32 v200, v200, v228
    v_add_f32 v201, v201, v228
    v_mfma_f32_16x16x32_bf16 v[196:199], a[120:123], a[72:75], v[196:199]
    ds_read_b128 v[172:175], v249 offset:50880
    v_add_f32 v202, v202, v228
    v_add_f32 v203, v203, v228
    v_max3_f32 v244, v192, v193, v194
    v_mfma_f32_16x16x32_bf16 v[196:199], a[116:119], a[68:71], v[196:199]
    v_exp_f32 v200, v200
    v_exp_f32 v201, v201
    v_exp_f32 v202, v202
    v_exp_f32 v203, v203
    v_mfma_f32_16x16x32_bf16 v[196:199], a[112:115], a[64:67], v[196:199]
    v_cvt_pk_bf16_f32 v212, v200, v201
    v_cvt_pk_bf16_f32 v213, v202, v203
    v_mfma_f32_16x16x32_bf16 v[200:203], a[128:131], a[64:67], 0
    buffer_load_dwordx4 v248, s[8:11], s24 offen offset:3072 nt lds
    v_mfma_f32_16x16x32_bf16 v[200:203], a[132:135], a[68:71], v[200:203]
    s_add_u32 s24, s24, 8192
    v_add_f32 v204, v204, v228
    v_add_f32 v205, v205, v228
    v_add_f32 v206, v206, v228
    v_add_f32 v207, v207, v228
    v_max3_f32 v244, v244, v195, v196
    v_max3_f32 v244, v244, v197, v198
    v_max_f32 v245, v244, v199
    v_max_f32 v244, v244, v199
    v_mfma_f32_16x16x32_bf16 v[200:203], a[136:139], a[72:75], v[200:203]
    s_waitcnt lgkmcnt(0)
    v_exp_f32 v204, v204
    v_exp_f32 v205, v205
    v_exp_f32 v206, v206
    v_exp_f32 v207, v207
    v_permlane16_swap_b32 v244, v245
    v_max_f32 v244, v244, v245
    v_mov_b32 v245, v244
    v_lshlrev_b32 v176, 16, v160
    v_lshlrev_b32 v178, 16, v161
    v_lshlrev_b32 v180, 16, v162
    v_lshlrev_b32 v182, 16, v163
    v_and_b32 v177, 0xffff0000, v160
    v_and_b32 v179, 0xffff0000, v161
    v_and_b32 v181, 0xffff0000, v162
    v_and_b32 v183, 0xffff0000, v163
    v_pk_mul_f32 v[176:177], v[176:177], s[32:33]
    v_pk_mul_f32 v[178:179], v[178:179], s[32:33]
    v_pk_mul_f32 v[180:181], v[180:181], s[32:33]
    v_pk_mul_f32 v[182:183], v[182:183], s[32:33]
    v_cvt_pk_bf16_f32 v160, v176, v177
    v_cvt_pk_bf16_f32 v161, v178, v179
    v_cvt_pk_bf16_f32 v162, v180, v181
    v_cvt_pk_bf16_f32 v163, v182, v183
    v_accvgpr_write_b32 a80, v160
    v_accvgpr_write_b32 a81, v161
    v_accvgpr_write_b32 a82, v162
    v_accvgpr_write_b32 a83, v163
    v_lshlrev_b32 v184, 16, v164
    v_lshlrev_b32 v186, 16, v165
    v_lshlrev_b32 v188, 16, v166
    v_lshlrev_b32 v190, 16, v167
    v_and_b32 v185, 0xffff0000, v164
    v_and_b32 v187, 0xffff0000, v165
    v_and_b32 v189, 0xffff0000, v166
    v_and_b32 v191, 0xffff0000, v167
    v_pk_mul_f32 v[184:185], v[184:185], s[32:33]
    v_pk_mul_f32 v[186:187], v[186:187], s[32:33]
    v_pk_mul_f32 v[188:189], v[188:189], s[32:33]
    v_pk_mul_f32 v[190:191], v[190:191], s[32:33]
    v_cvt_pk_bf16_f32 v164, v184, v185
    v_cvt_pk_bf16_f32 v165, v186, v187
    v_cvt_pk_bf16_f32 v166, v188, v189
    v_cvt_pk_bf16_f32 v167, v190, v191
    v_accvgpr_write_b32 a84, v164
    v_accvgpr_write_b32 a85, v165
    v_accvgpr_write_b32 a86, v166
    v_accvgpr_write_b32 a87, v167
    v_lshlrev_b32 v176, 16, v168
    v_lshlrev_b32 v178, 16, v169
    v_lshlrev_b32 v180, 16, v170
    v_lshlrev_b32 v182, 16, v171
    v_and_b32 v177, 0xffff0000, v168
    v_and_b32 v179, 0xffff0000, v169
    v_and_b32 v181, 0xffff0000, v170
    v_and_b32 v183, 0xffff0000, v171
    v_pk_mul_f32 v[176:177], v[176:177], s[32:33]
    v_pk_mul_f32 v[178:179], v[178:179], s[32:33]
    v_pk_mul_f32 v[180:181], v[180:181], s[32:33]
    v_pk_mul_f32 v[182:183], v[182:183], s[32:33]
    v_cvt_pk_bf16_f32 v168, v176, v177
    v_cvt_pk_bf16_f32 v169, v178, v179
    v_cvt_pk_bf16_f32 v170, v180, v181
    v_cvt_pk_bf16_f32 v171, v182, v183
    v_accvgpr_write_b32 a88, v168
    v_accvgpr_write_b32 a89, v169
    v_accvgpr_write_b32 a90, v170
    v_accvgpr_write_b32 a91, v171
    v_lshlrev_b32 v184, 16, v172
    v_lshlrev_b32 v186, 16, v173
    v_lshlrev_b32 v188, 16, v174
    v_lshlrev_b32 v190, 16, v175
    v_and_b32 v185, 0xffff0000, v172
    v_and_b32 v187, 0xffff0000, v173
    v_and_b32 v189, 0xffff0000, v174
    v_and_b32 v191, 0xffff0000, v175
    v_pk_mul_f32 v[184:185], v[184:185], s[32:33]
    v_pk_mul_f32 v[186:187], v[186:187], s[32:33]
    v_pk_mul_f32 v[188:189], v[188:189], s[32:33]
    v_pk_mul_f32 v[190:191], v[190:191], s[32:33]
    v_cvt_pk_bf16_f32 v172, v184, v185
    v_cvt_pk_bf16_f32 v173, v186, v187
    v_cvt_pk_bf16_f32 v174, v188, v189
    v_cvt_pk_bf16_f32 v175, v190, v191
    v_accvgpr_write_b32 a92, v172
    v_accvgpr_write_b32 a93, v173
    v_accvgpr_write_b32 a94, v174
    v_accvgpr_write_b32 a95, v175
    v_mfma_f32_16x16x32_bf16 v[200:203], a[140:143], a[76:79], v[200:203]
    v_cvt_pk_bf16_f32 v214, v204, v205
    v_cvt_pk_bf16_f32 v215, v206, v207
    v_permlane32_swap_b32 v244, v245
    v_max_f32 v244, v244, v245
    v_sub_f32 v232, 0x41c00000, v244
    v_mfma_f32_16x16x32_bf16 v[204:207], a[156:159], a[76:79], 0
    v_add_f32 v192, v192, v232
    v_add_f32 v193, v193, v232
    v_mfma_f32_16x16x32_bf16 v[204:207], a[152:155], a[72:75], v[204:207]
    v_add_f32 v194, v194, v232
    v_add_f32 v195, v195, v232
    v_mfma_f32_16x16x32_bf16 v[204:207], a[148:151], a[68:71], v[204:207]
    v_exp_f32 v192, v192
    v_mfma_f32_16x16x32_bf16 v[204:207], a[144:147], a[64:67], v[204:207]
    v_exp_f32 v193, v193
    v_mfma_f32_16x16x32_bf16 a[240:243], a[224:227], v[208:211], 0
    v_exp_f32 v194, v194
    v_mfma_f32_16x16x32_bf16 a[240:243], a[224:227], v[212:215], a[240:243]
    v_exp_f32 v195, v195
    v_mfma_f32_16x16x32_bf16 v[96:99], a[192:195], v[212:215], 0
    v_cvt_pk_bf16_f32 v240, v192, v193
    v_cvt_pk_bf16_f32 v241, v194, v195
    v_mfma_f32_16x16x32_bf16 v[96:99], a[160:163], v[208:211], v[96:99]
    v_add_f32 v196, v196, v232
    v_add_f32 v197, v197, v232
    v_mfma_f32_16x16x32_bf16 v[100:103], a[164:167], v[208:211], 0
    v_add_f32 v198, v198, v232
    v_add_f32 v199, v199, v232
    v_mfma_f32_16x16x32_bf16 v[100:103], a[196:199], v[212:215], v[100:103]
    v_exp_f32 v196, v196
    v_mfma_f32_16x16x32_bf16 v[104:107], a[200:203], v[212:215], 0
    v_exp_f32 v197, v197
    v_mfma_f32_16x16x32_bf16 v[104:107], a[168:171], v[208:211], v[104:107]
    v_exp_f32 v198, v198
    v_mfma_f32_16x16x32_bf16 v[108:111], a[172:175], v[208:211], 0
    v_exp_f32 v199, v199
    v_mfma_f32_16x16x32_bf16 v[108:111], a[204:207], v[212:215], v[108:111]
    v_cvt_pk_bf16_f32 v242, v196, v197
    v_cvt_pk_bf16_f32 v243, v198, v199
    v_mfma_f32_16x16x32_bf16 v[112:115], a[208:211], v[212:215], 0
    v_add_f32 v200, v200, v232
    v_add_f32 v201, v201, v232
    v_mfma_f32_16x16x32_bf16 v[112:115], a[176:179], v[208:211], v[112:115]
    v_add_f32 v202, v202, v232
    v_add_f32 v203, v203, v232
    v_mfma_f32_16x16x32_bf16 v[116:119], a[180:183], v[208:211], 0
    v_exp_f32 v200, v200
    v_mfma_f32_16x16x32_bf16 v[116:119], a[212:215], v[212:215], v[116:119]
    v_exp_f32 v201, v201
    v_mfma_f32_16x16x32_bf16 v[120:123], a[216:219], v[212:215], 0
    v_exp_f32 v202, v202
    v_mfma_f32_16x16x32_bf16 v[120:123], a[184:187], v[208:211], v[120:123]
    v_exp_f32 v203, v203
    v_mfma_f32_16x16x32_bf16 v[124:127], a[188:191], v[208:211], 0
    v_cvt_pk_bf16_f32 v252, v200, v201
    v_cvt_pk_bf16_f32 v253, v202, v203
    v_mfma_f32_16x16x32_bf16 v[124:127], a[220:223], v[212:215], v[124:127]
    v_add_f32 v204, v204, v232
    v_add_f32 v205, v205, v232
    v_mfma_f32_16x16x32_bf16 v[192:195], a[96:99], a[80:83], 0
    v_add_f32 v206, v206, v232
    v_add_f32 v207, v207, v232
    v_mfma_f32_16x16x32_bf16 v[192:195], a[100:103], a[84:87], v[192:195]
    v_exp_f32 v204, v204
    v_mfma_f32_16x16x32_bf16 v[192:195], a[104:107], a[88:91], v[192:195]
    v_exp_f32 v205, v205
    v_mfma_f32_16x16x32_bf16 v[192:195], a[108:111], a[92:95], v[192:195]
    v_exp_f32 v206, v206
    v_mfma_f32_16x16x32_bf16 v[196:199], a[124:127], a[92:95], 0
    v_exp_f32 v207, v207
    v_mfma_f32_16x16x32_bf16 v[196:199], a[120:123], a[88:91], v[196:199]
    v_cvt_pk_bf16_f32 v254, v204, v205
    v_cvt_pk_bf16_f32 v255, v206, v207
    v_mfma_f32_16x16x32_bf16 v[196:199], a[116:119], a[84:87], v[196:199]
    v_mov_b32 v229, v228
    v_max3_f32 v244, v192, v193, v194
    v_mfma_f32_16x16x32_bf16 v[196:199], a[112:115], a[80:83], v[196:199]
    s_add_u32 m0, s27, 67584
    v_mov_b32 v230, v228
    v_mov_b32 v231, v228
    v_mfma_f32_16x16x32_bf16 v[200:203], a[128:131], a[80:83], 0
    buffer_load_dwordx4 v248, s[8:11], s24 offen nt lds
    v_mfma_f32_16x16x32_bf16 v[200:203], a[132:135], a[84:87], v[200:203]
    s_add_u32 m0, s27, 67616
    v_mov_b32 v233, v232
    v_max3_f32 v244, v244, v195, v196
    v_max3_f32 v244, v244, v197, v198
    v_max_f32 v245, v244, v199
    v_max_f32 v244, v244, v199
    v_mfma_f32_16x16x32_bf16 v[200:203], a[136:139], a[88:91], v[200:203]
    buffer_load_dwordx4 v248, s[8:11], s24 offen offset:1024 nt lds
    v_permlane16_swap_b32 v244, v245
    v_max_f32 v244, v244, v245
    v_mov_b32 v245, v244
    v_mfma_f32_16x16x32_bf16 v[200:203], a[140:143], a[92:95], v[200:203]
    s_add_u32 m0, s27, 67648
    v_permlane32_swap_b32 v244, v245
    v_max_f32 v244, v244, v245
    v_sub_f32 v236, 0x41c00000, v244
    v_mfma_f32_16x16x32_bf16 v[204:207], a[156:159], a[92:95], 0
    buffer_load_dwordx4 v248, s[8:11], s24 offen offset:2048 nt lds
    v_mfma_f32_16x16x32_bf16 v[204:207], a[152:155], a[88:91], v[204:207]
    s_add_u32 m0, s27, 67680
    v_add_f32 v192, v192, v236
    v_add_f32 v193, v193, v236
    v_mfma_f32_16x16x32_bf16 v[204:207], a[148:151], a[84:87], v[204:207]
    buffer_load_dwordx4 v248, s[8:11], s24 offen offset:3072 nt lds
    v_mfma_f32_16x16x32_bf16 v[204:207], a[144:147], a[80:83], v[204:207]
    s_add_u32 s24, s24, 8192
    v_add_f32 v194, v194, v236
    v_add_f32 v195, v195, v236
    v_mfma_f32_16x16x32_bf16 a[244:247], a[224:227], v[240:243], 0
    v_exp_f32 v192, v192
    v_mfma_f32_16x16x32_bf16 a[244:247], a[224:227], v[252:255], a[244:247]
    v_exp_f32 v193, v193
    v_mfma_f32_16x16x32_bf16 v[128:131], a[192:195], v[252:255], 0
    v_exp_f32 v194, v194
    v_mfma_f32_16x16x32_bf16 v[128:131], a[160:163], v[240:243], v[128:131]
    v_exp_f32 v195, v195
    v_mfma_f32_16x16x32_bf16 v[132:135], a[164:167], v[240:243], 0
    v_cvt_pk_bf16_f32 v208, v192, v193
    v_cvt_pk_bf16_f32 v209, v194, v195
    v_mfma_f32_16x16x32_bf16 v[132:135], a[196:199], v[252:255], v[132:135]
    v_add_f32 v196, v196, v236
    v_add_f32 v197, v197, v236
    v_mfma_f32_16x16x32_bf16 v[136:139], a[200:203], v[252:255], 0
    s_waitcnt vmcnt(4)
    s_barrier
    ds_read_b128 a[96:99], v246 offset:33792
    ds_read_b128 a[100:103], v246 offset:33856
    ds_read_b128 a[104:107], v246 offset:33920
    ds_read_b128 a[108:111], v246 offset:33984
    ds_read_b128 a[124:127], v246 offset:34496
    ds_read_b128 a[128:131], v246 offset:50688
    ds_read_b128 a[120:123], v246 offset:34432
    ds_read_b128 a[132:135], v246 offset:50752
    v_mfma_f32_16x16x32_bf16 v[136:139], a[168:171], v[240:243], v[136:139]
    v_add_f32 v198, v198, v236
    v_add_f32 v199, v199, v236
    v_mfma_f32_16x16x32_bf16 v[140:143], a[172:175], v[240:243], 0
    ds_read_b128 a[116:119], v246 offset:34368
    ds_read_b128 a[136:139], v246 offset:50816
    v_mfma_f32_16x16x32_bf16 v[140:143], a[204:207], v[252:255], v[140:143]
    v_exp_f32 v196, v196
    v_mfma_f32_16x16x32_bf16 v[144:147], a[208:211], v[252:255], 0
    ds_read_b128 a[112:115], v246 offset:34304
    ds_read_b128 a[140:143], v246 offset:50880
    v_mfma_f32_16x16x32_bf16 v[144:147], a[176:179], v[240:243], v[144:147]
    v_exp_f32 v197, v197
    v_mfma_f32_16x16x32_bf16 v[148:151], a[180:183], v[240:243], 0
    ds_read_b128 a[156:159], v246 offset:51392
    ds_read_b128 a[152:155], v246 offset:51328
    v_mfma_f32_16x16x32_bf16 v[148:151], a[212:215], v[252:255], v[148:151]
    v_exp_f32 v198, v198
    v_mfma_f32_16x16x32_bf16 v[152:155], a[216:219], v[252:255], 0
    ds_read_b128 a[148:151], v246 offset:51264
    ds_read_b128 a[144:147], v246 offset:51200
    v_mfma_f32_16x16x32_bf16 v[152:155], a[184:187], v[240:243], v[152:155]
    v_exp_f32 v199, v199
    v_mfma_f32_16x16x32_bf16 v[156:159], a[188:191], v[240:243], 0
    v_cvt_pk_bf16_f32 v210, v196, v197
    v_cvt_pk_bf16_f32 v211, v198, v199
    v_mfma_f32_16x16x32_bf16 v[156:159], a[220:223], v[252:255], v[156:159]
    s_waitcnt lgkmcnt(5)
    v_add_f32 v200, v200, v236
    v_add_f32 v201, v201, v236
    v_mfma_f32_16x16x32_bf16 v[192:195], a[96:99], a[0:3], v[216:219]
    v_add_f32 v202, v202, v236
    v_add_f32 v203, v203, v236
    v_mfma_f32_16x16x32_bf16 v[192:195], a[100:103], a[4:7], v[192:195]
    v_exp_f32 v200, v200
    v_mfma_f32_16x16x32_bf16 v[192:195], a[104:107], a[8:11], v[192:195]
    v_exp_f32 v201, v201
    v_mfma_f32_16x16x32_bf16 v[192:195], a[108:111], a[12:15], v[192:195]
    v_exp_f32 v202, v202
    v_mfma_f32_16x16x32_bf16 v[196:199], a[124:127], a[12:15], v[216:219]
    v_exp_f32 v203, v203
    v_mfma_f32_16x16x32_bf16 v[196:199], a[120:123], a[8:11], v[196:199]
    s_waitcnt lgkmcnt(0)
    v_cvt_pk_bf16_f32 v212, v200, v201
    v_cvt_pk_bf16_f32 v213, v202, v203
    v_mfma_f32_16x16x32_bf16 v[196:199], a[116:119], a[4:7], v[196:199]
    v_add_f32 v204, v204, v236
    v_add_f32 v205, v205, v236
    v_mfma_f32_16x16x32_bf16 v[196:199], a[112:115], a[0:3], v[196:199]
    v_add_f32 v206, v206, v236
    v_add_f32 v207, v207, v236
    v_mfma_f32_16x16x32_bf16 v[200:203], a[128:131], a[0:3], v[216:219]
    v_exp_f32 v204, v204
    v_mfma_f32_16x16x32_bf16 v[200:203], a[132:135], a[4:7], v[200:203]
    v_exp_f32 v205, v205
    v_mfma_f32_16x16x32_bf16 v[200:203], a[136:139], a[8:11], v[200:203]
    v_exp_f32 v206, v206
    v_exp_f32 v207, v207
    v_mfma_f32_16x16x32_bf16 v[200:203], a[140:143], a[12:15], v[200:203]
Lhop1:
    s_cbranch_execz Lret0
    v_cvt_pk_bf16_f32 v214, v204, v205
    v_cvt_pk_bf16_f32 v215, v206, v207
    v_mfma_f32_16x16x32_bf16 v[204:207], a[156:159], a[12:15], v[216:219]
    v_exp_f32 v192, v192
    v_mfma_f32_16x16x32_bf16 v[204:207], a[152:155], a[8:11], v[204:207]
    v_exp_f32 v193, v193
    v_mfma_f32_16x16x32_bf16 v[204:207], a[148:151], a[4:7], v[204:207]
    v_exp_f32 v194, v194
    v_mfma_f32_16x16x32_bf16 v[204:207], a[144:147], a[0:3], v[204:207]
    v_exp_f32 v195, v195
    v_mfma_f32_16x16x32_bf16 a[248:251], a[224:227], v[208:211], 0
    v_cvt_pk_bf16_f32 v240, v192, v193
    v_cvt_pk_bf16_f32 v241, v194, v195
    v_mfma_f32_16x16x32_bf16 a[248:251], a[224:227], v[212:215], a[248:251]
    v_exp_f32 v196, v196
    v_mfma_f32_16x16x32_bf16 v[160:163], a[192:195], v[212:215], 0
    ds_read_b64_tr_b16 a[192:193], v247 offset:59136
    ds_read_b64_tr_b16 a[194:195], v247 offset:59648
    v_mfma_f32_16x16x32_bf16 v[160:163], a[160:163], v[208:211], v[160:163]
    v_exp_f32 v197, v197
    v_mfma_f32_16x16x32_bf16 v[164:167], a[164:167], v[208:211], 0
    ds_read_b64_tr_b16 a[160:161], v247 offset:42240
    ds_read_b64_tr_b16 a[162:163], v247 offset:42752
    v_mfma_f32_16x16x32_bf16 v[164:167], a[196:199], v[212:215], v[164:167]
    v_exp_f32 v198, v198
    v_mfma_f32_16x16x32_bf16 v[168:171], a[200:203], v[212:215], 0
    ds_read_b64_tr_b16 a[164:165], v247 offset:42248
    ds_read_b64_tr_b16 a[166:167], v247 offset:42760
    v_mfma_f32_16x16x32_bf16 v[168:171], a[168:171], v[208:211], v[168:171]
    v_exp_f32 v199, v199
    v_mfma_f32_16x16x32_bf16 v[172:175], a[172:175], v[208:211], 0
    ds_read_b64_tr_b16 a[196:197], v247 offset:59144
    ds_read_b64_tr_b16 a[198:199], v247 offset:59656
    v_mfma_f32_16x16x32_bf16 v[172:175], a[204:207], v[212:215], v[172:175]
    v_cvt_pk_bf16_f32 v242, v196, v197
    v_cvt_pk_bf16_f32 v243, v198, v199
    v_mfma_f32_16x16x32_bf16 v[176:179], a[208:211], v[212:215], 0
    ds_read_b64_tr_b16 a[168:169], v247 offset:42304
    ds_read_b64_tr_b16 a[170:171], v247 offset:42816
    v_mfma_f32_16x16x32_bf16 v[176:179], a[176:179], v[208:211], v[176:179]
    v_exp_f32 v200, v200
    v_mfma_f32_16x16x32_bf16 v[180:183], a[180:183], v[208:211], 0
    ds_read_b64_tr_b16 a[200:201], v247 offset:59200
    ds_read_b64_tr_b16 a[202:203], v247 offset:59712
    v_mfma_f32_16x16x32_bf16 v[180:183], a[212:215], v[212:215], v[180:183]
    v_exp_f32 v201, v201
    v_mfma_f32_16x16x32_bf16 v[184:187], a[216:219], v[212:215], 0
    ds_read_b64_tr_b16 a[172:173], v247 offset:42312
    ds_read_b64_tr_b16 a[174:175], v247 offset:42824
    v_mfma_f32_16x16x32_bf16 v[184:187], a[184:187], v[208:211], v[184:187]
    v_exp_f32 v202, v202
    v_mfma_f32_16x16x32_bf16 v[188:191], a[188:191], v[208:211], 0
    ds_read_b64_tr_b16 a[204:205], v247 offset:59208
    ds_read_b64_tr_b16 a[206:207], v247 offset:59720
    v_mfma_f32_16x16x32_bf16 v[188:191], a[220:223], v[212:215], v[188:191]
    v_exp_f32 v203, v203
    v_mfma_f32_16x16x32_bf16 v[192:195], a[96:99], a[16:19], v[220:223]
    ds_read_b64_tr_b16 a[176:177], v247 offset:42368
    v_cvt_pk_bf16_f32 v252, v200, v201
    v_mfma_f32_16x16x32_bf16 v[192:195], a[100:103], a[20:23], v[192:195]
    ds_read_b64_tr_b16 a[178:179], v247 offset:42880
    v_cvt_pk_bf16_f32 v253, v202, v203
    v_mfma_f32_16x16x32_bf16 v[192:195], a[104:107], a[24:27], v[192:195]
    ds_read_b64_tr_b16 a[208:209], v247 offset:59264
    v_mov_b32 v234, v232
    v_mfma_f32_16x16x32_bf16 v[192:195], a[108:111], a[28:31], v[192:195]
    v_exp_f32 v204, v204
    v_mfma_f32_16x16x32_bf16 v[196:199], a[124:127], a[28:31], v[220:223]
    v_exp_f32 v205, v205
    v_mfma_f32_16x16x32_bf16 v[196:199], a[120:123], a[24:27], v[196:199]
    v_exp_f32 v206, v206
    v_mfma_f32_16x16x32_bf16 v[196:199], a[116:119], a[20:23], v[196:199]
    v_exp_f32 v207, v207
    v_mfma_f32_16x16x32_bf16 v[196:199], a[112:115], a[16:19], v[196:199]
    ds_read_b64_tr_b16 a[210:211], v247 offset:59776
    v_cvt_pk_bf16_f32 v254, v204, v205
    v_mfma_f32_16x16x32_bf16 v[200:203], a[128:131], a[16:19], v[220:223]
    ds_read_b64_tr_b16 a[180:181], v247 offset:42376
    v_cvt_pk_bf16_f32 v255, v206, v207
    v_mfma_f32_16x16x32_bf16 v[200:203], a[132:135], a[20:23], v[200:203]
    ds_read_b64_tr_b16 a[182:183], v247 offset:42888
    v_mov_b32 v235, v232
    v_mfma_f32_16x16x32_bf16 v[200:203], a[136:139], a[24:27], v[200:203]
    s_add_u32 m0, s27, 84480
    ds_read_b64_tr_b16 a[212:213], v247 offset:59272
    v_mov_b32 v237, v236
    v_mfma_f32_16x16x32_bf16 v[200:203], a[140:143], a[28:31], v[200:203]
    ds_read_b64_tr_b16 a[214:215], v247 offset:59784
    v_mov_b32 v238, v236
    v_mfma_f32_16x16x32_bf16 v[204:207], a[156:159], a[28:31], v[220:223]
    ds_read_b64_tr_b16 a[184:185], v247 offset:42432
    v_mov_b32 v239, v236
    v_mfma_f32_16x16x32_bf16 v[204:207], a[152:155], a[24:27], v[204:207]
    buffer_load_dwordx4 v248, s[8:11], s24 offen nt lds
    v_mfma_f32_16x16x32_bf16 v[204:207], a[148:151], a[20:23], v[204:207]
    s_add_u32 m0, s27, 84512
    ds_read_b64_tr_b16 a[186:187], v247 offset:42944
    ds_read_b64_tr_b16 a[216:217], v247 offset:59328
    v_mfma_f32_16x16x32_bf16 v[204:207], a[144:147], a[16:19], v[204:207]
    s_waitcnt lgkmcnt(15)
    buffer_load_dwordx4 v248, s[8:11], s24 offen offset:1024 nt lds
    v_mfma_f32_16x16x32_bf16 a[228:231], a[224:227], v[240:243], a[228:231]
    s_add_u32 m0, s27, 84544
    ds_read_b64_tr_b16 a[218:219], v247 offset:59840
    ds_read_b64_tr_b16 a[188:189], v247 offset:42440
    v_mfma_f32_16x16x32_bf16 a[228:231], a[224:227], v[252:255], a[228:231]
    buffer_load_dwordx4 v248, s[8:11], s24 offen offset:2048 nt lds
    v_mfma_f32_16x16x32_bf16 v[0:3], a[192:195], v[252:255], v[0:3]
    s_add_u32 m0, s27, 84576
    ds_read_b64_tr_b16 a[190:191], v247 offset:42952
    ds_read_b64_tr_b16 a[220:221], v247 offset:59336
    v_mfma_f32_16x16x32_bf16 v[0:3], a[160:163], v[240:243], v[0:3]
    s_waitcnt lgkmcnt(15)
    buffer_load_dwordx4 v248, s[8:11], s24 offen offset:3072 nt lds
    v_mfma_f32_16x16x32_bf16 v[4:7], a[164:167], v[240:243], v[4:7]
    s_add_u32 s24, s24, 8192
    v_exp_f32 v192, v192
    v_mfma_f32_16x16x32_bf16 v[4:7], a[196:199], v[252:255], v[4:7]
    v_exp_f32 v193, v193
    v_mfma_f32_16x16x32_bf16 v[8:11], a[200:203], v[252:255], v[8:11]
    ds_read_b64_tr_b16 a[222:223], v247 offset:59848
    v_cvt_pk_bf16_f32 v208, v192, v193
    v_mfma_f32_16x16x32_bf16 v[8:11], a[168:171], v[240:243], v[8:11]
    s_waitcnt lgkmcnt(8)
    v_exp_f32 v194, v194
    v_mfma_f32_16x16x32_bf16 v[12:15], a[172:175], v[240:243], v[12:15]
    v_exp_f32 v195, v195
    v_mfma_f32_16x16x32_bf16 v[12:15], a[204:207], v[252:255], v[12:15]
    v_exp_f32 v196, v196
    v_mfma_f32_16x16x32_bf16 v[16:19], a[208:211], v[252:255], v[16:19]
    v_exp_f32 v197, v197
    v_mfma_f32_16x16x32_bf16 v[16:19], a[176:179], v[240:243], v[16:19]
    v_cvt_pk_bf16_f32 v209, v194, v195
    v_cvt_pk_bf16_f32 v210, v196, v197
    v_mfma_f32_16x16x32_bf16 v[20:23], a[180:183], v[240:243], v[20:23]
    v_exp_f32 v198, v198
    v_mfma_f32_16x16x32_bf16 v[20:23], a[212:215], v[252:255], v[20:23]
    s_waitcnt lgkmcnt(0)
    v_exp_f32 v199, v199
    v_mfma_f32_16x16x32_bf16 v[24:27], a[216:219], v[252:255], v[24:27]
    v_exp_f32 v200, v200
    v_mfma_f32_16x16x32_bf16 v[24:27], a[184:187], v[240:243], v[24:27]
    v_exp_f32 v201, v201
    v_mfma_f32_16x16x32_bf16 v[28:31], a[188:191], v[240:243], v[28:31]
    v_cvt_pk_bf16_f32 v211, v198, v199
    v_cvt_pk_bf16_f32 v212, v200, v201
    v_mfma_f32_16x16x32_bf16 v[28:31], a[220:223], v[252:255], v[28:31]
    v_exp_f32 v202, v202
    v_mfma_f32_16x16x32_bf16 v[192:195], a[96:99], a[32:35], v[224:227]
    v_exp_f32 v203, v203
    v_mfma_f32_16x16x32_bf16 v[192:195], a[100:103], a[36:39], v[192:195]
    v_exp_f32 v204, v204
    v_mfma_f32_16x16x32_bf16 v[192:195], a[104:107], a[40:43], v[192:195]
    v_exp_f32 v205, v205
    v_mfma_f32_16x16x32_bf16 v[192:195], a[108:111], a[44:47], v[192:195]
    v_cvt_pk_bf16_f32 v213, v202, v203
    v_cvt_pk_bf16_f32 v214, v204, v205
    v_mfma_f32_16x16x32_bf16 v[196:199], a[124:127], a[44:47], v[224:227]
    v_exp_f32 v206, v206
    v_mfma_f32_16x16x32_bf16 v[196:199], a[120:123], a[40:43], v[196:199]
    v_exp_f32 v207, v207
    v_mfma_f32_16x16x32_bf16 v[196:199], a[116:119], a[36:39], v[196:199]
    v_cvt_pk_bf16_f32 v215, v206, v207
    v_mfma_f32_16x16x32_bf16 v[196:199], a[112:115], a[32:35], v[196:199]
    v_exp_f32 v192, v192
    v_mfma_f32_16x16x32_bf16 v[200:203], a[128:131], a[32:35], v[224:227]
    v_exp_f32 v193, v193
    v_mfma_f32_16x16x32_bf16 v[200:203], a[132:135], a[36:39], v[200:203]
    v_exp_f32 v194, v194
    v_mfma_f32_16x16x32_bf16 v[200:203], a[136:139], a[40:43], v[200:203]
    v_exp_f32 v195, v195
    v_mfma_f32_16x16x32_bf16 v[200:203], a[140:143], a[44:47], v[200:203]
    v_cvt_pk_bf16_f32 v240, v192, v193
    v_cvt_pk_bf16_f32 v241, v194, v195
    v_mfma_f32_16x16x32_bf16 v[204:207], a[156:159], a[44:47], v[224:227]
    v_exp_f32 v196, v196
    v_mfma_f32_16x16x32_bf16 v[204:207], a[152:155], a[40:43], v[204:207]
    v_exp_f32 v197, v197
    v_mfma_f32_16x16x32_bf16 v[204:207], a[148:151], a[36:39], v[204:207]
    v_exp_f32 v198, v198
    v_mfma_f32_16x16x32_bf16 v[204:207], a[144:147], a[32:35], v[204:207]
    v_exp_f32 v199, v199
    v_mfma_f32_16x16x32_bf16 a[232:235], a[224:227], v[208:211], a[232:235]
    v_cvt_pk_bf16_f32 v242, v196, v197
    v_cvt_pk_bf16_f32 v243, v198, v199
    v_mfma_f32_16x16x32_bf16 a[232:235], a[224:227], v[212:215], a[232:235]
    v_exp_f32 v200, v200
    v_mfma_f32_16x16x32_bf16 v[32:35], a[192:195], v[212:215], v[32:35]
    v_exp_f32 v201, v201
    v_mfma_f32_16x16x32_bf16 v[32:35], a[160:163], v[208:211], v[32:35]
    v_exp_f32 v202, v202
    v_mfma_f32_16x16x32_bf16 v[36:39], a[164:167], v[208:211], v[36:39]
    v_exp_f32 v203, v203
    v_mfma_f32_16x16x32_bf16 v[36:39], a[196:199], v[212:215], v[36:39]
    v_exp_f32 v204, v204
    v_mfma_f32_16x16x32_bf16 v[40:43], a[200:203], v[212:215], v[40:43]
    v_exp_f32 v205, v205
    v_mfma_f32_16x16x32_bf16 v[40:43], a[168:171], v[208:211], v[40:43]
    v_exp_f32 v206, v206
    v_mfma_f32_16x16x32_bf16 v[44:47], a[172:175], v[208:211], v[44:47]
    v_exp_f32 v207, v207
    v_mfma_f32_16x16x32_bf16 v[44:47], a[204:207], v[212:215], v[44:47]
    v_cvt_pk_bf16_f32 v252, v200, v201
    v_cvt_pk_bf16_f32 v253, v202, v203
    v_mfma_f32_16x16x32_bf16 v[48:51], a[208:211], v[212:215], v[48:51]
    v_cvt_pk_bf16_f32 v254, v204, v205
    v_cvt_pk_bf16_f32 v255, v206, v207
    v_mfma_f32_16x16x32_bf16 v[48:51], a[176:179], v[208:211], v[48:51]
    v_mfma_f32_16x16x32_bf16 v[52:55], a[180:183], v[208:211], v[52:55]
    v_mfma_f32_16x16x32_bf16 v[52:55], a[212:215], v[212:215], v[52:55]
    v_mfma_f32_16x16x32_bf16 v[56:59], a[216:219], v[212:215], v[56:59]
    v_mfma_f32_16x16x32_bf16 v[56:59], a[184:187], v[208:211], v[56:59]
    v_mfma_f32_16x16x32_bf16 v[60:63], a[188:191], v[208:211], v[60:63]
    v_mfma_f32_16x16x32_bf16 v[60:63], a[220:223], v[212:215], v[60:63]
    v_mfma_f32_16x16x32_bf16 v[192:195], a[96:99], a[48:51], v[228:231]
    v_mfma_f32_16x16x32_bf16 v[192:195], a[100:103], a[52:55], v[192:195]
    v_mfma_f32_16x16x32_bf16 v[192:195], a[104:107], a[56:59], v[192:195]
    v_mfma_f32_16x16x32_bf16 v[192:195], a[108:111], a[60:63], v[192:195]
    v_mfma_f32_16x16x32_bf16 v[196:199], a[124:127], a[60:63], v[228:231]
    v_mfma_f32_16x16x32_bf16 v[196:199], a[120:123], a[56:59], v[196:199]
    v_mfma_f32_16x16x32_bf16 v[196:199], a[116:119], a[52:55], v[196:199]
    v_mfma_f32_16x16x32_bf16 v[196:199], a[112:115], a[48:51], v[196:199]
    s_add_u32 m0, s27, 101376
    s_nop 0
    buffer_load_dwordx4 v248, s[8:11], s24 offen nt lds
    s_add_u32 m0, s27, 101408
    s_nop 0
    buffer_load_dwordx4 v248, s[8:11], s24 offen offset:1024 nt lds
    s_add_u32 m0, s27, 101440
    s_nop 0
    buffer_load_dwordx4 v248, s[8:11], s24 offen offset:2048 nt lds
    s_add_u32 m0, s27, 101472
    s_nop 0
    buffer_load_dwordx4 v248, s[8:11], s24 offen offset:3072 nt lds
    s_add_u32 s24, s24, 8192
    v_mfma_f32_16x16x32_bf16 v[200:203], a[128:131], a[48:51], v[228:231]
    v_add_u32 v246, 67584, v246
    v_add_u32 v247, 67584, v247
    v_mfma_f32_16x16x32_bf16 v[200:203], a[132:135], a[52:55], v[200:203]
    v_exp_f32 v192, v192
    v_mfma_f32_16x16x32_bf16 v[200:203], a[136:139], a[56:59], v[200:203]
    v_exp_f32 v193, v193
    v_mfma_f32_16x16x32_bf16 v[200:203], a[140:143], a[60:63], v[200:203]
    v_exp_f32 v194, v194
    v_mfma_f32_16x16x32_bf16 v[204:207], a[156:159], a[60:63], v[228:231]
    v_exp_f32 v195, v195
    v_mfma_f32_16x16x32_bf16 v[204:207], a[152:155], a[56:59], v[204:207]
    v_cvt_pk_bf16_f32 v208, v192, v193
    v_cvt_pk_bf16_f32 v209, v194, v195
    v_mfma_f32_16x16x32_bf16 v[204:207], a[148:151], a[52:55], v[204:207]
    v_exp_f32 v196, v196
    v_mfma_f32_16x16x32_bf16 v[204:207], a[144:147], a[48:51], v[204:207]
    v_exp_f32 v197, v197
    v_mfma_f32_16x16x32_bf16 a[236:239], a[224:227], v[240:243], a[236:239]
    v_exp_f32 v198, v198
    v_mfma_f32_16x16x32_bf16 a[236:239], a[224:227], v[252:255], a[236:239]
    v_exp_f32 v199, v199
    v_mfma_f32_16x16x32_bf16 v[64:67], a[192:195], v[252:255], v[64:67]
    v_cvt_pk_bf16_f32 v210, v196, v197
    v_cvt_pk_bf16_f32 v211, v198, v199
    v_mfma_f32_16x16x32_bf16 v[64:67], a[160:163], v[240:243], v[64:67]
    v_exp_f32 v200, v200
    v_mfma_f32_16x16x32_bf16 v[68:71], a[164:167], v[240:243], v[68:71]
    v_exp_f32 v201, v201
    v_mfma_f32_16x16x32_bf16 v[68:71], a[196:199], v[252:255], v[68:71]
    v_exp_f32 v202, v202
    v_mfma_f32_16x16x32_bf16 v[72:75], a[200:203], v[252:255], v[72:75]
    v_exp_f32 v203, v203
    v_mfma_f32_16x16x32_bf16 v[72:75], a[168:171], v[240:243], v[72:75]
    v_cvt_pk_bf16_f32 v212, v200, v201
    v_cvt_pk_bf16_f32 v213, v202, v203
    v_mfma_f32_16x16x32_bf16 v[76:79], a[172:175], v[240:243], v[76:79]
    v_exp_f32 v204, v204
    v_mfma_f32_16x16x32_bf16 v[76:79], a[204:207], v[252:255], v[76:79]
    v_exp_f32 v205, v205
    v_mfma_f32_16x16x32_bf16 v[80:83], a[208:211], v[252:255], v[80:83]
    v_exp_f32 v206, v206
    v_mfma_f32_16x16x32_bf16 v[80:83], a[176:179], v[240:243], v[80:83]
    v_exp_f32 v207, v207
    v_mfma_f32_16x16x32_bf16 v[84:87], a[180:183], v[240:243], v[84:87]
    v_cvt_pk_bf16_f32 v214, v204, v205
    v_cvt_pk_bf16_f32 v215, v206, v207
    v_mfma_f32_16x16x32_bf16 v[84:87], a[212:215], v[252:255], v[84:87]
    v_mfma_f32_16x16x32_bf16 v[88:91], a[216:219], v[252:255], v[88:91]
    v_mfma_f32_16x16x32_bf16 v[88:91], a[184:187], v[240:243], v[88:91]
    v_mfma_f32_16x16x32_bf16 v[92:95], a[188:191], v[240:243], v[92:95]
    v_mfma_f32_16x16x32_bf16 v[92:95], a[220:223], v[252:255], v[92:95]
    v_mfma_f32_16x16x32_bf16 v[192:195], a[96:99], a[64:67], v[232:235]
    v_mfma_f32_16x16x32_bf16 v[192:195], a[100:103], a[68:71], v[192:195]
    v_mfma_f32_16x16x32_bf16 v[192:195], a[104:107], a[72:75], v[192:195]
    v_mfma_f32_16x16x32_bf16 v[192:195], a[108:111], a[76:79], v[192:195]
    v_mfma_f32_16x16x32_bf16 v[196:199], a[124:127], a[76:79], v[232:235]
    v_mfma_f32_16x16x32_bf16 v[196:199], a[120:123], a[72:75], v[196:199]
    v_mfma_f32_16x16x32_bf16 v[196:199], a[116:119], a[68:71], v[196:199]
    v_mfma_f32_16x16x32_bf16 v[196:199], a[112:115], a[64:67], v[196:199]
    v_mfma_f32_16x16x32_bf16 v[200:203], a[128:131], a[64:67], v[232:235]
    v_mfma_f32_16x16x32_bf16 v[200:203], a[132:135], a[68:71], v[200:203]
    v_mfma_f32_16x16x32_bf16 v[200:203], a[136:139], a[72:75], v[200:203]
    v_mfma_f32_16x16x32_bf16 v[200:203], a[140:143], a[76:79], v[200:203]
    v_exp_f32 v192, v192
    v_mfma_f32_16x16x32_bf16 v[204:207], a[156:159], a[76:79], v[232:235]
    v_exp_f32 v193, v193
    v_mfma_f32_16x16x32_bf16 v[204:207], a[152:155], a[72:75], v[204:207]
    v_exp_f32 v194, v194
    v_mfma_f32_16x16x32_bf16 v[204:207], a[148:151], a[68:71], v[204:207]
    v_exp_f32 v195, v195
    v_mfma_f32_16x16x32_bf16 v[204:207], a[144:147], a[64:67], v[204:207]
    v_cvt_pk_bf16_f32 v240, v192, v193
    v_cvt_pk_bf16_f32 v241, v194, v195
    v_mfma_f32_16x16x32_bf16 a[240:243], a[224:227], v[208:211], a[240:243]
    v_exp_f32 v196, v196
    v_mfma_f32_16x16x32_bf16 a[240:243], a[224:227], v[212:215], a[240:243]
    v_exp_f32 v197, v197
    v_mfma_f32_16x16x32_bf16 v[96:99], a[192:195], v[212:215], v[96:99]
    v_exp_f32 v198, v198
    v_mfma_f32_16x16x32_bf16 v[96:99], a[160:163], v[208:211], v[96:99]
    v_exp_f32 v199, v199
    v_mfma_f32_16x16x32_bf16 v[100:103], a[164:167], v[208:211], v[100:103]
    v_cvt_pk_bf16_f32 v242, v196, v197
    v_cvt_pk_bf16_f32 v243, v198, v199
    v_mfma_f32_16x16x32_bf16 v[100:103], a[196:199], v[212:215], v[100:103]
    v_exp_f32 v200, v200
    v_mfma_f32_16x16x32_bf16 v[104:107], a[200:203], v[212:215], v[104:107]
    v_exp_f32 v201, v201
    v_mfma_f32_16x16x32_bf16 v[104:107], a[168:171], v[208:211], v[104:107]
    v_exp_f32 v202, v202
    v_mfma_f32_16x16x32_bf16 v[108:111], a[172:175], v[208:211], v[108:111]
    v_exp_f32 v203, v203
    v_mfma_f32_16x16x32_bf16 v[108:111], a[204:207], v[212:215], v[108:111]
    v_cvt_pk_bf16_f32 v252, v200, v201
    v_cvt_pk_bf16_f32 v253, v202, v203
    v_mfma_f32_16x16x32_bf16 v[112:115], a[208:211], v[212:215], v[112:115]
    v_exp_f32 v204, v204
    v_mfma_f32_16x16x32_bf16 v[112:115], a[176:179], v[208:211], v[112:115]
    v_exp_f32 v205, v205
    v_mfma_f32_16x16x32_bf16 v[116:119], a[180:183], v[208:211], v[116:119]
    v_exp_f32 v206, v206
    v_mfma_f32_16x16x32_bf16 v[116:119], a[212:215], v[212:215], v[116:119]
    v_exp_f32 v207, v207
    v_mfma_f32_16x16x32_bf16 v[120:123], a[216:219], v[212:215], v[120:123]
    v_cvt_pk_bf16_f32 v254, v204, v205
    v_cvt_pk_bf16_f32 v255, v206, v207
    v_mfma_f32_16x16x32_bf16 v[120:123], a[184:187], v[208:211], v[120:123]
    v_mfma_f32_16x16x32_bf16 v[124:127], a[188:191], v[208:211], v[124:127]
    v_mfma_f32_16x16x32_bf16 v[124:127], a[220:223], v[212:215], v[124:127]
    v_mfma_f32_16x16x32_bf16 v[192:195], a[96:99], a[80:83], v[236:239]
    v_mfma_f32_16x16x32_bf16 v[192:195], a[100:103], a[84:87], v[192:195]
    v_mfma_f32_16x16x32_bf16 v[192:195], a[104:107], a[88:91], v[192:195]
    v_mfma_f32_16x16x32_bf16 v[192:195], a[108:111], a[92:95], v[192:195]
    v_mfma_f32_16x16x32_bf16 v[196:199], a[124:127], a[92:95], v[236:239]
    v_mfma_f32_16x16x32_bf16 v[196:199], a[120:123], a[88:91], v[196:199]
    v_mfma_f32_16x16x32_bf16 v[196:199], a[116:119], a[84:87], v[196:199]
    s_add_u32 m0, s27, 118272
    v_mfma_f32_16x16x32_bf16 v[196:199], a[112:115], a[80:83], v[196:199]
    buffer_load_dwordx4 v248, s[8:11], s24 offen nt lds
    v_mfma_f32_16x16x32_bf16 v[200:203], a[128:131], a[80:83], v[236:239]
    s_waitcnt vmcnt(5)
    v_exp_f32 v192, v192
    v_mfma_f32_16x16x32_bf16 v[200:203], a[132:135], a[84:87], v[200:203]
    s_barrier
    v_mfma_f32_16x16x32_bf16 v[200:203], a[136:139], a[88:91], v[200:203]
    s_add_u32 m0, s27, 118304
    ds_read_b128 a[96:99], v246 offset:0
    ds_read_b128 a[100:103], v246 offset:64
    v_mfma_f32_16x16x32_bf16 v[200:203], a[140:143], a[92:95], v[200:203]
    buffer_load_dwordx4 v248, s[8:11], s24 offen offset:1024 nt lds
    v_mfma_f32_16x16x32_bf16 v[204:207], a[156:159], a[92:95], v[236:239]
    s_add_u32 m0, s27, 118336
    ds_read_b128 a[104:107], v246 offset:128
    ds_read_b128 a[108:111], v246 offset:192
    v_mfma_f32_16x16x32_bf16 v[204:207], a[152:155], a[88:91], v[204:207]
    buffer_load_dwordx4 v248, s[8:11], s24 offen offset:2048 nt lds
    v_mfma_f32_16x16x32_bf16 v[204:207], a[148:151], a[84:87], v[204:207]
    s_add_u32 m0, s27, 118368
    ds_read_b128 a[124:127], v246 offset:704
    ds_read_b128 a[128:131], v246 offset:16896
    v_mfma_f32_16x16x32_bf16 v[204:207], a[144:147], a[80:83], v[204:207]
    buffer_load_dwordx4 v248, s[8:11], s24 offen offset:3072 nt lds
    v_mfma_f32_16x16x32_bf16 a[244:247], a[224:227], v[240:243], a[244:247]
    s_add_u32 s24, s24, 8192
    ds_read_b128 a[120:123], v246 offset:640
    ds_read_b128 a[132:135], v246 offset:16960
    v_mfma_f32_16x16x32_bf16 a[244:247], a[224:227], v[252:255], a[244:247]
    v_exp_f32 v193, v193
    v_mfma_f32_16x16x32_bf16 v[128:131], a[192:195], v[252:255], v[128:131]
    ds_read_b128 a[116:119], v246 offset:576
    ds_read_b128 a[136:139], v246 offset:17024
    v_mfma_f32_16x16x32_bf16 v[128:131], a[160:163], v[240:243], v[128:131]
    v_exp_f32 v194, v194
    v_mfma_f32_16x16x32_bf16 v[132:135], a[164:167], v[240:243], v[132:135]
    ds_read_b128 a[112:115], v246 offset:512
    ds_read_b128 a[140:143], v246 offset:17088
    v_mfma_f32_16x16x32_bf16 v[132:135], a[196:199], v[252:255], v[132:135]
    v_exp_f32 v195, v195
    v_mfma_f32_16x16x32_bf16 v[136:139], a[200:203], v[252:255], v[136:139]
    ds_read_b128 a[156:159], v246 offset:17600
    ds_read_b128 a[152:155], v246 offset:17536
    v_mfma_f32_16x16x32_bf16 v[136:139], a[168:171], v[240:243], v[136:139]
    v_cvt_pk_bf16_f32 v208, v192, v193
    v_cvt_pk_bf16_f32 v209, v194, v195
    v_mfma_f32_16x16x32_bf16 v[140:143], a[172:175], v[240:243], v[140:143]
    ds_read_b128 a[148:151], v246 offset:17472
    ds_read_b128 a[144:147], v246 offset:17408
    v_mfma_f32_16x16x32_bf16 v[140:143], a[204:207], v[252:255], v[140:143]
    v_exp_f32 v196, v196
    v_mfma_f32_16x16x32_bf16 v[144:147], a[208:211], v[252:255], v[144:147]
    v_exp_f32 v197, v197
    v_mfma_f32_16x16x32_bf16 v[144:147], a[176:179], v[240:243], v[144:147]
    v_exp_f32 v198, v198
    v_mfma_f32_16x16x32_bf16 v[148:151], a[180:183], v[240:243], v[148:151]
    v_exp_f32 v199, v199
    v_mfma_f32_16x16x32_bf16 v[148:151], a[212:215], v[252:255], v[148:151]
    v_cvt_pk_bf16_f32 v210, v196, v197
    v_cvt_pk_bf16_f32 v211, v198, v199
    v_mfma_f32_16x16x32_bf16 v[152:155], a[216:219], v[252:255], v[152:155]
    v_exp_f32 v200, v200
    v_mfma_f32_16x16x32_bf16 v[152:155], a[184:187], v[240:243], v[152:155]
    s_waitcnt lgkmcnt(5)
    v_exp_f32 v201, v201
    v_mfma_f32_16x16x32_bf16 v[156:159], a[188:191], v[240:243], v[156:159]
    v_exp_f32 v202, v202
    v_mfma_f32_16x16x32_bf16 v[156:159], a[220:223], v[252:255], v[156:159]
    v_exp_f32 v203, v203
    v_mfma_f32_16x16x32_bf16 v[192:195], a[96:99], a[0:3], v[216:219]
    v_cvt_pk_bf16_f32 v212, v200, v201
    v_cvt_pk_bf16_f32 v213, v202, v203
    v_mfma_f32_16x16x32_bf16 v[192:195], a[100:103], a[4:7], v[192:195]
    v_exp_f32 v204, v204
    v_mfma_f32_16x16x32_bf16 v[192:195], a[104:107], a[8:11], v[192:195]
    v_exp_f32 v205, v205
    v_mfma_f32_16x16x32_bf16 v[192:195], a[108:111], a[12:15], v[192:195]
    v_exp_f32 v206, v206
    v_mfma_f32_16x16x32_bf16 v[196:199], a[124:127], a[12:15], v[216:219]
    v_exp_f32 v207, v207
    v_mfma_f32_16x16x32_bf16 v[196:199], a[120:123], a[8:11], v[196:199]
    s_waitcnt lgkmcnt(0)
    v_cvt_pk_bf16_f32 v214, v204, v205
    v_cvt_pk_bf16_f32 v215, v206, v207
    v_mfma_f32_16x16x32_bf16 v[196:199], a[116:119], a[4:7], v[196:199]
    v_exp_f32 v192, v192
    v_mfma_f32_16x16x32_bf16 v[196:199], a[112:115], a[0:3], v[196:199]
    v_exp_f32 v193, v193
    v_mfma_f32_16x16x32_bf16 v[200:203], a[128:131], a[0:3], v[216:219]
    v_exp_f32 v194, v194
    v_mfma_f32_16x16x32_bf16 v[200:203], a[132:135], a[4:7], v[200:203]
    v_exp_f32 v195, v195
    v_mfma_f32_16x16x32_bf16 v[200:203], a[136:139], a[8:11], v[200:203]
    v_cvt_pk_bf16_f32 v240, v192, v193
    v_cvt_pk_bf16_f32 v241, v194, v195
    v_mfma_f32_16x16x32_bf16 v[200:203], a[140:143], a[12:15], v[200:203]
    v_exp_f32 v196, v196
    v_mfma_f32_16x16x32_bf16 v[204:207], a[156:159], a[12:15], v[216:219]
    v_exp_f32 v197, v197
    v_mfma_f32_16x16x32_bf16 v[204:207], a[152:155], a[8:11], v[204:207]
    v_exp_f32 v198, v198
    v_mfma_f32_16x16x32_bf16 v[204:207], a[148:151], a[4:7], v[204:207]
    v_exp_f32 v199, v199
    v_mfma_f32_16x16x32_bf16 v[204:207], a[144:147], a[0:3], v[204:207]
    v_cvt_pk_bf16_f32 v242, v196, v197
    v_cvt_pk_bf16_f32 v243, v198, v199
    v_mfma_f32_16x16x32_bf16 a[248:251], a[224:227], v[208:211], a[248:251]
    v_exp_f32 v200, v200
    v_mfma_f32_16x16x32_bf16 a[248:251], a[224:227], v[212:215], a[248:251]
    v_exp_f32 v201, v201
    v_mfma_f32_16x16x32_bf16 v[160:163], a[192:195], v[212:215], v[160:163]
    ds_read_b64_tr_b16 a[192:193], v247 offset:25344
    ds_read_b64_tr_b16 a[194:195], v247 offset:25856
    v_mfma_f32_16x16x32_bf16 v[160:163], a[160:163], v[208:211], v[160:163]
    v_exp_f32 v202, v202
    v_mfma_f32_16x16x32_bf16 v[164:167], a[164:167], v[208:211], v[164:167]
    ds_read_b64_tr_b16 a[160:161], v247 offset:8448
    ds_read_b64_tr_b16 a[162:163], v247 offset:8960
    v_mfma_f32_16x16x32_bf16 v[164:167], a[196:199], v[212:215], v[164:167]
    v_exp_f32 v203, v203
    v_mfma_f32_16x16x32_bf16 v[168:171], a[200:203], v[212:215], v[168:171]
    ds_read_b64_tr_b16 a[164:165], v247 offset:8456
    ds_read_b64_tr_b16 a[166:167], v247 offset:8968
    v_mfma_f32_16x16x32_bf16 v[168:171], a[168:171], v[208:211], v[168:171]
    v_cvt_pk_bf16_f32 v252, v200, v201
    v_cvt_pk_bf16_f32 v253, v202, v203
    v_mfma_f32_16x16x32_bf16 v[172:175], a[172:175], v[208:211], v[172:175]
    ds_read_b64_tr_b16 a[196:197], v247 offset:25352
    ds_read_b64_tr_b16 a[198:199], v247 offset:25864
    v_mfma_f32_16x16x32_bf16 v[172:175], a[204:207], v[212:215], v[172:175]
    v_exp_f32 v204, v204
    v_mfma_f32_16x16x32_bf16 v[176:179], a[208:211], v[212:215], v[176:179]
    ds_read_b64_tr_b16 a[168:169], v247 offset:8512
    ds_read_b64_tr_b16 a[170:171], v247 offset:9024
    v_mfma_f32_16x16x32_bf16 v[176:179], a[176:179], v[208:211], v[176:179]
    v_exp_f32 v205, v205
    v_mfma_f32_16x16x32_bf16 v[180:183], a[180:183], v[208:211], v[180:183]
    ds_read_b64_tr_b16 a[200:201], v247 offset:25408
    ds_read_b64_tr_b16 a[202:203], v247 offset:25920
    v_mfma_f32_16x16x32_bf16 v[180:183], a[212:215], v[212:215], v[180:183]
    v_exp_f32 v206, v206
    v_mfma_f32_16x16x32_bf16 v[184:187], a[216:219], v[212:215], v[184:187]
    ds_read_b64_tr_b16 a[172:173], v247 offset:8520
    ds_read_b64_tr_b16 a[174:175], v247 offset:9032
    v_mfma_f32_16x16x32_bf16 v[184:187], a[184:187], v[208:211], v[184:187]
    v_exp_f32 v207, v207
    v_mfma_f32_16x16x32_bf16 v[188:191], a[188:191], v[208:211], v[188:191]
    ds_read_b64_tr_b16 a[204:205], v247 offset:25416
    ds_read_b64_tr_b16 a[206:207], v247 offset:25928
    v_mfma_f32_16x16x32_bf16 v[188:191], a[220:223], v[212:215], v[188:191]
    v_cvt_pk_bf16_f32 v254, v204, v205
    v_cvt_pk_bf16_f32 v255, v206, v207
    v_mfma_f32_16x16x32_bf16 v[192:195], a[96:99], a[16:19], v[220:223]
    ds_read_b64_tr_b16 a[176:177], v247 offset:8576
    ds_read_b64_tr_b16 a[178:179], v247 offset:9088
    v_mfma_f32_16x16x32_bf16 v[192:195], a[100:103], a[20:23], v[192:195]
    v_mfma_f32_16x16x32_bf16 v[192:195], a[104:107], a[24:27], v[192:195]
    ds_read_b64_tr_b16 a[208:209], v247 offset:25472
    ds_read_b64_tr_b16 a[210:211], v247 offset:25984
    v_mfma_f32_16x16x32_bf16 v[192:195], a[108:111], a[28:31], v[192:195]
    v_mfma_f32_16x16x32_bf16 v[196:199], a[124:127], a[28:31], v[220:223]
    ds_read_b64_tr_b16 a[180:181], v247 offset:8584
    ds_read_b64_tr_b16 a[182:183], v247 offset:9096
    v_mfma_f32_16x16x32_bf16 v[196:199], a[120:123], a[24:27], v[196:199]
    v_mfma_f32_16x16x32_bf16 v[196:199], a[116:119], a[20:23], v[196:199]
    ds_read_b64_tr_b16 a[212:213], v247 offset:25480
    ds_read_b64_tr_b16 a[214:215], v247 offset:25992
    v_mfma_f32_16x16x32_bf16 v[196:199], a[112:115], a[16:19], v[196:199]
    v_exp_f32 v192, v192
    v_mfma_f32_16x16x32_bf16 v[200:203], a[128:131], a[16:19], v[220:223]
    ds_read_b64_tr_b16 a[184:185], v247 offset:8640
    ds_read_b64_tr_b16 a[186:187], v247 offset:9152
    v_mfma_f32_16x16x32_bf16 v[200:203], a[132:135], a[20:23], v[200:203]
    v_exp_f32 v193, v193
    v_mfma_f32_16x16x32_bf16 v[200:203], a[136:139], a[24:27], v[200:203]
    ds_read_b64_tr_b16 a[216:217], v247 offset:25536
    ds_read_b64_tr_b16 a[218:219], v247 offset:26048
    v_mfma_f32_16x16x32_bf16 v[200:203], a[140:143], a[28:31], v[200:203]
    v_exp_f32 v194, v194
    v_mfma_f32_16x16x32_bf16 v[204:207], a[156:159], a[28:31], v[220:223]
    s_add_u32 m0, s27, 33792
    ds_read_b64_tr_b16 a[188:189], v247 offset:8648
    ds_read_b64_tr_b16 a[190:191], v247 offset:9160
    v_mfma_f32_16x16x32_bf16 v[204:207], a[152:155], a[24:27], v[204:207]
    buffer_load_dwordx4 v248, s[8:11], s24 offen nt lds
    v_mfma_f32_16x16x32_bf16 v[204:207], a[148:151], a[20:23], v[204:207]
    s_add_u32 m0, s27, 33824
    ds_read_b64_tr_b16 a[220:221], v247 offset:25544
    ds_read_b64_tr_b16 a[222:223], v247 offset:26056
    v_mfma_f32_16x16x32_bf16 v[204:207], a[144:147], a[16:19], v[204:207]
    s_waitcnt lgkmcnt(15)
    buffer_load_dwordx4 v248, s[8:11], s24 offen offset:1024 nt lds
    v_mfma_f32_16x16x32_bf16 a[228:231], a[224:227], v[240:243], a[228:231]
    s_add_u32 m0, s27, 33856
    v_exp_f32 v195, v195
    v_mfma_f32_16x16x32_bf16 a[228:231], a[224:227], v[252:255], a[228:231]
    buffer_load_dwordx4 v248, s[8:11], s24 offen offset:2048 nt lds
    v_mfma_f32_16x16x32_bf16 v[0:3], a[192:195], v[252:255], v[0:3]
    s_add_u32 m0, s27, 33888
    v_cvt_pk_bf16_f32 v208, v192, v193
    v_cvt_pk_bf16_f32 v209, v194, v195
    v_mfma_f32_16x16x32_bf16 v[0:3], a[160:163], v[240:243], v[0:3]
    s_waitcnt lgkmcnt(15)
    buffer_load_dwordx4 v248, s[8:11], s24 offen offset:3072 nt lds
    v_mfma_f32_16x16x32_bf16 v[4:7], a[164:167], v[240:243], v[4:7]
    s_add_u32 s24, s24, 8192
    v_exp_f32 v196, v196
    v_mfma_f32_16x16x32_bf16 v[4:7], a[196:199], v[252:255], v[4:7]
    v_exp_f32 v197, v197
    v_mfma_f32_16x16x32_bf16 v[8:11], a[200:203], v[252:255], v[8:11]
    v_exp_f32 v198, v198
    v_mfma_f32_16x16x32_bf16 v[8:11], a[168:171], v[240:243], v[8:11]
    s_waitcnt lgkmcnt(8)
    v_exp_f32 v199, v199
    v_mfma_f32_16x16x32_bf16 v[12:15], a[172:175], v[240:243], v[12:15]
    v_cvt_pk_bf16_f32 v210, v196, v197
    v_cvt_pk_bf16_f32 v211, v198, v199
    v_mfma_f32_16x16x32_bf16 v[12:15], a[204:207], v[252:255], v[12:15]
    v_exp_f32 v200, v200
    v_mfma_f32_16x16x32_bf16 v[16:19], a[208:211], v[252:255], v[16:19]
    v_exp_f32 v201, v201
    v_mfma_f32_16x16x32_bf16 v[16:19], a[176:179], v[240:243], v[16:19]
    s_waitcnt lgkmcnt(0)
    v_exp_f32 v202, v202
    v_mfma_f32_16x16x32_bf16 v[20:23], a[180:183], v[240:243], v[20:23]
    v_exp_f32 v203, v203
    v_mfma_f32_16x16x32_bf16 v[20:23], a[212:215], v[252:255], v[20:23]
    v_cvt_pk_bf16_f32 v212, v200, v201
    v_cvt_pk_bf16_f32 v213, v202, v203
    v_mfma_f32_16x16x32_bf16 v[24:27], a[216:219], v[252:255], v[24:27]
Lhop2:
    s_cbranch_execz Lret0
    v_exp_f32 v204, v204
    v_mfma_f32_16x16x32_bf16 v[24:27], a[184:187], v[240:243], v[24:27]
    v_exp_f32 v205, v205
    v_mfma_f32_16x16x32_bf16 v[28:31], a[188:191], v[240:243], v[28:31]
    v_exp_f32 v206, v206
    v_mfma_f32_16x16x32_bf16 v[28:31], a[220:223], v[252:255], v[28:31]
    v_exp_f32 v207, v207
    v_mfma_f32_16x16x32_bf16 v[192:195], a[96:99], a[32:35], v[224:227]
    v_cvt_pk_bf16_f32 v214, v204, v205
    v_cvt_pk_bf16_f32 v215, v206, v207
    v_mfma_f32_16x16x32_bf16 v[192:195], a[100:103], a[36:39], v[192:195]
    v_mfma_f32_16x16x32_bf16 v[192:195], a[104:107], a[40:43], v[192:195]
    v_mfma_f32_16x16x32_bf16 v[192:195], a[108:111], a[44:47], v[192:195]
    v_mfma_f32_16x16x32_bf16 v[196:199], a[124:127], a[44:47], v[224:227]
    v_mfma_f32_16x16x32_bf16 v[196:199], a[120:123], a[40:43], v[196:199]
    v_mfma_f32_16x16x32_bf16 v[196:199], a[116:119], a[36:39], v[196:199]
    v_mfma_f32_16x16x32_bf16 v[196:199], a[112:115], a[32:35], v[196:199]
    v_mfma_f32_16x16x32_bf16 v[200:203], a[128:131], a[32:35], v[224:227]
    v_mfma_f32_16x16x32_bf16 v[200:203], a[132:135], a[36:39], v[200:203]
    v_mfma_f32_16x16x32_bf16 v[200:203], a[136:139], a[40:43], v[200:203]
    v_mfma_f32_16x16x32_bf16 v[200:203], a[140:143], a[44:47], v[200:203]
    v_exp_f32 v192, v192
    v_mfma_f32_16x16x32_bf16 v[204:207], a[156:159], a[44:47], v[224:227]
    v_exp_f32 v193, v193
    v_mfma_f32_16x16x32_bf16 v[204:207], a[152:155], a[40:43], v[204:207]
    v_exp_f32 v194, v194
    v_mfma_f32_16x16x32_bf16 v[204:207], a[148:151], a[36:39], v[204:207]
    v_exp_f32 v195, v195
    v_mfma_f32_16x16x32_bf16 v[204:207], a[144:147], a[32:35], v[204:207]
    v_cvt_pk_bf16_f32 v240, v192, v193
    v_cvt_pk_bf16_f32 v241, v194, v195
    v_mfma_f32_16x16x32_bf16 a[232:235], a[224:227], v[208:211], a[232:235]
    v_exp_f32 v196, v196
    v_mfma_f32_16x16x32_bf16 a[232:235], a[224:227], v[212:215], a[232:235]
    v_exp_f32 v197, v197
    v_mfma_f32_16x16x32_bf16 v[32:35], a[192:195], v[212:215], v[32:35]
    v_exp_f32 v198, v198
    v_mfma_f32_16x16x32_bf16 v[32:35], a[160:163], v[208:211], v[32:35]
    v_exp_f32 v199, v199
    v_mfma_f32_16x16x32_bf16 v[36:39], a[164:167], v[208:211], v[36:39]
    v_cvt_pk_bf16_f32 v242, v196, v197
    v_cvt_pk_bf16_f32 v243, v198, v199
    v_mfma_f32_16x16x32_bf16 v[36:39], a[196:199], v[212:215], v[36:39]
    v_exp_f32 v200, v200
    v_mfma_f32_16x16x32_bf16 v[40:43], a[200:203], v[212:215], v[40:43]
    v_exp_f32 v201, v201
    v_mfma_f32_16x16x32_bf16 v[40:43], a[168:171], v[208:211], v[40:43]
    v_exp_f32 v202, v202
    v_mfma_f32_16x16x32_bf16 v[44:47], a[172:175], v[208:211], v[44:47]
    v_exp_f32 v203, v203
    v_mfma_f32_16x16x32_bf16 v[44:47], a[204:207], v[212:215], v[44:47]
    v_exp_f32 v204, v204
    v_mfma_f32_16x16x32_bf16 v[48:51], a[208:211], v[212:215], v[48:51]
    v_exp_f32 v205, v205
    v_mfma_f32_16x16x32_bf16 v[48:51], a[176:179], v[208:211], v[48:51]
    v_exp_f32 v206, v206
    v_mfma_f32_16x16x32_bf16 v[52:55], a[180:183], v[208:211], v[52:55]
    v_exp_f32 v207, v207
    v_mfma_f32_16x16x32_bf16 v[52:55], a[212:215], v[212:215], v[52:55]
    v_cvt_pk_bf16_f32 v252, v200, v201
    v_cvt_pk_bf16_f32 v253, v202, v203
    v_mfma_f32_16x16x32_bf16 v[56:59], a[216:219], v[212:215], v[56:59]
    v_cvt_pk_bf16_f32 v254, v204, v205
    v_cvt_pk_bf16_f32 v255, v206, v207
    v_mfma_f32_16x16x32_bf16 v[56:59], a[184:187], v[208:211], v[56:59]
    v_mfma_f32_16x16x32_bf16 v[60:63], a[188:191], v[208:211], v[60:63]
    v_mfma_f32_16x16x32_bf16 v[60:63], a[220:223], v[212:215], v[60:63]
    v_mfma_f32_16x16x32_bf16 v[192:195], a[96:99], a[48:51], v[228:231]
    v_mfma_f32_16x16x32_bf16 v[192:195], a[100:103], a[52:55], v[192:195]
    v_mfma_f32_16x16x32_bf16 v[192:195], a[104:107], a[56:59], v[192:195]
    v_mfma_f32_16x16x32_bf16 v[192:195], a[108:111], a[60:63], v[192:195]
    v_mfma_f32_16x16x32_bf16 v[196:199], a[124:127], a[60:63], v[228:231]
    v_mfma_f32_16x16x32_bf16 v[196:199], a[120:123], a[56:59], v[196:199]
    v_mfma_f32_16x16x32_bf16 v[196:199], a[116:119], a[52:55], v[196:199]
    v_mfma_f32_16x16x32_bf16 v[196:199], a[112:115], a[48:51], v[196:199]
    v_mfma_f32_16x16x32_bf16 v[200:203], a[128:131], a[48:51], v[228:231]
    v_mfma_f32_16x16x32_bf16 v[200:203], a[132:135], a[52:55], v[200:203]
    v_mfma_f32_16x16x32_bf16 v[200:203], a[136:139], a[56:59], v[200:203]
    v_mfma_f32_16x16x32_bf16 v[200:203], a[140:143], a[60:63], v[200:203]
    v_exp_f32 v192, v192
    v_mfma_f32_16x16x32_bf16 v[204:207], a[156:159], a[60:63], v[228:231]
    s_add_u32 m0, s27, 50688
    v_exp_f32 v193, v193
    v_mfma_f32_16x16x32_bf16 v[204:207], a[152:155], a[56:59], v[204:207]
    buffer_load_dwordx4 v248, s[8:11], s24 offen nt lds
    v_mfma_f32_16x16x32_bf16 v[204:207], a[148:151], a[52:55], v[204:207]
    s_add_u32 m0, s27, 50720
    v_exp_f32 v194, v194
    v_mfma_f32_16x16x32_bf16 v[204:207], a[144:147], a[48:51], v[204:207]
    buffer_load_dwordx4 v248, s[8:11], s24 offen offset:1024 nt lds
    v_mfma_f32_16x16x32_bf16 a[236:239], a[224:227], v[240:243], a[236:239]
    s_add_u32 m0, s27, 50752
    v_exp_f32 v195, v195
    v_mfma_f32_16x16x32_bf16 a[236:239], a[224:227], v[252:255], a[236:239]
    buffer_load_dwordx4 v248, s[8:11], s24 offen offset:2048 nt lds
    v_mfma_f32_16x16x32_bf16 v[64:67], a[192:195], v[252:255], v[64:67]
    s_add_u32 m0, s27, 50784
    v_cvt_pk_bf16_f32 v208, v192, v193
    v_cvt_pk_bf16_f32 v209, v194, v195
    v_mfma_f32_16x16x32_bf16 v[64:67], a[160:163], v[240:243], v[64:67]
    buffer_load_dwordx4 v248, s[8:11], s24 offen offset:3072 nt lds
    v_mfma_f32_16x16x32_bf16 v[68:71], a[164:167], v[240:243], v[68:71]
    s_add_u32 s24, s24, 8192
    v_exp_f32 v196, v196
    v_mfma_f32_16x16x32_bf16 v[68:71], a[196:199], v[252:255], v[68:71]
    v_exp_f32 v197, v197
    v_mfma_f32_16x16x32_bf16 v[72:75], a[200:203], v[252:255], v[72:75]
    v_exp_f32 v198, v198
    v_mfma_f32_16x16x32_bf16 v[72:75], a[168:171], v[240:243], v[72:75]
    v_exp_f32 v199, v199
    v_mfma_f32_16x16x32_bf16 v[76:79], a[172:175], v[240:243], v[76:79]
    v_cvt_pk_bf16_f32 v210, v196, v197
    v_cvt_pk_bf16_f32 v211, v198, v199
    v_mfma_f32_16x16x32_bf16 v[76:79], a[204:207], v[252:255], v[76:79]
    v_exp_f32 v200, v200
    v_mfma_f32_16x16x32_bf16 v[80:83], a[208:211], v[252:255], v[80:83]
    v_exp_f32 v201, v201
    v_mfma_f32_16x16x32_bf16 v[80:83], a[176:179], v[240:243], v[80:83]
    v_exp_f32 v202, v202
    v_mfma_f32_16x16x32_bf16 v[84:87], a[180:183], v[240:243], v[84:87]
    v_exp_f32 v203, v203
    v_mfma_f32_16x16x32_bf16 v[84:87], a[212:215], v[252:255], v[84:87]
    v_cvt_pk_bf16_f32 v212, v200, v201
    v_cvt_pk_bf16_f32 v213, v202, v203
    v_mfma_f32_16x16x32_bf16 v[88:91], a[216:219], v[252:255], v[88:91]
    v_exp_f32 v204, v204
    v_mfma_f32_16x16x32_bf16 v[88:91], a[184:187], v[240:243], v[88:91]
    v_exp_f32 v205, v205
    v_mfma_f32_16x16x32_bf16 v[92:95], a[188:191], v[240:243], v[92:95]
    v_exp_f32 v206, v206
    v_mfma_f32_16x16x32_bf16 v[92:95], a[220:223], v[252:255], v[92:95]
    v_exp_f32 v207, v207
    v_mfma_f32_16x16x32_bf16 v[192:195], a[96:99], a[64:67], v[232:235]
    v_cvt_pk_bf16_f32 v214, v204, v205
    v_cvt_pk_bf16_f32 v215, v206, v207
    v_mfma_f32_16x16x32_bf16 v[192:195], a[100:103], a[68:71], v[192:195]
    v_mfma_f32_16x16x32_bf16 v[192:195], a[104:107], a[72:75], v[192:195]
    v_mfma_f32_16x16x32_bf16 v[192:195], a[108:111], a[76:79], v[192:195]
    v_mfma_f32_16x16x32_bf16 v[196:199], a[124:127], a[76:79], v[232:235]
    v_mfma_f32_16x16x32_bf16 v[196:199], a[120:123], a[72:75], v[196:199]
    v_mfma_f32_16x16x32_bf16 v[196:199], a[116:119], a[68:71], v[196:199]
    v_mfma_f32_16x16x32_bf16 v[196:199], a[112:115], a[64:67], v[196:199]
    v_mfma_f32_16x16x32_bf16 v[200:203], a[128:131], a[64:67], v[232:235]
    v_mfma_f32_16x16x32_bf16 v[200:203], a[132:135], a[68:71], v[200:203]
    v_mfma_f32_16x16x32_bf16 v[200:203], a[136:139], a[72:75], v[200:203]
    v_mfma_f32_16x16x32_bf16 v[200:203], a[140:143], a[76:79], v[200:203]
    v_exp_f32 v192, v192
    v_mfma_f32_16x16x32_bf16 v[204:207], a[156:159], a[76:79], v[232:235]
    v_exp_f32 v193, v193
    v_mfma_f32_16x16x32_bf16 v[204:207], a[152:155], a[72:75], v[204:207]
    v_exp_f32 v194, v194
    v_mfma_f32_16x16x32_bf16 v[204:207], a[148:151], a[68:71], v[204:207]
    v_exp_f32 v195, v195
    v_mfma_f32_16x16x32_bf16 v[204:207], a[144:147], a[64:67], v[204:207]
    v_cvt_pk_bf16_f32 v240, v192, v193
    v_cvt_pk_bf16_f32 v241, v194, v195
    v_mfma_f32_16x16x32_bf16 a[240:243], a[224:227], v[208:211], a[240:243]
    v_exp_f32 v196, v196
    v_mfma_f32_16x16x32_bf16 a[240:243], a[224:227], v[212:215], a[240:243]
    v_exp_f32 v197, v197
    v_mfma_f32_16x16x32_bf16 v[96:99], a[192:195], v[212:215], v[96:99]
    v_exp_f32 v198, v198
    v_mfma_f32_16x16x32_bf16 v[96:99], a[160:163], v[208:211], v[96:99]
    v_exp_f32 v199, v199
    v_mfma_f32_16x16x32_bf16 v[100:103], a[164:167], v[208:211], v[100:103]
    v_cvt_pk_bf16_f32 v242, v196, v197
    v_cvt_pk_bf16_f32 v243, v198, v199
    v_mfma_f32_16x16x32_bf16 v[100:103], a[196:199], v[212:215], v[100:103]
    v_exp_f32 v200, v200
    v_mfma_f32_16x16x32_bf16 v[104:107], a[200:203], v[212:215], v[104:107]
    v_exp_f32 v201, v201
    v_mfma_f32_16x16x32_bf16 v[104:107], a[168:171], v[208:211], v[104:107]
    v_exp_f32 v202, v202
    v_mfma_f32_16x16x32_bf16 v[108:111], a[172:175], v[208:211], v[108:111]
    v_exp_f32 v203, v203
    v_mfma_f32_16x16x32_bf16 v[108:111], a[204:207], v[212:215], v[108:111]
    v_cvt_pk_bf16_f32 v252, v200, v201
    v_cvt_pk_bf16_f32 v253, v202, v203
    v_mfma_f32_16x16x32_bf16 v[112:115], a[208:211], v[212:215], v[112:115]
    v_exp_f32 v204, v204
    v_mfma_f32_16x16x32_bf16 v[112:115], a[176:179], v[208:211], v[112:115]
    v_exp_f32 v205, v205
    v_mfma_f32_16x16x32_bf16 v[116:119], a[180:183], v[208:211], v[116:119]
    v_exp_f32 v206, v206
    v_mfma_f32_16x16x32_bf16 v[116:119], a[212:215], v[212:215], v[116:119]
    v_exp_f32 v207, v207
    v_mfma_f32_16x16x32_bf16 v[120:123], a[216:219], v[212:215], v[120:123]
    v_cvt_pk_bf16_f32 v254, v204, v205
    v_cvt_pk_bf16_f32 v255, v206, v207
    v_mfma_f32_16x16x32_bf16 v[120:123], a[184:187], v[208:211], v[120:123]
    v_mfma_f32_16x16x32_bf16 v[124:127], a[188:191], v[208:211], v[124:127]
    v_mfma_f32_16x16x32_bf16 v[124:127], a[220:223], v[212:215], v[124:127]
    v_mfma_f32_16x16x32_bf16 v[192:195], a[96:99], a[80:83], v[236:239]
    v_mfma_f32_16x16x32_bf16 v[192:195], a[100:103], a[84:87], v[192:195]
    v_mfma_f32_16x16x32_bf16 v[192:195], a[104:107], a[88:91], v[192:195]
    v_mfma_f32_16x16x32_bf16 v[192:195], a[108:111], a[92:95], v[192:195]
    v_mfma_f32_16x16x32_bf16 v[196:199], a[124:127], a[92:95], v[236:239]
    v_mfma_f32_16x16x32_bf16 v[196:199], a[120:123], a[88:91], v[196:199]
    v_mfma_f32_16x16x32_bf16 v[196:199], a[116:119], a[84:87], v[196:199]
    v_mfma_f32_16x16x32_bf16 v[196:199], a[112:115], a[80:83], v[196:199]
    v_mfma_f32_16x16x32_bf16 v[200:203], a[128:131], a[80:83], v[236:239]
    s_waitcnt vmcnt(8)
    v_mfma_f32_16x16x32_bf16 v[200:203], a[132:135], a[84:87], v[200:203]
    s_barrier
    v_mfma_f32_16x16x32_bf16 v[200:203], a[136:139], a[88:91], v[200:203]
    ds_read_b128 a[96:99], v246 offset:33792
    ds_read_b128 a[100:103], v246 offset:33856
    v_mfma_f32_16x16x32_bf16 v[200:203], a[140:143], a[92:95], v[200:203]
    v_exp_f32 v192, v192
    v_mfma_f32_16x16x32_bf16 v[204:207], a[156:159], a[92:95], v[236:239]
    s_mov_b32 m0, s27
    ds_read_b128 a[104:107], v246 offset:33920
    ds_read_b128 a[108:111], v246 offset:33984
    v_mfma_f32_16x16x32_bf16 v[204:207], a[152:155], a[88:91], v[204:207]
    buffer_load_dwordx4 v248, s[8:11], s24 offen nt lds
    v_mfma_f32_16x16x32_bf16 v[204:207], a[148:151], a[84:87], v[204:207]
    s_add_u32 m0, s27, 32
    ds_read_b128 a[124:127], v246 offset:34496
    ds_read_b128 a[128:131], v246 offset:50688
    v_mfma_f32_16x16x32_bf16 v[204:207], a[144:147], a[80:83], v[204:207]
    buffer_load_dwordx4 v248, s[8:11], s24 offen offset:1024 nt lds
    v_mfma_f32_16x16x32_bf16 a[244:247], a[224:227], v[240:243], a[244:247]
    s_add_u32 m0, s27, 64
    ds_read_b128 a[120:123], v246 offset:34432
    ds_read_b128 a[132:135], v246 offset:50752
    v_mfma_f32_16x16x32_bf16 a[244:247], a[224:227], v[252:255], a[244:247]
    buffer_load_dwordx4 v248, s[8:11], s24 offen offset:2048 nt lds
    v_mfma_f32_16x16x32_bf16 v[128:131], a[192:195], v[252:255], v[128:131]
    s_add_u32 m0, s27, 96
    ds_read_b128 a[116:119], v246 offset:34368
    ds_read_b128 a[136:139], v246 offset:50816
    v_mfma_f32_16x16x32_bf16 v[128:131], a[160:163], v[240:243], v[128:131]
    buffer_load_dwordx4 v248, s[8:11], s24 offen offset:3072 nt lds
    v_mfma_f32_16x16x32_bf16 v[132:135], a[164:167], v[240:243], v[132:135]
    s_add_u32 s24, s24, 8192
    ds_read_b128 a[112:115], v246 offset:34304
    ds_read_b128 a[140:143], v246 offset:50880
    v_mfma_f32_16x16x32_bf16 v[132:135], a[196:199], v[252:255], v[132:135]
    v_exp_f32 v193, v193
    v_mfma_f32_16x16x32_bf16 v[136:139], a[200:203], v[252:255], v[136:139]
    ds_read_b128 a[156:159], v246 offset:51392
    ds_read_b128 a[152:155], v246 offset:51328
    v_mfma_f32_16x16x32_bf16 v[136:139], a[168:171], v[240:243], v[136:139]
    v_exp_f32 v194, v194
    v_mfma_f32_16x16x32_bf16 v[140:143], a[172:175], v[240:243], v[140:143]
    ds_read_b128 a[148:151], v246 offset:51264
    v_cvt_pk_bf16_f32 v208, v192, v193
    v_mfma_f32_16x16x32_bf16 v[140:143], a[204:207], v[252:255], v[140:143]
    v_exp_f32 v195, v195
    v_mfma_f32_16x16x32_bf16 v[144:147], a[208:211], v[252:255], v[144:147]
    ds_read_b128 a[144:147], v246 offset:51200
    v_cvt_pk_bf16_f32 v209, v194, v195
    v_mfma_f32_16x16x32_bf16 v[144:147], a[176:179], v[240:243], v[144:147]
    v_exp_f32 v196, v196
    v_mfma_f32_16x16x32_bf16 v[148:151], a[180:183], v[240:243], v[148:151]
    v_exp_f32 v197, v197
    v_mfma_f32_16x16x32_bf16 v[148:151], a[212:215], v[252:255], v[148:151]
    v_exp_f32 v198, v198
    v_mfma_f32_16x16x32_bf16 v[152:155], a[216:219], v[252:255], v[152:155]
    v_exp_f32 v199, v199
    v_mfma_f32_16x16x32_bf16 v[152:155], a[184:187], v[240:243], v[152:155]
    s_waitcnt lgkmcnt(5)
    v_cvt_pk_bf16_f32 v210, v196, v197
    v_cvt_pk_bf16_f32 v211, v198, v199
    v_mfma_f32_16x16x32_bf16 v[156:159], a[188:191], v[240:243], v[156:159]
    v_exp_f32 v200, v200
    v_mfma_f32_16x16x32_bf16 v[156:159], a[220:223], v[252:255], v[156:159]
    v_exp_f32 v201, v201
    v_mfma_f32_16x16x32_bf16 v[192:195], a[96:99], a[0:3], v[216:219]
    v_exp_f32 v202, v202
    v_mfma_f32_16x16x32_bf16 v[192:195], a[100:103], a[4:7], v[192:195]
    v_exp_f32 v203, v203
    v_mfma_f32_16x16x32_bf16 v[192:195], a[104:107], a[8:11], v[192:195]
    v_cvt_pk_bf16_f32 v212, v200, v201
    v_cvt_pk_bf16_f32 v213, v202, v203
    v_mfma_f32_16x16x32_bf16 v[192:195], a[108:111], a[12:15], v[192:195]
    v_exp_f32 v204, v204
    v_mfma_f32_16x16x32_bf16 v[196:199], a[124:127], a[12:15], v[216:219]
    v_exp_f32 v205, v205
    v_mfma_f32_16x16x32_bf16 v[196:199], a[120:123], a[8:11], v[196:199]
    s_waitcnt lgkmcnt(0)
    v_exp_f32 v206, v206
    v_mfma_f32_16x16x32_bf16 v[196:199], a[116:119], a[4:7], v[196:199]
    v_exp_f32 v207, v207
    v_mfma_f32_16x16x32_bf16 v[196:199], a[112:115], a[0:3], v[196:199]
    v_cvt_pk_bf16_f32 v214, v204, v205
    v_cvt_pk_bf16_f32 v215, v206, v207
    v_mfma_f32_16x16x32_bf16 v[200:203], a[128:131], a[0:3], v[216:219]
    v_exp_f32 v192, v192
    v_mfma_f32_16x16x32_bf16 v[200:203], a[132:135], a[4:7], v[200:203]
    v_exp_f32 v193, v193
    v_mfma_f32_16x16x32_bf16 v[200:203], a[136:139], a[8:11], v[200:203]
    v_exp_f32 v194, v194
    v_mfma_f32_16x16x32_bf16 v[200:203], a[140:143], a[12:15], v[200:203]
    v_exp_f32 v195, v195
    v_mfma_f32_16x16x32_bf16 v[204:207], a[156:159], a[12:15], v[216:219]
    v_cvt_pk_bf16_f32 v240, v192, v193
    v_cvt_pk_bf16_f32 v241, v194, v195
    v_mfma_f32_16x16x32_bf16 v[204:207], a[152:155], a[8:11], v[204:207]
    v_exp_f32 v196, v196
    v_mfma_f32_16x16x32_bf16 v[204:207], a[148:151], a[4:7], v[204:207]
    v_exp_f32 v197, v197
    v_mfma_f32_16x16x32_bf16 v[204:207], a[144:147], a[0:3], v[204:207]
    v_exp_f32 v198, v198
    v_mfma_f32_16x16x32_bf16 a[248:251], a[224:227], v[208:211], a[248:251]
    v_exp_f32 v199, v199
    v_mfma_f32_16x16x32_bf16 a[248:251], a[224:227], v[212:215], a[248:251]
    v_cvt_pk_bf16_f32 v242, v196, v197
    v_cvt_pk_bf16_f32 v243, v198, v199
    v_mfma_f32_16x16x32_bf16 v[160:163], a[192:195], v[212:215], v[160:163]
    ds_read_b64_tr_b16 a[192:193], v247 offset:59136
    ds_read_b64_tr_b16 a[194:195], v247 offset:59648
    v_mfma_f32_16x16x32_bf16 v[160:163], a[160:163], v[208:211], v[160:163]
    v_exp_f32 v200, v200
    v_mfma_f32_16x16x32_bf16 v[164:167], a[164:167], v[208:211], v[164:167]
    ds_read_b64_tr_b16 a[160:161], v247 offset:42240
    ds_read_b64_tr_b16 a[162:163], v247 offset:42752
    v_mfma_f32_16x16x32_bf16 v[164:167], a[196:199], v[212:215], v[164:167]
    v_exp_f32 v201, v201
    v_mfma_f32_16x16x32_bf16 v[168:171], a[200:203], v[212:215], v[168:171]
    ds_read_b64_tr_b16 a[164:165], v247 offset:42248
    ds_read_b64_tr_b16 a[166:167], v247 offset:42760
    v_mfma_f32_16x16x32_bf16 v[168:171], a[168:171], v[208:211], v[168:171]
    v_exp_f32 v202, v202
    v_mfma_f32_16x16x32_bf16 v[172:175], a[172:175], v[208:211], v[172:175]
    ds_read_b64_tr_b16 a[196:197], v247 offset:59144
    ds_read_b64_tr_b16 a[198:199], v247 offset:59656
    v_mfma_f32_16x16x32_bf16 v[172:175], a[204:207], v[212:215], v[172:175]
    v_exp_f32 v203, v203
    v_mfma_f32_16x16x32_bf16 v[176:179], a[208:211], v[212:215], v[176:179]
    ds_read_b64_tr_b16 a[168:169], v247 offset:42304
    ds_read_b64_tr_b16 a[170:171], v247 offset:42816
    v_mfma_f32_16x16x32_bf16 v[176:179], a[176:179], v[208:211], v[176:179]
    v_cvt_pk_bf16_f32 v252, v200, v201
    v_cvt_pk_bf16_f32 v253, v202, v203
    v_mfma_f32_16x16x32_bf16 v[180:183], a[180:183], v[208:211], v[180:183]
    ds_read_b64_tr_b16 a[200:201], v247 offset:59200
    ds_read_b64_tr_b16 a[202:203], v247 offset:59712
    v_mfma_f32_16x16x32_bf16 v[180:183], a[212:215], v[212:215], v[180:183]
    v_exp_f32 v204, v204
    v_mfma_f32_16x16x32_bf16 v[184:187], a[216:219], v[212:215], v[184:187]
    ds_read_b64_tr_b16 a[172:173], v247 offset:42312
    ds_read_b64_tr_b16 a[174:175], v247 offset:42824
    v_mfma_f32_16x16x32_bf16 v[184:187], a[184:187], v[208:211], v[184:187]
    v_exp_f32 v205, v205
    v_mfma_f32_16x16x32_bf16 v[188:191], a[188:191], v[208:211], v[188:191]
    ds_read_b64_tr_b16 a[204:205], v247 offset:59208
    ds_read_b64_tr_b16 a[206:207], v247 offset:59720
    v_mfma_f32_16x16x32_bf16 v[188:191], a[220:223], v[212:215], v[188:191]
    v_exp_f32 v206, v206
    v_mfma_f32_16x16x32_bf16 v[192:195], a[96:99], a[16:19], v[220:223]
    ds_read_b64_tr_b16 a[176:177], v247 offset:42368
    ds_read_b64_tr_b16 a[178:179], v247 offset:42880
    v_mfma_f32_16x16x32_bf16 v[192:195], a[100:103], a[20:23], v[192:195]
    v_exp_f32 v207, v207
    v_mfma_f32_16x16x32_bf16 v[192:195], a[104:107], a[24:27], v[192:195]
    ds_read_b64_tr_b16 a[208:209], v247 offset:59264
    ds_read_b64_tr_b16 a[210:211], v247 offset:59776
    v_mfma_f32_16x16x32_bf16 v[192:195], a[108:111], a[28:31], v[192:195]
    v_cvt_pk_bf16_f32 v254, v204, v205
    v_cvt_pk_bf16_f32 v255, v206, v207
    v_mfma_f32_16x16x32_bf16 v[196:199], a[124:127], a[28:31], v[220:223]
    ds_read_b64_tr_b16 a[180:181], v247 offset:42376
    ds_read_b64_tr_b16 a[182:183], v247 offset:42888
    v_mfma_f32_16x16x32_bf16 v[196:199], a[120:123], a[24:27], v[196:199]
    v_mfma_f32_16x16x32_bf16 v[196:199], a[116:119], a[20:23], v[196:199]
    ds_read_b64_tr_b16 a[212:213], v247 offset:59272
    ds_read_b64_tr_b16 a[214:215], v247 offset:59784
    v_mfma_f32_16x16x32_bf16 v[196:199], a[112:115], a[16:19], v[196:199]
    v_exp_f32 v192, v192
    v_mfma_f32_16x16x32_bf16 v[200:203], a[128:131], a[16:19], v[220:223]
    ds_read_b64_tr_b16 a[184:185], v247 offset:42432
    ds_read_b64_tr_b16 a[186:187], v247 offset:42944
    v_mfma_f32_16x16x32_bf16 v[200:203], a[132:135], a[20:23], v[200:203]
    v_exp_f32 v193, v193
    v_mfma_f32_16x16x32_bf16 v[200:203], a[136:139], a[24:27], v[200:203]
    ds_read_b64_tr_b16 a[216:217], v247 offset:59328
    ds_read_b64_tr_b16 a[218:219], v247 offset:59840
    v_mfma_f32_16x16x32_bf16 v[200:203], a[140:143], a[28:31], v[200:203]
    v_exp_f32 v194, v194
    v_mfma_f32_16x16x32_bf16 v[204:207], a[156:159], a[28:31], v[220:223]
    s_add_u32 m0, s27, 16896
    ds_read_b64_tr_b16 a[188:189], v247 offset:42440
    ds_read_b64_tr_b16 a[190:191], v247 offset:42952
    v_mfma_f32_16x16x32_bf16 v[204:207], a[152:155], a[24:27], v[204:207]
    buffer_load_dwordx4 v248, s[8:11], s24 offen nt lds
    v_mfma_f32_16x16x32_bf16 v[204:207], a[148:151], a[20:23], v[204:207]
    s_add_u32 m0, s27, 16928
    ds_read_b64_tr_b16 a[220:221], v247 offset:59336
    ds_read_b64_tr_b16 a[222:223], v247 offset:59848
    v_mfma_f32_16x16x32_bf16 v[204:207], a[144:147], a[16:19], v[204:207]
    s_waitcnt lgkmcnt(15)
    buffer_load_dwordx4 v248, s[8:11], s24 offen offset:1024 nt lds
    v_mfma_f32_16x16x32_bf16 a[228:231], a[224:227], v[240:243], a[228:231]
    s_add_u32 m0, s27, 16960
    v_exp_f32 v195, v195
    v_mfma_f32_16x16x32_bf16 a[228:231], a[224:227], v[252:255], a[228:231]
    buffer_load_dwordx4 v248, s[8:11], s24 offen offset:2048 nt lds
    v_mfma_f32_16x16x32_bf16 v[0:3], a[192:195], v[252:255], v[0:3]
    s_add_u32 m0, s27, 16992
    v_cvt_pk_bf16_f32 v208, v192, v193
    v_cvt_pk_bf16_f32 v209, v194, v195
    v_mfma_f32_16x16x32_bf16 v[0:3], a[160:163], v[240:243], v[0:3]
    s_waitcnt lgkmcnt(15)
    buffer_load_dwordx4 v248, s[8:11], s24 offen offset:3072 nt lds
    v_mfma_f32_16x16x32_bf16 v[4:7], a[164:167], v[240:243], v[4:7]
    s_add_u32 s24, s24, 8192
    v_exp_f32 v196, v196
    v_mfma_f32_16x16x32_bf16 v[4:7], a[196:199], v[252:255], v[4:7]
    v_exp_f32 v197, v197
    v_mfma_f32_16x16x32_bf16 v[8:11], a[200:203], v[252:255], v[8:11]
    v_exp_f32 v198, v198
    v_mfma_f32_16x16x32_bf16 v[8:11], a[168:171], v[240:243], v[8:11]
    s_waitcnt lgkmcnt(8)
    v_exp_f32 v199, v199
    v_mfma_f32_16x16x32_bf16 v[12:15], a[172:175], v[240:243], v[12:15]
    v_cvt_pk_bf16_f32 v210, v196, v197
    v_cvt_pk_bf16_f32 v211, v198, v199
    v_mfma_f32_16x16x32_bf16 v[12:15], a[204:207], v[252:255], v[12:15]
    v_exp_f32 v200, v200
    v_mfma_f32_16x16x32_bf16 v[16:19], a[208:211], v[252:255], v[16:19]
    v_exp_f32 v201, v201
    v_mfma_f32_16x16x32_bf16 v[16:19], a[176:179], v[240:243], v[16:19]
    s_waitcnt lgkmcnt(0)
    v_exp_f32 v202, v202
    v_mfma_f32_16x16x32_bf16 v[20:23], a[180:183], v[240:243], v[20:23]
    v_exp_f32 v203, v203
    v_mfma_f32_16x16x32_bf16 v[20:23], a[212:215], v[252:255], v[20:23]
    v_cvt_pk_bf16_f32 v212, v200, v201
    v_cvt_pk_bf16_f32 v213, v202, v203
    v_mfma_f32_16x16x32_bf16 v[24:27], a[216:219], v[252:255], v[24:27]
    v_exp_f32 v204, v204
    v_mfma_f32_16x16x32_bf16 v[24:27], a[184:187], v[240:243], v[24:27]
    v_exp_f32 v205, v205
    v_mfma_f32_16x16x32_bf16 v[28:31], a[188:191], v[240:243], v[28:31]
    v_exp_f32 v206, v206
    v_mfma_f32_16x16x32_bf16 v[28:31], a[220:223], v[252:255], v[28:31]
    v_exp_f32 v207, v207
    v_mfma_f32_16x16x32_bf16 v[192:195], a[96:99], a[32:35], v[224:227]
    v_cvt_pk_bf16_f32 v214, v204, v205
    v_cvt_pk_bf16_f32 v215, v206, v207
    v_mfma_f32_16x16x32_bf16 v[192:195], a[100:103], a[36:39], v[192:195]
    v_mfma_f32_16x16x32_bf16 v[192:195], a[104:107], a[40:43], v[192:195]
    v_mfma_f32_16x16x32_bf16 v[192:195], a[108:111], a[44:47], v[192:195]
    v_mfma_f32_16x16x32_bf16 v[196:199], a[124:127], a[44:47], v[224:227]
    v_mfma_f32_16x16x32_bf16 v[196:199], a[120:123], a[40:43], v[196:199]
    v_mfma_f32_16x16x32_bf16 v[196:199], a[116:119], a[36:39], v[196:199]
    v_mfma_f32_16x16x32_bf16 v[196:199], a[112:115], a[32:35], v[196:199]
    v_mfma_f32_16x16x32_bf16 v[200:203], a[128:131], a[32:35], v[224:227]
    v_mfma_f32_16x16x32_bf16 v[200:203], a[132:135], a[36:39], v[200:203]
    v_mfma_f32_16x16x32_bf16 v[200:203], a[136:139], a[40:43], v[200:203]
    v_mfma_f32_16x16x32_bf16 v[200:203], a[140:143], a[44:47], v[200:203]
    v_exp_f32 v192, v192
    v_mfma_f32_16x16x32_bf16 v[204:207], a[156:159], a[44:47], v[224:227]
    v_exp_f32 v193, v193
    v_mfma_f32_16x16x32_bf16 v[204:207], a[152:155], a[40:43], v[204:207]
    v_exp_f32 v194, v194
    v_mfma_f32_16x16x32_bf16 v[204:207], a[148:151], a[36:39], v[204:207]
    v_exp_f32 v195, v195
    v_mfma_f32_16x16x32_bf16 v[204:207], a[144:147], a[32:35], v[204:207]
    v_cvt_pk_bf16_f32 v240, v192, v193
    v_cvt_pk_bf16_f32 v241, v194, v195
    v_mfma_f32_16x16x32_bf16 a[232:235], a[224:227], v[208:211], a[232:235]
    v_exp_f32 v196, v196
    v_mfma_f32_16x16x32_bf16 a[232:235], a[224:227], v[212:215], a[232:235]
    v_exp_f32 v197, v197
    v_mfma_f32_16x16x32_bf16 v[32:35], a[192:195], v[212:215], v[32:35]
    v_exp_f32 v198, v198
    v_mfma_f32_16x16x32_bf16 v[32:35], a[160:163], v[208:211], v[32:35]
    v_exp_f32 v199, v199
    v_mfma_f32_16x16x32_bf16 v[36:39], a[164:167], v[208:211], v[36:39]
    v_cvt_pk_bf16_f32 v242, v196, v197
    v_cvt_pk_bf16_f32 v243, v198, v199
    v_mfma_f32_16x16x32_bf16 v[36:39], a[196:199], v[212:215], v[36:39]
    v_exp_f32 v200, v200
    v_mfma_f32_16x16x32_bf16 v[40:43], a[200:203], v[212:215], v[40:43]
    v_exp_f32 v201, v201
    v_mfma_f32_16x16x32_bf16 v[40:43], a[168:171], v[208:211], v[40:43]
    v_exp_f32 v202, v202
    v_mfma_f32_16x16x32_bf16 v[44:47], a[172:175], v[208:211], v[44:47]
    v_exp_f32 v203, v203
    v_mfma_f32_16x16x32_bf16 v[44:47], a[204:207], v[212:215], v[44:47]
    v_exp_f32 v204, v204
    v_mfma_f32_16x16x32_bf16 v[48:51], a[208:211], v[212:215], v[48:51]
    v_exp_f32 v205, v205
    v_mfma_f32_16x16x32_bf16 v[48:51], a[176:179], v[208:211], v[48:51]
    v_exp_f32 v206, v206
    v_mfma_f32_16x16x32_bf16 v[52:55], a[180:183], v[208:211], v[52:55]
    v_exp_f32 v207, v207
    v_mfma_f32_16x16x32_bf16 v[52:55], a[212:215], v[212:215], v[52:55]
    v_cvt_pk_bf16_f32 v252, v200, v201
    v_cvt_pk_bf16_f32 v253, v202, v203
    v_mfma_f32_16x16x32_bf16 v[56:59], a[216:219], v[212:215], v[56:59]
    v_cvt_pk_bf16_f32 v254, v204, v205
    v_cvt_pk_bf16_f32 v255, v206, v207
    v_mfma_f32_16x16x32_bf16 v[56:59], a[184:187], v[208:211], v[56:59]
    v_mfma_f32_16x16x32_bf16 v[60:63], a[188:191], v[208:211], v[60:63]
    v_mfma_f32_16x16x32_bf16 v[60:63], a[220:223], v[212:215], v[60:63]
    v_mfma_f32_16x16x32_bf16 v[192:195], a[96:99], a[48:51], v[228:231]
    v_mfma_f32_16x16x32_bf16 v[192:195], a[100:103], a[52:55], v[192:195]
    v_mfma_f32_16x16x32_bf16 v[192:195], a[104:107], a[56:59], v[192:195]
    v_mfma_f32_16x16x32_bf16 v[192:195], a[108:111], a[60:63], v[192:195]
    v_mfma_f32_16x16x32_bf16 v[196:199], a[124:127], a[60:63], v[228:231]
    v_mfma_f32_16x16x32_bf16 v[196:199], a[120:123], a[56:59], v[196:199]
    v_mfma_f32_16x16x32_bf16 v[196:199], a[116:119], a[52:55], v[196:199]
    v_mfma_f32_16x16x32_bf16 v[196:199], a[112:115], a[48:51], v[196:199]
    v_mfma_f32_16x16x32_bf16 v[200:203], a[128:131], a[48:51], v[228:231]
    v_subrev_u32 v246, 33792, v246
    v_subrev_u32 v247, 33792, v247
    v_mfma_f32_16x16x32_bf16 v[200:203], a[132:135], a[52:55], v[200:203]
    v_exp_f32 v192, v192
    v_mfma_f32_16x16x32_bf16 v[200:203], a[136:139], a[56:59], v[200:203]
    v_exp_f32 v193, v193
    v_mfma_f32_16x16x32_bf16 v[200:203], a[140:143], a[60:63], v[200:203]
    v_exp_f32 v194, v194
    v_mfma_f32_16x16x32_bf16 v[204:207], a[156:159], a[60:63], v[228:231]
    s_add_u32 m0, s27, 67584
    v_exp_f32 v195, v195
    v_mfma_f32_16x16x32_bf16 v[204:207], a[152:155], a[56:59], v[204:207]
    buffer_load_dwordx4 v248, s[4:7], s28 offen nt lds
    v_mfma_f32_16x16x32_bf16 v[204:207], a[148:151], a[52:55], v[204:207]
    s_add_u32 m0, s27, 67616
    v_cvt_pk_bf16_f32 v208, v192, v193
    v_cvt_pk_bf16_f32 v209, v194, v195
    v_mfma_f32_16x16x32_bf16 v[204:207], a[144:147], a[48:51], v[204:207]
    buffer_load_dwordx4 v248, s[4:7], s28 offen offset:1024 nt lds
    v_mfma_f32_16x16x32_bf16 a[236:239], a[224:227], v[240:243], a[236:239]
    s_add_u32 m0, s27, 67648
    v_exp_f32 v196, v196
    v_mfma_f32_16x16x32_bf16 a[236:239], a[224:227], v[252:255], a[236:239]
    buffer_load_dwordx4 v248, s[4:7], s28 offen offset:2048 nt lds
    v_mfma_f32_16x16x32_bf16 v[64:67], a[192:195], v[252:255], v[64:67]
    s_add_u32 m0, s27, 67680
    v_exp_f32 v197, v197
    v_mfma_f32_16x16x32_bf16 v[64:67], a[160:163], v[240:243], v[64:67]
    buffer_load_dwordx4 v248, s[4:7], s28 offen offset:3072 nt lds
    v_mfma_f32_16x16x32_bf16 v[68:71], a[164:167], v[240:243], v[68:71]
    s_add_u32 s28, s28, 4096
    v_exp_f32 v198, v198
    v_mfma_f32_16x16x32_bf16 v[68:71], a[196:199], v[252:255], v[68:71]
    v_exp_f32 v199, v199
    v_mfma_f32_16x16x32_bf16 v[72:75], a[200:203], v[252:255], v[72:75]
    v_cvt_pk_bf16_f32 v210, v196, v197
    v_cvt_pk_bf16_f32 v211, v198, v199
    v_mfma_f32_16x16x32_bf16 v[72:75], a[168:171], v[240:243], v[72:75]
    v_exp_f32 v200, v200
    v_mfma_f32_16x16x32_bf16 v[76:79], a[172:175], v[240:243], v[76:79]
    v_exp_f32 v201, v201
    v_mfma_f32_16x16x32_bf16 v[76:79], a[204:207], v[252:255], v[76:79]
    v_exp_f32 v202, v202
    v_mfma_f32_16x16x32_bf16 v[80:83], a[208:211], v[252:255], v[80:83]
    v_exp_f32 v203, v203
    v_mfma_f32_16x16x32_bf16 v[80:83], a[176:179], v[240:243], v[80:83]
    v_cvt_pk_bf16_f32 v212, v200, v201
    v_cvt_pk_bf16_f32 v213, v202, v203
    v_mfma_f32_16x16x32_bf16 v[84:87], a[180:183], v[240:243], v[84:87]
    v_exp_f32 v204, v204
    v_mfma_f32_16x16x32_bf16 v[84:87], a[212:215], v[252:255], v[84:87]
    v_exp_f32 v205, v205
    v_mfma_f32_16x16x32_bf16 v[88:91], a[216:219], v[252:255], v[88:91]
    v_exp_f32 v206, v206
    v_mfma_f32_16x16x32_bf16 v[88:91], a[184:187], v[240:243], v[88:91]
    v_exp_f32 v207, v207
    v_mfma_f32_16x16x32_bf16 v[92:95], a[188:191], v[240:243], v[92:95]
    v_cvt_pk_bf16_f32 v214, v204, v205
    v_cvt_pk_bf16_f32 v215, v206, v207
    v_mfma_f32_16x16x32_bf16 v[92:95], a[220:223], v[252:255], v[92:95]
    v_mfma_f32_16x16x32_bf16 v[192:195], a[96:99], a[64:67], v[232:235]
    v_mfma_f32_16x16x32_bf16 v[192:195], a[100:103], a[68:71], v[192:195]
    v_mfma_f32_16x16x32_bf16 v[192:195], a[104:107], a[72:75], v[192:195]
    v_mfma_f32_16x16x32_bf16 v[192:195], a[108:111], a[76:79], v[192:195]
    v_mfma_f32_16x16x32_bf16 v[196:199], a[124:127], a[76:79], v[232:235]
    v_mfma_f32_16x16x32_bf16 v[196:199], a[120:123], a[72:75], v[196:199]
    v_mfma_f32_16x16x32_bf16 v[196:199], a[116:119], a[68:71], v[196:199]
    v_mfma_f32_16x16x32_bf16 v[196:199], a[112:115], a[64:67], v[196:199]
    v_mfma_f32_16x16x32_bf16 v[200:203], a[128:131], a[64:67], v[232:235]
    v_mfma_f32_16x16x32_bf16 v[200:203], a[132:135], a[68:71], v[200:203]
    v_mfma_f32_16x16x32_bf16 v[200:203], a[136:139], a[72:75], v[200:203]
    v_mfma_f32_16x16x32_bf16 v[200:203], a[140:143], a[76:79], v[200:203]
    v_exp_f32 v192, v192
    v_mfma_f32_16x16x32_bf16 v[204:207], a[156:159], a[76:79], v[232:235]
    v_exp_f32 v193, v193
    v_mfma_f32_16x16x32_bf16 v[204:207], a[152:155], a[72:75], v[204:207]
Lhop3:
    s_cbranch_execz Lret0
    v_exp_f32 v194, v194
    v_mfma_f32_16x16x32_bf16 v[204:207], a[148:151], a[68:71], v[204:207]
    v_exp_f32 v195, v195
    v_mfma_f32_16x16x32_bf16 v[204:207], a[144:147], a[64:67], v[204:207]
    v_cvt_pk_bf16_f32 v240, v192, v193
    v_cvt_pk_bf16_f32 v241, v194, v195
    v_mfma_f32_16x16x32_bf16 a[240:243], a[224:227], v[208:211], a[240:243]
    v_exp_f32 v196, v196
    v_mfma_f32_16x16x32_bf16 a[240:243], a[224:227], v[212:215], a[240:243]
    v_exp_f32 v197, v197
    v_mfma_f32_16x16x32_bf16 v[96:99], a[192:195], v[212:215], v[96:99]
    v_exp_f32 v198, v198
    v_mfma_f32_16x16x32_bf16 v[96:99], a[160:163], v[208:211], v[96:99]
    v_exp_f32 v199, v199
    v_mfma_f32_16x16x32_bf16 v[100:103], a[164:167], v[208:211], v[100:103]
    v_cvt_pk_bf16_f32 v242, v196, v197
    v_cvt_pk_bf16_f32 v243, v198, v199
    v_mfma_f32_16x16x32_bf16 v[100:103], a[196:199], v[212:215], v[100:103]
    v_exp_f32 v200, v200
    v_mfma_f32_16x16x32_bf16 v[104:107], a[200:203], v[212:215], v[104:107]
    v_exp_f32 v201, v201
    v_mfma_f32_16x16x32_bf16 v[104:107], a[168:171], v[208:211], v[104:107]
    v_exp_f32 v202, v202
    v_mfma_f32_16x16x32_bf16 v[108:111], a[172:175], v[208:211], v[108:111]
    v_exp_f32 v203, v203
    v_mfma_f32_16x16x32_bf16 v[108:111], a[204:207], v[212:215], v[108:111]
    v_cvt_pk_bf16_f32 v252, v200, v201
    v_cvt_pk_bf16_f32 v253, v202, v203
    v_mfma_f32_16x16x32_bf16 v[112:115], a[208:211], v[212:215], v[112:115]
    v_exp_f32 v204, v204
    v_mfma_f32_16x16x32_bf16 v[112:115], a[176:179], v[208:211], v[112:115]
    v_exp_f32 v205, v205
    v_mfma_f32_16x16x32_bf16 v[116:119], a[180:183], v[208:211], v[116:119]
    v_exp_f32 v206, v206
    v_mfma_f32_16x16x32_bf16 v[116:119], a[212:215], v[212:215], v[116:119]
    v_exp_f32 v207, v207
    v_mfma_f32_16x16x32_bf16 v[120:123], a[216:219], v[212:215], v[120:123]
    v_cvt_pk_bf16_f32 v254, v204, v205
    v_cvt_pk_bf16_f32 v255, v206, v207
    v_mfma_f32_16x16x32_bf16 v[120:123], a[184:187], v[208:211], v[120:123]
    v_mfma_f32_16x16x32_bf16 v[124:127], a[188:191], v[208:211], v[124:127]
    v_mfma_f32_16x16x32_bf16 v[124:127], a[220:223], v[212:215], v[124:127]
    v_mfma_f32_16x16x32_bf16 v[192:195], a[96:99], a[80:83], v[236:239]
    v_mfma_f32_16x16x32_bf16 v[192:195], a[100:103], a[84:87], v[192:195]
    v_mfma_f32_16x16x32_bf16 v[192:195], a[104:107], a[88:91], v[192:195]
    v_mfma_f32_16x16x32_bf16 v[192:195], a[108:111], a[92:95], v[192:195]
    v_mfma_f32_16x16x32_bf16 v[196:199], a[124:127], a[92:95], v[236:239]
    v_mfma_f32_16x16x32_bf16 v[196:199], a[120:123], a[88:91], v[196:199]
    v_mfma_f32_16x16x32_bf16 v[196:199], a[116:119], a[84:87], v[196:199]
    v_mfma_f32_16x16x32_bf16 v[196:199], a[112:115], a[80:83], v[196:199]
    v_mfma_f32_16x16x32_bf16 v[200:203], a[128:131], a[80:83], v[236:239]
    s_waitcnt vmcnt(12)
    v_mfma_f32_16x16x32_bf16 v[200:203], a[132:135], a[84:87], v[200:203]
    s_barrier
    v_mfma_f32_16x16x32_bf16 v[200:203], a[136:139], a[88:91], v[200:203]
    s_add_u32 m0, s27, 84480
    ds_read_b128 a[96:99], v246 offset:0
    ds_read_b128 a[100:103], v246 offset:64
    v_mfma_f32_16x16x32_bf16 v[200:203], a[140:143], a[92:95], v[200:203]
    buffer_load_dwordx4 v248, s[4:7], s28 offen nt lds
    v_mfma_f32_16x16x32_bf16 v[204:207], a[156:159], a[92:95], v[236:239]
    s_add_u32 m0, s27, 84512
    ds_read_b128 a[104:107], v246 offset:128
    ds_read_b128 a[108:111], v246 offset:192
    v_mfma_f32_16x16x32_bf16 v[204:207], a[152:155], a[88:91], v[204:207]
    buffer_load_dwordx4 v248, s[4:7], s28 offen offset:1024 nt lds
    v_mfma_f32_16x16x32_bf16 v[204:207], a[148:151], a[84:87], v[204:207]
    s_add_u32 m0, s27, 84544
    ds_read_b128 a[124:127], v246 offset:704
    ds_read_b128 a[128:131], v246 offset:16896
    v_mfma_f32_16x16x32_bf16 v[204:207], a[144:147], a[80:83], v[204:207]
    buffer_load_dwordx4 v248, s[4:7], s28 offen offset:2048 nt lds
    v_mfma_f32_16x16x32_bf16 a[244:247], a[224:227], v[240:243], a[244:247]
    s_add_u32 m0, s27, 84576
    ds_read_b128 a[120:123], v246 offset:640
    ds_read_b128 a[132:135], v246 offset:16960
    v_mfma_f32_16x16x32_bf16 a[244:247], a[224:227], v[252:255], a[244:247]
    buffer_load_dwordx4 v248, s[4:7], s28 offen offset:3072 nt lds
    v_mfma_f32_16x16x32_bf16 v[128:131], a[192:195], v[252:255], v[128:131]
    s_add_u32 s28, s28, 4096
    ds_read_b128 a[116:119], v246 offset:576
    ds_read_b128 a[136:139], v246 offset:17024
    v_mfma_f32_16x16x32_bf16 v[128:131], a[160:163], v[240:243], v[128:131]
    v_exp_f32 v192, v192
    v_mfma_f32_16x16x32_bf16 v[132:135], a[164:167], v[240:243], v[132:135]
    ds_read_b128 a[112:115], v246 offset:512
    ds_read_b128 a[140:143], v246 offset:17088
    v_mfma_f32_16x16x32_bf16 v[132:135], a[196:199], v[252:255], v[132:135]
    v_exp_f32 v193, v193
    v_mfma_f32_16x16x32_bf16 v[136:139], a[200:203], v[252:255], v[136:139]
    ds_read_b128 a[156:159], v246 offset:17600
    ds_read_b128 a[152:155], v246 offset:17536
    v_mfma_f32_16x16x32_bf16 v[136:139], a[168:171], v[240:243], v[136:139]
    v_exp_f32 v194, v194
    v_mfma_f32_16x16x32_bf16 v[140:143], a[172:175], v[240:243], v[140:143]
    ds_read_b128 a[148:151], v246 offset:17472
    v_cvt_pk_bf16_f32 v208, v192, v193
    v_mfma_f32_16x16x32_bf16 v[140:143], a[204:207], v[252:255], v[140:143]
    v_exp_f32 v195, v195
    v_mfma_f32_16x16x32_bf16 v[144:147], a[208:211], v[252:255], v[144:147]
    ds_read_b128 a[144:147], v246 offset:17408
    v_cvt_pk_bf16_f32 v209, v194, v195
    v_mfma_f32_16x16x32_bf16 v[144:147], a[176:179], v[240:243], v[144:147]
    v_exp_f32 v196, v196
    v_mfma_f32_16x16x32_bf16 v[148:151], a[180:183], v[240:243], v[148:151]
    v_exp_f32 v197, v197
    v_mfma_f32_16x16x32_bf16 v[148:151], a[212:215], v[252:255], v[148:151]
    v_exp_f32 v198, v198
    v_mfma_f32_16x16x32_bf16 v[152:155], a[216:219], v[252:255], v[152:155]
    v_exp_f32 v199, v199
    v_mfma_f32_16x16x32_bf16 v[152:155], a[184:187], v[240:243], v[152:155]
    s_waitcnt lgkmcnt(5)
    v_cvt_pk_bf16_f32 v210, v196, v197
    v_cvt_pk_bf16_f32 v211, v198, v199
    v_mfma_f32_16x16x32_bf16 v[156:159], a[188:191], v[240:243], v[156:159]
    v_exp_f32 v200, v200
    v_mfma_f32_16x16x32_bf16 v[156:159], a[220:223], v[252:255], v[156:159]
    v_exp_f32 v201, v201
    v_mfma_f32_16x16x32_bf16 v[192:195], a[96:99], a[0:3], v[216:219]
    v_exp_f32 v202, v202
    v_mfma_f32_16x16x32_bf16 v[192:195], a[100:103], a[4:7], v[192:195]
    v_exp_f32 v203, v203
    v_mfma_f32_16x16x32_bf16 v[192:195], a[104:107], a[8:11], v[192:195]
    v_cvt_pk_bf16_f32 v212, v200, v201
    v_cvt_pk_bf16_f32 v213, v202, v203
    v_mfma_f32_16x16x32_bf16 v[192:195], a[108:111], a[12:15], v[192:195]
    v_exp_f32 v204, v204
    v_mfma_f32_16x16x32_bf16 v[196:199], a[124:127], a[12:15], v[216:219]
    v_exp_f32 v205, v205
    v_mfma_f32_16x16x32_bf16 v[196:199], a[120:123], a[8:11], v[196:199]
    s_waitcnt lgkmcnt(0)
    v_exp_f32 v206, v206
    v_mfma_f32_16x16x32_bf16 v[196:199], a[116:119], a[4:7], v[196:199]
    v_exp_f32 v207, v207
    v_mfma_f32_16x16x32_bf16 v[196:199], a[112:115], a[0:3], v[196:199]
    v_cvt_pk_bf16_f32 v214, v204, v205
    v_cvt_pk_bf16_f32 v215, v206, v207
    v_mfma_f32_16x16x32_bf16 v[200:203], a[128:131], a[0:3], v[216:219]
    v_exp_f32 v192, v192
    v_mfma_f32_16x16x32_bf16 v[200:203], a[132:135], a[4:7], v[200:203]
    v_exp_f32 v193, v193
    v_mfma_f32_16x16x32_bf16 v[200:203], a[136:139], a[8:11], v[200:203]
    v_exp_f32 v194, v194
    v_mfma_f32_16x16x32_bf16 v[200:203], a[140:143], a[12:15], v[200:203]
    v_exp_f32 v195, v195
    v_mfma_f32_16x16x32_bf16 v[204:207], a[156:159], a[12:15], v[216:219]
    v_cvt_pk_bf16_f32 v240, v192, v193
    v_cvt_pk_bf16_f32 v241, v194, v195
    v_mfma_f32_16x16x32_bf16 v[204:207], a[152:155], a[8:11], v[204:207]
    v_exp_f32 v196, v196
    v_mfma_f32_16x16x32_bf16 v[204:207], a[148:151], a[4:7], v[204:207]
    v_exp_f32 v197, v197
    v_mfma_f32_16x16x32_bf16 v[204:207], a[144:147], a[0:3], v[204:207]
    v_exp_f32 v198, v198
    v_mfma_f32_16x16x32_bf16 a[248:251], a[224:227], v[208:211], a[248:251]
    v_exp_f32 v199, v199
    v_mfma_f32_16x16x32_bf16 a[248:251], a[224:227], v[212:215], a[248:251]
    v_cvt_pk_bf16_f32 v242, v196, v197
    v_cvt_pk_bf16_f32 v243, v198, v199
    v_mfma_f32_16x16x32_bf16 v[160:163], a[192:195], v[212:215], v[160:163]
    ds_read_b64_tr_b16 a[192:193], v247 offset:25344
    ds_read_b64_tr_b16 a[194:195], v247 offset:25856
    v_mfma_f32_16x16x32_bf16 v[160:163], a[160:163], v[208:211], v[160:163]
    v_exp_f32 v200, v200
    v_mfma_f32_16x16x32_bf16 v[164:167], a[164:167], v[208:211], v[164:167]
    ds_read_b64_tr_b16 a[160:161], v247 offset:8448
    ds_read_b64_tr_b16 a[162:163], v247 offset:8960
    v_mfma_f32_16x16x32_bf16 v[164:167], a[196:199], v[212:215], v[164:167]
    v_exp_f32 v201, v201
    v_mfma_f32_16x16x32_bf16 v[168:171], a[200:203], v[212:215], v[168:171]
    ds_read_b64_tr_b16 a[164:165], v247 offset:8456
    ds_read_b64_tr_b16 a[166:167], v247 offset:8968
    v_mfma_f32_16x16x32_bf16 v[168:171], a[168:171], v[208:211], v[168:171]
    v_exp_f32 v202, v202
    v_mfma_f32_16x16x32_bf16 v[172:175], a[172:175], v[208:211], v[172:175]
    ds_read_b64_tr_b16 a[196:197], v247 offset:25352
    ds_read_b64_tr_b16 a[198:199], v247 offset:25864
    v_mfma_f32_16x16x32_bf16 v[172:175], a[204:207], v[212:215], v[172:175]
    v_exp_f32 v203, v203
    v_mfma_f32_16x16x32_bf16 v[176:179], a[208:211], v[212:215], v[176:179]
    ds_read_b64_tr_b16 a[168:169], v247 offset:8512
    ds_read_b64_tr_b16 a[170:171], v247 offset:9024
    v_mfma_f32_16x16x32_bf16 v[176:179], a[176:179], v[208:211], v[176:179]
    v_cvt_pk_bf16_f32 v252, v200, v201
    v_cvt_pk_bf16_f32 v253, v202, v203
    v_mfma_f32_16x16x32_bf16 v[180:183], a[180:183], v[208:211], v[180:183]
    ds_read_b64_tr_b16 a[200:201], v247 offset:25408
    ds_read_b64_tr_b16 a[202:203], v247 offset:25920
    v_mfma_f32_16x16x32_bf16 v[180:183], a[212:215], v[212:215], v[180:183]
    v_exp_f32 v204, v204
    v_mfma_f32_16x16x32_bf16 v[184:187], a[216:219], v[212:215], v[184:187]
    ds_read_b64_tr_b16 a[172:173], v247 offset:8520
    ds_read_b64_tr_b16 a[174:175], v247 offset:9032
    v_mfma_f32_16x16x32_bf16 v[184:187], a[184:187], v[208:211], v[184:187]
    v_exp_f32 v205, v205
    v_mfma_f32_16x16x32_bf16 v[188:191], a[188:191], v[208:211], v[188:191]
    ds_read_b64_tr_b16 a[204:205], v247 offset:25416
    ds_read_b64_tr_b16 a[206:207], v247 offset:25928
    v_mfma_f32_16x16x32_bf16 v[188:191], a[220:223], v[212:215], v[188:191]
    v_exp_f32 v206, v206
    v_mfma_f32_16x16x32_bf16 v[192:195], a[96:99], a[16:19], v[220:223]
    ds_read_b64_tr_b16 a[176:177], v247 offset:8576
    ds_read_b64_tr_b16 a[178:179], v247 offset:9088
    v_mfma_f32_16x16x32_bf16 v[192:195], a[100:103], a[20:23], v[192:195]
    v_exp_f32 v207, v207
    v_mfma_f32_16x16x32_bf16 v[192:195], a[104:107], a[24:27], v[192:195]
    ds_read_b64_tr_b16 a[208:209], v247 offset:25472
    ds_read_b64_tr_b16 a[210:211], v247 offset:25984
    v_mfma_f32_16x16x32_bf16 v[192:195], a[108:111], a[28:31], v[192:195]
    v_cvt_pk_bf16_f32 v254, v204, v205
    v_cvt_pk_bf16_f32 v255, v206, v207
    v_mfma_f32_16x16x32_bf16 v[196:199], a[124:127], a[28:31], v[220:223]
    ds_read_b64_tr_b16 a[180:181], v247 offset:8584
    ds_read_b64_tr_b16 a[182:183], v247 offset:9096
    v_mfma_f32_16x16x32_bf16 v[196:199], a[120:123], a[24:27], v[196:199]
    v_mfma_f32_16x16x32_bf16 v[196:199], a[116:119], a[20:23], v[196:199]
    s_add_u32 m0, s27, 135168
    ds_read_b64_tr_b16 a[212:213], v247 offset:25480
    ds_read_b64_tr_b16 a[214:215], v247 offset:25992
    v_mfma_f32_16x16x32_bf16 v[196:199], a[112:115], a[16:19], v[196:199]
    buffer_load_dwordx4 v248, s[4:7], s28 offen nt lds
    v_mfma_f32_16x16x32_bf16 v[200:203], a[128:131], a[16:19], v[220:223]
    s_add_u32 m0, s27, 135200
    ds_read_b64_tr_b16 a[184:185], v247 offset:8640
    ds_read_b64_tr_b16 a[186:187], v247 offset:9152
    v_mfma_f32_16x16x32_bf16 v[200:203], a[132:135], a[20:23], v[200:203]
    buffer_load_dwordx4 v248, s[4:7], s28 offen offset:1024 nt lds
    v_mfma_f32_16x16x32_bf16 v[200:203], a[136:139], a[24:27], v[200:203]
    s_add_u32 m0, s27, 135232
    ds_read_b64_tr_b16 a[216:217], v247 offset:25536
    ds_read_b64_tr_b16 a[218:219], v247 offset:26048
    v_mfma_f32_16x16x32_bf16 v[200:203], a[140:143], a[28:31], v[200:203]
    buffer_load_dwordx4 v248, s[4:7], s28 offen offset:2048 nt lds
    v_mfma_f32_16x16x32_bf16 v[204:207], a[156:159], a[28:31], v[220:223]
    s_add_u32 m0, s27, 135264
    ds_read_b64_tr_b16 a[188:189], v247 offset:8648
    ds_read_b64_tr_b16 a[190:191], v247 offset:9160
    v_mfma_f32_16x16x32_bf16 v[204:207], a[152:155], a[24:27], v[204:207]
    buffer_load_dwordx4 v248, s[4:7], s28 offen offset:3072 nt lds
    v_mfma_f32_16x16x32_bf16 v[204:207], a[148:151], a[20:23], v[204:207]
    s_add_u32 s28, s28, 4096
    ds_read_b64_tr_b16 a[220:221], v247 offset:25544
    ds_read_b64_tr_b16 a[222:223], v247 offset:26056
    v_mfma_f32_16x16x32_bf16 v[204:207], a[144:147], a[16:19], v[204:207]
    s_waitcnt lgkmcnt(15)
    v_exp_f32 v192, v192
    v_mfma_f32_16x16x32_bf16 a[228:231], a[224:227], v[240:243], a[228:231]
    v_exp_f32 v193, v193
    v_mfma_f32_16x16x32_bf16 a[228:231], a[224:227], v[252:255], a[228:231]
    v_exp_f32 v194, v194
    v_mfma_f32_16x16x32_bf16 v[0:3], a[192:195], v[252:255], v[0:3]
    v_exp_f32 v195, v195
    v_mfma_f32_16x16x32_bf16 v[0:3], a[160:163], v[240:243], v[0:3]
    s_waitcnt lgkmcnt(15)
    v_cvt_pk_bf16_f32 v208, v192, v193
    v_cvt_pk_bf16_f32 v209, v194, v195
    v_mfma_f32_16x16x32_bf16 v[4:7], a[164:167], v[240:243], v[4:7]
    v_exp_f32 v196, v196
    v_mfma_f32_16x16x32_bf16 v[4:7], a[196:199], v[252:255], v[4:7]
    v_exp_f32 v197, v197
    v_mfma_f32_16x16x32_bf16 v[8:11], a[200:203], v[252:255], v[8:11]
    v_exp_f32 v198, v198
    v_mfma_f32_16x16x32_bf16 v[8:11], a[168:171], v[240:243], v[8:11]
    s_waitcnt lgkmcnt(8)
    v_exp_f32 v199, v199
    v_mfma_f32_16x16x32_bf16 v[12:15], a[172:175], v[240:243], v[12:15]
    v_cvt_pk_bf16_f32 v210, v196, v197
    v_cvt_pk_bf16_f32 v211, v198, v199
    v_mfma_f32_16x16x32_bf16 v[12:15], a[204:207], v[252:255], v[12:15]
    v_exp_f32 v200, v200
    v_mfma_f32_16x16x32_bf16 v[16:19], a[208:211], v[252:255], v[16:19]
    v_exp_f32 v201, v201
    v_mfma_f32_16x16x32_bf16 v[16:19], a[176:179], v[240:243], v[16:19]
    s_waitcnt lgkmcnt(0)
    v_exp_f32 v202, v202
    v_mfma_f32_16x16x32_bf16 v[20:23], a[180:183], v[240:243], v[20:23]
    v_exp_f32 v203, v203
    v_mfma_f32_16x16x32_bf16 v[20:23], a[212:215], v[252:255], v[20:23]
    v_cvt_pk_bf16_f32 v212, v200, v201
    v_cvt_pk_bf16_f32 v213, v202, v203
    v_mfma_f32_16x16x32_bf16 v[24:27], a[216:219], v[252:255], v[24:27]
    v_exp_f32 v204, v204
    v_mfma_f32_16x16x32_bf16 v[24:27], a[184:187], v[240:243], v[24:27]
    v_exp_f32 v205, v205
    v_mfma_f32_16x16x32_bf16 v[28:31], a[188:191], v[240:243], v[28:31]
    v_exp_f32 v206, v206
    v_mfma_f32_16x16x32_bf16 v[28:31], a[220:223], v[252:255], v[28:31]
    s_waitcnt lgkmcnt(0)
    v_exp_f32 v207, v207
    v_mfma_f32_16x16x32_bf16 v[192:195], a[96:99], a[32:35], v[224:227]
    s_barrier
    v_mfma_f32_16x16x32_bf16 v[192:195], a[100:103], a[36:39], v[192:195]
    v_cvt_pk_bf16_f32 v214, v204, v205
    v_cvt_pk_bf16_f32 v215, v206, v207
    v_mfma_f32_16x16x32_bf16 v[192:195], a[104:107], a[40:43], v[192:195]
    v_mfma_f32_16x16x32_bf16 v[192:195], a[108:111], a[44:47], v[192:195]
    v_mfma_f32_16x16x32_bf16 v[196:199], a[124:127], a[44:47], v[224:227]
    v_mfma_f32_16x16x32_bf16 v[196:199], a[120:123], a[40:43], v[196:199]
    v_mfma_f32_16x16x32_bf16 v[196:199], a[116:119], a[36:39], v[196:199]
    v_mfma_f32_16x16x32_bf16 v[196:199], a[112:115], a[32:35], v[196:199]
    v_mfma_f32_16x16x32_bf16 v[200:203], a[128:131], a[32:35], v[224:227]
    v_mfma_f32_16x16x32_bf16 v[200:203], a[132:135], a[36:39], v[200:203]
    v_mfma_f32_16x16x32_bf16 v[200:203], a[136:139], a[40:43], v[200:203]
    v_mfma_f32_16x16x32_bf16 v[200:203], a[140:143], a[44:47], v[200:203]
    v_exp_f32 v192, v192
    v_mfma_f32_16x16x32_bf16 v[204:207], a[156:159], a[44:47], v[224:227]
    v_exp_f32 v193, v193
    v_mfma_f32_16x16x32_bf16 v[204:207], a[152:155], a[40:43], v[204:207]
    v_exp_f32 v194, v194
    v_mfma_f32_16x16x32_bf16 v[204:207], a[148:151], a[36:39], v[204:207]
    v_exp_f32 v195, v195
    v_mfma_f32_16x16x32_bf16 v[204:207], a[144:147], a[32:35], v[204:207]
    v_cvt_pk_bf16_f32 v240, v192, v193
    v_cvt_pk_bf16_f32 v241, v194, v195
    v_mfma_f32_16x16x32_bf16 a[232:235], a[224:227], v[208:211], a[232:235]
    v_exp_f32 v196, v196
    v_mfma_f32_16x16x32_bf16 a[232:235], a[224:227], v[212:215], a[232:235]
    v_exp_f32 v197, v197
    v_mfma_f32_16x16x32_bf16 v[32:35], a[192:195], v[212:215], v[32:35]
    v_exp_f32 v198, v198
    v_mfma_f32_16x16x32_bf16 v[32:35], a[160:163], v[208:211], v[32:35]
    v_exp_f32 v199, v199
    v_mfma_f32_16x16x32_bf16 v[36:39], a[164:167], v[208:211], v[36:39]
    v_cvt_pk_bf16_f32 v242, v196, v197
    v_cvt_pk_bf16_f32 v243, v198, v199
    v_mfma_f32_16x16x32_bf16 v[36:39], a[196:199], v[212:215], v[36:39]
    v_exp_f32 v200, v200
    v_mfma_f32_16x16x32_bf16 v[40:43], a[200:203], v[212:215], v[40:43]
    v_exp_f32 v201, v201
    v_mfma_f32_16x16x32_bf16 v[40:43], a[168:171], v[208:211], v[40:43]
    v_exp_f32 v202, v202
    v_mfma_f32_16x16x32_bf16 v[44:47], a[172:175], v[208:211], v[44:47]
    v_exp_f32 v203, v203
    v_mfma_f32_16x16x32_bf16 v[44:47], a[204:207], v[212:215], v[44:47]
    v_exp_f32 v204, v204
    v_mfma_f32_16x16x32_bf16 v[48:51], a[208:211], v[212:215], v[48:51]
    v_exp_f32 v205, v205
    v_mfma_f32_16x16x32_bf16 v[48:51], a[176:179], v[208:211], v[48:51]
    v_exp_f32 v206, v206
    v_mfma_f32_16x16x32_bf16 v[52:55], a[180:183], v[208:211], v[52:55]
    v_exp_f32 v207, v207
    v_mfma_f32_16x16x32_bf16 v[52:55], a[212:215], v[212:215], v[52:55]
    s_add_u32 m0, s27, 33792
    v_cvt_pk_bf16_f32 v252, v200, v201
    v_cvt_pk_bf16_f32 v253, v202, v203
    v_mfma_f32_16x16x32_bf16 v[56:59], a[216:219], v[212:215], v[56:59]
    buffer_load_dwordx4 v248, s[8:11], s24 offen nt lds
    v_mfma_f32_16x16x32_bf16 v[56:59], a[184:187], v[208:211], v[56:59]
    s_add_u32 m0, s27, 33824
    v_cvt_pk_bf16_f32 v254, v204, v205
    v_cvt_pk_bf16_f32 v255, v206, v207
    v_mfma_f32_16x16x32_bf16 v[60:63], a[188:191], v[208:211], v[60:63]
    buffer_load_dwordx4 v248, s[8:11], s24 offen offset:1024 nt lds
    v_mfma_f32_16x16x32_bf16 v[60:63], a[220:223], v[212:215], v[60:63]
    s_add_u32 m0, s27, 33856
    v_mfma_f32_16x16x32_bf16 v[192:195], a[96:99], a[48:51], v[228:231]
    buffer_load_dwordx4 v248, s[8:11], s24 offen offset:2048 nt lds
    v_mfma_f32_16x16x32_bf16 v[192:195], a[100:103], a[52:55], v[192:195]
    s_add_u32 m0, s27, 33888
    v_mfma_f32_16x16x32_bf16 v[192:195], a[104:107], a[56:59], v[192:195]
    buffer_load_dwordx4 v248, s[8:11], s24 offen offset:3072 nt lds
    v_mfma_f32_16x16x32_bf16 v[192:195], a[108:111], a[60:63], v[192:195]
    s_add_u32 s24, s24, 8192
    v_mfma_f32_16x16x32_bf16 v[196:199], a[124:127], a[60:63], v[228:231]
    v_mfma_f32_16x16x32_bf16 v[196:199], a[120:123], a[56:59], v[196:199]
    v_mfma_f32_16x16x32_bf16 v[196:199], a[116:119], a[52:55], v[196:199]
    v_mfma_f32_16x16x32_bf16 v[196:199], a[112:115], a[48:51], v[196:199]
    v_mfma_f32_16x16x32_bf16 v[200:203], a[128:131], a[48:51], v[228:231]
    v_subrev_u32 v246, 33792, v246
    v_subrev_u32 v247, 33792, v247
    v_subrev_u32 v249, 16896, v249
    v_mfma_f32_16x16x32_bf16 v[200:203], a[132:135], a[52:55], v[200:203]
    v_exp_f32 v192, v192
    v_mfma_f32_16x16x32_bf16 v[200:203], a[136:139], a[56:59], v[200:203]
    v_exp_f32 v193, v193
    v_mfma_f32_16x16x32_bf16 v[200:203], a[140:143], a[60:63], v[200:203]
    v_exp_f32 v194, v194
    v_mfma_f32_16x16x32_bf16 v[204:207], a[156:159], a[60:63], v[228:231]
    v_exp_f32 v195, v195
    v_mfma_f32_16x16x32_bf16 v[204:207], a[152:155], a[56:59], v[204:207]
    v_cvt_pk_bf16_f32 v208, v192, v193
    v_cvt_pk_bf16_f32 v209, v194, v195
    v_mfma_f32_16x16x32_bf16 v[204:207], a[148:151], a[52:55], v[204:207]
    v_exp_f32 v196, v196
    v_mfma_f32_16x16x32_bf16 v[204:207], a[144:147], a[48:51], v[204:207]
    v_exp_f32 v197, v197
    v_mfma_f32_16x16x32_bf16 a[236:239], a[224:227], v[240:243], a[236:239]
    v_exp_f32 v198, v198
    v_mfma_f32_16x16x32_bf16 a[236:239], a[224:227], v[252:255], a[236:239]
    v_exp_f32 v199, v199
    v_mfma_f32_16x16x32_bf16 v[64:67], a[192:195], v[252:255], v[64:67]
    v_cvt_pk_bf16_f32 v210, v196, v197
    v_cvt_pk_bf16_f32 v211, v198, v199
    v_mfma_f32_16x16x32_bf16 v[64:67], a[160:163], v[240:243], v[64:67]
    v_exp_f32 v200, v200
    v_mfma_f32_16x16x32_bf16 v[68:71], a[164:167], v[240:243], v[68:71]
    v_exp_f32 v201, v201
    v_mfma_f32_16x16x32_bf16 v[68:71], a[196:199], v[252:255], v[68:71]
    v_exp_f32 v202, v202
    v_mfma_f32_16x16x32_bf16 v[72:75], a[200:203], v[252:255], v[72:75]
    v_exp_f32 v203, v203
    v_mfma_f32_16x16x32_bf16 v[72:75], a[168:171], v[240:243], v[72:75]
    v_cvt_pk_bf16_f32 v212, v200, v201
    v_cvt_pk_bf16_f32 v213, v202, v203
    v_mfma_f32_16x16x32_bf16 v[76:79], a[172:175], v[240:243], v[76:79]
    v_exp_f32 v204, v204
    v_mfma_f32_16x16x32_bf16 v[76:79], a[204:207], v[252:255], v[76:79]
    v_exp_f32 v205, v205
    v_mfma_f32_16x16x32_bf16 v[80:83], a[208:211], v[252:255], v[80:83]
    v_exp_f32 v206, v206
    v_mfma_f32_16x16x32_bf16 v[80:83], a[176:179], v[240:243], v[80:83]
    v_exp_f32 v207, v207
    v_mfma_f32_16x16x32_bf16 v[84:87], a[180:183], v[240:243], v[84:87]
    v_cvt_pk_bf16_f32 v214, v204, v205
    v_cvt_pk_bf16_f32 v215, v206, v207
    v_mfma_f32_16x16x32_bf16 v[84:87], a[212:215], v[252:255], v[84:87]
    v_mfma_f32_16x16x32_bf16 v[88:91], a[216:219], v[252:255], v[88:91]
    v_mfma_f32_16x16x32_bf16 v[88:91], a[184:187], v[240:243], v[88:91]
    v_mfma_f32_16x16x32_bf16 v[92:95], a[188:191], v[240:243], v[92:95]
    v_mfma_f32_16x16x32_bf16 v[92:95], a[220:223], v[252:255], v[92:95]
    v_mfma_f32_16x16x32_bf16 v[192:195], a[96:99], a[64:67], v[232:235]
    v_mfma_f32_16x16x32_bf16 v[192:195], a[100:103], a[68:71], v[192:195]
    v_mfma_f32_16x16x32_bf16 v[192:195], a[104:107], a[72:75], v[192:195]
    v_mfma_f32_16x16x32_bf16 v[192:195], a[108:111], a[76:79], v[192:195]
    v_mfma_f32_16x16x32_bf16 v[196:199], a[124:127], a[76:79], v[232:235]
    v_mfma_f32_16x16x32_bf16 v[196:199], a[120:123], a[72:75], v[196:199]
    v_mfma_f32_16x16x32_bf16 v[196:199], a[116:119], a[68:71], v[196:199]
    v_mfma_f32_16x16x32_bf16 v[196:199], a[112:115], a[64:67], v[196:199]
    v_mfma_f32_16x16x32_bf16 v[200:203], a[128:131], a[64:67], v[232:235]
    v_mfma_f32_16x16x32_bf16 v[200:203], a[132:135], a[68:71], v[200:203]
    v_mfma_f32_16x16x32_bf16 v[200:203], a[136:139], a[72:75], v[200:203]
    v_mfma_f32_16x16x32_bf16 v[200:203], a[140:143], a[76:79], v[200:203]
    v_exp_f32 v192, v192
    v_mfma_f32_16x16x32_bf16 v[204:207], a[156:159], a[76:79], v[232:235]
    v_exp_f32 v193, v193
    v_mfma_f32_16x16x32_bf16 v[204:207], a[152:155], a[72:75], v[204:207]
    v_exp_f32 v194, v194
    v_mfma_f32_16x16x32_bf16 v[204:207], a[148:151], a[68:71], v[204:207]
    v_exp_f32 v195, v195
    v_mfma_f32_16x16x32_bf16 v[204:207], a[144:147], a[64:67], v[204:207]
    v_cvt_pk_bf16_f32 v240, v192, v193
    v_cvt_pk_bf16_f32 v241, v194, v195
    v_mfma_f32_16x16x32_bf16 a[240:243], a[224:227], v[208:211], a[240:243]
    v_exp_f32 v196, v196
    v_mfma_f32_16x16x32_bf16 a[240:243], a[224:227], v[212:215], a[240:243]
    v_exp_f32 v197, v197
    v_mfma_f32_16x16x32_bf16 v[96:99], a[192:195], v[212:215], v[96:99]
    v_exp_f32 v198, v198
    v_mfma_f32_16x16x32_bf16 v[96:99], a[160:163], v[208:211], v[96:99]
    s_add_u32 m0, s27, 50688
    v_exp_f32 v199, v199
    v_mfma_f32_16x16x32_bf16 v[100:103], a[164:167], v[208:211], v[100:103]
    buffer_load_dwordx4 v248, s[8:11], s24 offen nt lds
    v_mfma_f32_16x16x32_bf16 v[100:103], a[196:199], v[212:215], v[100:103]
    s_add_u32 m0, s27, 50720
    v_cvt_pk_bf16_f32 v242, v196, v197
    v_cvt_pk_bf16_f32 v243, v198, v199
    v_mfma_f32_16x16x32_bf16 v[104:107], a[200:203], v[212:215], v[104:107]
    buffer_load_dwordx4 v248, s[8:11], s24 offen offset:1024 nt lds
    v_mfma_f32_16x16x32_bf16 v[104:107], a[168:171], v[208:211], v[104:107]
    s_add_u32 m0, s27, 50752
    v_exp_f32 v200, v200
    v_mfma_f32_16x16x32_bf16 v[108:111], a[172:175], v[208:211], v[108:111]
    buffer_load_dwordx4 v248, s[8:11], s24 offen offset:2048 nt lds
    v_mfma_f32_16x16x32_bf16 v[108:111], a[204:207], v[212:215], v[108:111]
    s_add_u32 m0, s27, 50784
    v_exp_f32 v201, v201
    v_mfma_f32_16x16x32_bf16 v[112:115], a[208:211], v[212:215], v[112:115]
    buffer_load_dwordx4 v248, s[8:11], s24 offen offset:3072 nt lds
    v_mfma_f32_16x16x32_bf16 v[112:115], a[176:179], v[208:211], v[112:115]
    s_add_u32 s24, s24, 8192
    v_exp_f32 v202, v202
    v_mfma_f32_16x16x32_bf16 v[116:119], a[180:183], v[208:211], v[116:119]
    v_exp_f32 v203, v203
    v_mfma_f32_16x16x32_bf16 v[116:119], a[212:215], v[212:215], v[116:119]
    v_cvt_pk_bf16_f32 v252, v200, v201
    v_cvt_pk_bf16_f32 v253, v202, v203
    v_mfma_f32_16x16x32_bf16 v[120:123], a[216:219], v[212:215], v[120:123]
    v_exp_f32 v204, v204
    v_mfma_f32_16x16x32_bf16 v[120:123], a[184:187], v[208:211], v[120:123]
    v_exp_f32 v205, v205
    v_mfma_f32_16x16x32_bf16 v[124:127], a[188:191], v[208:211], v[124:127]
    v_exp_f32 v206, v206
    v_mfma_f32_16x16x32_bf16 v[124:127], a[220:223], v[212:215], v[124:127]
    v_exp_f32 v207, v207
    v_mfma_f32_16x16x32_bf16 v[192:195], a[96:99], a[80:83], v[236:239]
    v_cvt_pk_bf16_f32 v254, v204, v205
    v_cvt_pk_bf16_f32 v255, v206, v207
    v_mfma_f32_16x16x32_bf16 v[192:195], a[100:103], a[84:87], v[192:195]
    v_mfma_f32_16x16x32_bf16 v[192:195], a[104:107], a[88:91], v[192:195]
    v_mfma_f32_16x16x32_bf16 v[192:195], a[108:111], a[92:95], v[192:195]
    v_mfma_f32_16x16x32_bf16 v[196:199], a[124:127], a[92:95], v[236:239]
    v_mfma_f32_16x16x32_bf16 v[196:199], a[120:123], a[88:91], v[196:199]
    v_mfma_f32_16x16x32_bf16 v[196:199], a[116:119], a[84:87], v[196:199]
    v_mfma_f32_16x16x32_bf16 v[196:199], a[112:115], a[80:83], v[196:199]
    v_mfma_f32_16x16x32_bf16 v[200:203], a[128:131], a[80:83], v[236:239]
    s_waitcnt vmcnt(20)
    v_mfma_f32_16x16x32_bf16 v[200:203], a[132:135], a[84:87], v[200:203]
    s_barrier
    v_mfma_f32_16x16x32_bf16 v[200:203], a[136:139], a[88:91], v[200:203]
    ds_read_b128 a[96:99], v246 offset:0
    ds_read_b128 a[100:103], v246 offset:64
    v_mfma_f32_16x16x32_bf16 v[200:203], a[140:143], a[92:95], v[200:203]
    v_exp_f32 v192, v192
    v_mfma_f32_16x16x32_bf16 v[204:207], a[156:159], a[92:95], v[236:239]
    ds_read_b128 a[104:107], v246 offset:128
    ds_read_b128 a[108:111], v246 offset:192
    v_mfma_f32_16x16x32_bf16 v[204:207], a[152:155], a[88:91], v[204:207]
    v_exp_f32 v193, v193
    v_mfma_f32_16x16x32_bf16 v[204:207], a[148:151], a[84:87], v[204:207]
    ds_read_b128 a[124:127], v246 offset:704
    ds_read_b128 a[128:131], v246 offset:16896
    v_mfma_f32_16x16x32_bf16 v[204:207], a[144:147], a[80:83], v[204:207]
    v_exp_f32 v194, v194
    v_mfma_f32_16x16x32_bf16 a[244:247], a[224:227], v[240:243], a[244:247]
    ds_read_b128 a[120:123], v246 offset:640
    ds_read_b128 a[132:135], v246 offset:16960
    v_mfma_f32_16x16x32_bf16 a[244:247], a[224:227], v[252:255], a[244:247]
    v_exp_f32 v195, v195
    v_mfma_f32_16x16x32_bf16 v[128:131], a[192:195], v[252:255], v[128:131]
    ds_read_b128 a[116:119], v246 offset:576
    ds_read_b128 a[136:139], v246 offset:17024
    v_mfma_f32_16x16x32_bf16 v[128:131], a[160:163], v[240:243], v[128:131]
    v_cvt_pk_bf16_f32 v208, v192, v193
    v_cvt_pk_bf16_f32 v209, v194, v195
    v_mfma_f32_16x16x32_bf16 v[132:135], a[164:167], v[240:243], v[132:135]
    ds_read_b128 a[112:115], v246 offset:512
    ds_read_b128 a[140:143], v246 offset:17088
    v_mfma_f32_16x16x32_bf16 v[132:135], a[196:199], v[252:255], v[132:135]
    v_exp_f32 v196, v196
    v_mfma_f32_16x16x32_bf16 v[136:139], a[200:203], v[252:255], v[136:139]
    ds_read_b128 a[156:159], v246 offset:17600
    ds_read_b128 a[152:155], v246 offset:17536
    v_mfma_f32_16x16x32_bf16 v[136:139], a[168:171], v[240:243], v[136:139]
    v_exp_f32 v197, v197
    v_mfma_f32_16x16x32_bf16 v[140:143], a[172:175], v[240:243], v[140:143]
    ds_read_b128 a[148:151], v246 offset:17472
    ds_read_b128 a[144:147], v246 offset:17408
    v_mfma_f32_16x16x32_bf16 v[140:143], a[204:207], v[252:255], v[140:143]
    v_exp_f32 v198, v198
    v_mfma_f32_16x16x32_bf16 v[144:147], a[208:211], v[252:255], v[144:147]
    v_exp_f32 v199, v199
    v_mfma_f32_16x16x32_bf16 v[144:147], a[176:179], v[240:243], v[144:147]
    v_cvt_pk_bf16_f32 v210, v196, v197
    v_cvt_pk_bf16_f32 v211, v198, v199
    v_mfma_f32_16x16x32_bf16 v[148:151], a[180:183], v[240:243], v[148:151]
    v_exp_f32 v200, v200
    v_mfma_f32_16x16x32_bf16 v[148:151], a[212:215], v[252:255], v[148:151]
    v_exp_f32 v201, v201
    v_mfma_f32_16x16x32_bf16 v[152:155], a[216:219], v[252:255], v[152:155]
    v_exp_f32 v202, v202
    v_mfma_f32_16x16x32_bf16 v[152:155], a[184:187], v[240:243], v[152:155]
    s_waitcnt lgkmcnt(5)
    v_exp_f32 v203, v203
    v_mfma_f32_16x16x32_bf16 v[156:159], a[188:191], v[240:243], v[156:159]
    v_cvt_pk_bf16_f32 v212, v200, v201
    v_cvt_pk_bf16_f32 v213, v202, v203
    v_mfma_f32_16x16x32_bf16 v[156:159], a[220:223], v[252:255], v[156:159]
    v_exp_f32 v204, v204
    v_mfma_f32_16x16x32_bf16 v[192:195], a[96:99], a[0:3], v[216:219]
    v_exp_f32 v205, v205
    v_mfma_f32_16x16x32_bf16 v[192:195], a[100:103], a[4:7], v[192:195]
    v_exp_f32 v206, v206
    v_mfma_f32_16x16x32_bf16 v[192:195], a[104:107], a[8:11], v[192:195]
    v_exp_f32 v207, v207
    v_mfma_f32_16x16x32_bf16 v[192:195], a[108:111], a[12:15], v[192:195]
    v_cvt_pk_bf16_f32 v214, v204, v205
    v_cvt_pk_bf16_f32 v215, v206, v207
    v_mfma_f32_16x16x32_bf16 v[196:199], a[124:127], a[12:15], v[216:219]
    v_mfma_f32_16x16x32_bf16 v[196:199], a[120:123], a[8:11], v[196:199]
    s_waitcnt lgkmcnt(0)
    v_mfma_f32_16x16x32_bf16 v[196:199], a[116:119], a[4:7], v[196:199]
    s_add_u32 m0, s27, 101376
    v_mfma_f32_16x16x32_bf16 v[196:199], a[112:115], a[0:3], v[196:199]
    buffer_load_dwordx4 v248, s[4:7], s28 offen nt lds
    v_mfma_f32_16x16x32_bf16 v[200:203], a[128:131], a[0:3], v[216:219]
    s_add_u32 m0, s27, 101408
    v_exp_f32 v192, v192
    v_mfma_f32_16x16x32_bf16 v[200:203], a[132:135], a[4:7], v[200:203]
    buffer_load_dwordx4 v248, s[4:7], s28 offen offset:1024 nt lds
    v_mfma_f32_16x16x32_bf16 v[200:203], a[136:139], a[8:11], v[200:203]
    s_add_u32 m0, s27, 101440
    v_exp_f32 v193, v193
    v_mfma_f32_16x16x32_bf16 v[200:203], a[140:143], a[12:15], v[200:203]
Lhop4:
    s_cbranch_execz Lret1
    buffer_load_dwordx4 v248, s[4:7], s28 offen offset:2048 nt lds
    v_mfma_f32_16x16x32_bf16 v[204:207], a[156:159], a[12:15], v[216:219]
    s_add_u32 m0, s27, 101472
    v_exp_f32 v194, v194
    v_mfma_f32_16x16x32_bf16 v[204:207], a[152:155], a[8:11], v[204:207]
    buffer_load_dwordx4 v248, s[4:7], s28 offen offset:3072 nt lds
    v_mfma_f32_16x16x32_bf16 v[204:207], a[148:151], a[4:7], v[204:207]
    s_add_u32 s28, s28, 4096
    v_exp_f32 v195, v195
    v_mfma_f32_16x16x32_bf16 v[204:207], a[144:147], a[0:3], v[204:207]
    v_cvt_pk_bf16_f32 v240, v192, v193
    v_cvt_pk_bf16_f32 v241, v194, v195
    v_mfma_f32_16x16x32_bf16 a[248:251], a[224:227], v[208:211], a[248:251]
    s_waitcnt vmcnt(20)
    ds_read_b128 a[0:3], v249 offset:0
    v_mfma_f32_16x16x32_bf16 a[248:251], a[224:227], v[212:215], a[248:251]
    v_exp_f32 v196, v196
    v_mfma_f32_16x16x32_bf16 v[160:163], a[192:195], v[212:215], v[160:163]
    ds_read_b128 a[4:7], v249 offset:64
    ds_read_b64_tr_b16 a[192:193], v247 offset:25344
    v_mfma_f32_16x16x32_bf16 v[160:163], a[160:163], v[208:211], v[160:163]
    v_exp_f32 v197, v197
    v_mfma_f32_16x16x32_bf16 v[164:167], a[164:167], v[208:211], v[164:167]
    ds_read_b128 a[8:11], v249 offset:128
    ds_read_b64_tr_b16 a[160:161], v247 offset:8448
    v_mfma_f32_16x16x32_bf16 v[164:167], a[196:199], v[212:215], v[164:167]
    v_exp_f32 v198, v198
    v_mfma_f32_16x16x32_bf16 v[168:171], a[200:203], v[212:215], v[168:171]
    ds_read_b128 a[12:15], v249 offset:192
    ds_read_b64_tr_b16 a[162:163], v247 offset:8960
    v_mfma_f32_16x16x32_bf16 v[168:171], a[168:171], v[208:211], v[168:171]
    v_exp_f32 v199, v199
    v_mfma_f32_16x16x32_bf16 v[172:175], a[172:175], v[208:211], v[172:175]
    ds_read_b64_tr_b16 a[194:195], v247 offset:25856
    ds_read_b64_tr_b16 a[164:165], v247 offset:8456
    v_mfma_f32_16x16x32_bf16 v[172:175], a[204:207], v[212:215], v[172:175]
    v_cvt_pk_bf16_f32 v242, v196, v197
    v_cvt_pk_bf16_f32 v243, v198, v199
    v_mfma_f32_16x16x32_bf16 v[176:179], a[208:211], v[212:215], v[176:179]
    ds_read_b64_tr_b16 a[166:167], v247 offset:8968
    ds_read_b64_tr_b16 a[196:197], v247 offset:25352
    v_mfma_f32_16x16x32_bf16 v[176:179], a[176:179], v[208:211], v[176:179]
    v_exp_f32 v200, v200
    v_mfma_f32_16x16x32_bf16 v[180:183], a[180:183], v[208:211], v[180:183]
    ds_read_b64_tr_b16 a[198:199], v247 offset:25864
    ds_read_b64_tr_b16 a[168:169], v247 offset:8512
    v_mfma_f32_16x16x32_bf16 v[180:183], a[212:215], v[212:215], v[180:183]
    v_exp_f32 v201, v201
    v_mfma_f32_16x16x32_bf16 v[184:187], a[216:219], v[212:215], v[184:187]
    ds_read_b64_tr_b16 a[170:171], v247 offset:9024
    ds_read_b64_tr_b16 a[200:201], v247 offset:25408
    v_mfma_f32_16x16x32_bf16 v[184:187], a[184:187], v[208:211], v[184:187]
    v_exp_f32 v202, v202
    v_mfma_f32_16x16x32_bf16 v[188:191], a[188:191], v[208:211], v[188:191]
    ds_read_b64_tr_b16 a[202:203], v247 offset:25920
    ds_read_b64_tr_b16 a[172:173], v247 offset:8520
    v_mfma_f32_16x16x32_bf16 v[188:191], a[220:223], v[212:215], v[188:191]
    v_exp_f32 v203, v203
    v_mfma_f32_16x16x32_bf16 v[192:195], a[96:99], a[16:19], v[220:223]
    ds_read_b64_tr_b16 a[174:175], v247 offset:9032
    ds_read_b64_tr_b16 a[204:205], v247 offset:25416
    v_mfma_f32_16x16x32_bf16 v[192:195], a[100:103], a[20:23], v[192:195]
    v_cvt_pk_bf16_f32 v252, v200, v201
    v_cvt_pk_bf16_f32 v253, v202, v203
    v_mfma_f32_16x16x32_bf16 v[192:195], a[104:107], a[24:27], v[192:195]
    ds_read_b64_tr_b16 a[206:207], v247 offset:25928
    ds_read_b64_tr_b16 a[176:177], v247 offset:8576
    v_mfma_f32_16x16x32_bf16 v[192:195], a[108:111], a[28:31], v[192:195]
    v_exp_f32 v204, v204
    v_mfma_f32_16x16x32_bf16 v[196:199], a[124:127], a[28:31], v[220:223]
    ds_read_b64_tr_b16 a[178:179], v247 offset:9088
    ds_read_b64_tr_b16 a[208:209], v247 offset:25472
    v_mfma_f32_16x16x32_bf16 v[196:199], a[120:123], a[24:27], v[196:199]
    v_exp_f32 v205, v205
    v_mfma_f32_16x16x32_bf16 v[196:199], a[116:119], a[20:23], v[196:199]
    v_exp_f32 v206, v206
    v_mfma_f32_16x16x32_bf16 v[196:199], a[112:115], a[16:19], v[196:199]
    v_exp_f32 v207, v207
    v_mfma_f32_16x16x32_bf16 v[200:203], a[128:131], a[16:19], v[220:223]
    ds_read_b64_tr_b16 a[210:211], v247 offset:25984
    v_cvt_pk_bf16_f32 v254, v204, v205
    v_mfma_f32_16x16x32_bf16 v[200:203], a[132:135], a[20:23], v[200:203]
    ds_read_b64_tr_b16 a[180:181], v247 offset:8584
    v_cvt_pk_bf16_f32 v255, v206, v207
    v_mfma_f32_16x16x32_bf16 v[200:203], a[136:139], a[24:27], v[200:203]
    v_exp_f32 v192, v192
    v_mfma_f32_16x16x32_bf16 v[200:203], a[140:143], a[28:31], v[200:203]
    ds_read_b64_tr_b16 a[182:183], v247 offset:9096
    ds_read_b64_tr_b16 a[212:213], v247 offset:25480
    v_mfma_f32_16x16x32_bf16 v[204:207], a[156:159], a[28:31], v[220:223]
    v_exp_f32 v193, v193
    v_mfma_f32_16x16x32_bf16 v[204:207], a[152:155], a[24:27], v[204:207]
    ds_read_b64_tr_b16 a[214:215], v247 offset:25992
    ds_read_b64_tr_b16 a[184:185], v247 offset:8640
    v_mfma_f32_16x16x32_bf16 v[204:207], a[148:151], a[20:23], v[204:207]
    v_exp_f32 v194, v194
    v_mfma_f32_16x16x32_bf16 v[204:207], a[144:147], a[16:19], v[204:207]
    s_waitcnt lgkmcnt(15)
    ds_read_b64_tr_b16 a[186:187], v247 offset:9152
    ds_read_b64_tr_b16 a[216:217], v247 offset:25536
    v_mfma_f32_16x16x32_bf16 a[228:231], a[224:227], v[240:243], a[228:231]
    s_waitcnt vmcnt(16)
    v_exp_f32 v195, v195
    v_mfma_f32_16x16x32_bf16 a[228:231], a[224:227], v[252:255], a[228:231]
    ds_read_b128 a[16:19], v249 offset:16896
    ds_read_b64_tr_b16 a[218:219], v247 offset:26048
    v_mfma_f32_16x16x32_bf16 v[0:3], a[192:195], v[252:255], v[0:3]
    v_cvt_pk_bf16_f32 v208, v192, v193
    v_cvt_pk_bf16_f32 v209, v194, v195
    v_mfma_f32_16x16x32_bf16 v[0:3], a[160:163], v[240:243], v[0:3]
    s_waitcnt lgkmcnt(13)
    ds_read_b128 a[20:23], v249 offset:16960
    ds_read_b64_tr_b16 a[188:189], v247 offset:8648
    v_mfma_f32_16x16x32_bf16 v[4:7], a[164:167], v[240:243], v[4:7]
    s_add_u32 m0, s27, 118272
    v_exp_f32 v196, v196
    v_mfma_f32_16x16x32_bf16 v[4:7], a[196:199], v[252:255], v[4:7]
    ds_read_b64_tr_b16 a[190:191], v247 offset:9160
    ds_read_b128 a[24:27], v249 offset:17024
    v_mfma_f32_16x16x32_bf16 v[8:11], a[200:203], v[252:255], v[8:11]
    ds_read_b64_tr_b16 a[220:221], v247 offset:25544
    ds_read_b64_tr_b16 a[222:223], v247 offset:26056
    v_mfma_f32_16x16x32_bf16 v[8:11], a[168:171], v[240:243], v[8:11]
    s_waitcnt lgkmcnt(11)
    buffer_load_dwordx4 v248, s[4:7], s28 offen nt lds
    v_mfma_f32_16x16x32_bf16 v[12:15], a[172:175], v[240:243], v[12:15]
    s_add_u32 m0, s27, 118304
    ds_read_b128 a[28:31], v249 offset:17088
    v_add_u32 v249, 16896, v249
    v_mfma_f32_16x16x32_bf16 v[12:15], a[204:207], v[252:255], v[12:15]
    buffer_load_dwordx4 v248, s[4:7], s28 offen offset:1024 nt lds
    v_mfma_f32_16x16x32_bf16 v[16:19], a[208:211], v[252:255], v[16:19]
    s_add_u32 m0, s27, 118336
    v_exp_f32 v197, v197
    v_mfma_f32_16x16x32_bf16 v[16:19], a[176:179], v[240:243], v[16:19]
    buffer_load_dwordx4 v248, s[4:7], s28 offen offset:2048 nt lds
    v_mfma_f32_16x16x32_bf16 v[20:23], a[180:183], v[240:243], v[20:23]
    s_add_u32 m0, s27, 118368
    v_exp_f32 v198, v198
    v_mfma_f32_16x16x32_bf16 v[20:23], a[212:215], v[252:255], v[20:23]
    s_waitcnt lgkmcnt(1)
    v_exp_f32 v199, v199
    v_mfma_f32_16x16x32_bf16 v[24:27], a[216:219], v[252:255], v[24:27]
    v_cvt_pk_bf16_f32 v210, v196, v197
    v_cvt_pk_bf16_f32 v211, v198, v199
    v_mfma_f32_16x16x32_bf16 v[24:27], a[184:187], v[240:243], v[24:27]
    buffer_load_dwordx4 v248, s[4:7], s28 offen offset:3072 nt lds
    v_mfma_f32_16x16x32_bf16 v[28:31], a[188:191], v[240:243], v[28:31]
    s_add_u32 s28, s28, 4096
    v_exp_f32 v200, v200
    v_mfma_f32_16x16x32_bf16 v[28:31], a[220:223], v[252:255], v[28:31]
    s_waitcnt lgkmcnt(1)
    v_exp_f32 v201, v201
    v_mfma_f32_16x16x32_bf16 v[192:195], a[96:99], a[32:35], v[224:227]
    s_barrier
    v_mfma_f32_16x16x32_bf16 v[192:195], a[100:103], a[36:39], v[192:195]
    v_exp_f32 v202, v202
    v_mfma_f32_16x16x32_bf16 v[192:195], a[104:107], a[40:43], v[192:195]
    v_exp_f32 v203, v203
    v_accvgpr_read_b32 v216, a228
    v_rcp_f32 v218, v216
    v_cmp_ngt_f32 vcc, s22, v216
    v_pk_mul_f32 v[0:1], v[0:1], v[218:219] op_sel_hi:[1,0]
    v_pk_mul_f32 v[2:3], v[2:3], v[218:219] op_sel_hi:[1,0]
    v_pk_mul_f32 v[4:5], v[4:5], v[218:219] op_sel_hi:[1,0]
    v_pk_mul_f32 v[6:7], v[6:7], v[218:219] op_sel_hi:[1,0]
    v_pk_mul_f32 v[8:9], v[8:9], v[218:219] op_sel_hi:[1,0]
    v_pk_mul_f32 v[10:11], v[10:11], v[218:219] op_sel_hi:[1,0]
    v_pk_mul_f32 v[12:13], v[12:13], v[218:219] op_sel_hi:[1,0]
    v_pk_mul_f32 v[14:15], v[14:15], v[218:219] op_sel_hi:[1,0]
    v_pk_mul_f32 v[16:17], v[16:17], v[218:219] op_sel_hi:[1,0]
    v_pk_mul_f32 v[18:19], v[18:19], v[218:219] op_sel_hi:[1,0]
    v_pk_mul_f32 v[20:21], v[20:21], v[218:219] op_sel_hi:[1,0]
    v_pk_mul_f32 v[22:23], v[22:23], v[218:219] op_sel_hi:[1,0]
    v_pk_mul_f32 v[24:25], v[24:25], v[218:219] op_sel_hi:[1,0]
    v_pk_mul_f32 v[26:27], v[26:27], v[218:219] op_sel_hi:[1,0]
    v_pk_mul_f32 v[28:29], v[28:29], v[218:219] op_sel_hi:[1,0]
    v_pk_mul_f32 v[30:31], v[30:31], v[218:219] op_sel_hi:[1,0]
    v_mfma_f32_16x16x32_bf16 v[192:195], a[108:111], a[44:47], v[192:195]
    s_or_b64 s[76:77], s[76:77], vcc
    v_cvt_pk_bf16_f32 v212, v200, v201
    v_cvt_pk_bf16_f32 v213, v202, v203
    v_mfma_f32_16x16x32_bf16 v[196:199], a[124:127], a[44:47], v[224:227]
    v_exp_f32 v204, v204
    v_mfma_f32_16x16x32_bf16 v[196:199], a[120:123], a[40:43], v[196:199]
    v_exp_f32 v205, v205
    v_mfma_f32_16x16x32_bf16 v[196:199], a[116:119], a[36:39], v[196:199]
    v_exp_f32 v206, v206
    v_mfma_f32_16x16x32_bf16 v[196:199], a[112:115], a[32:35], v[196:199]
    v_exp_f32 v207, v207
    v_mfma_f32_16x16x32_bf16 v[200:203], a[128:131], a[32:35], v[224:227]
    v_cvt_pk_bf16_f32 v214, v204, v205
    v_cvt_pk_bf16_f32 v215, v206, v207
    v_mfma_f32_16x16x32_bf16 v[200:203], a[132:135], a[36:39], v[200:203]
    v_exp_f32 v192, v192
    v_mfma_f32_16x16x32_bf16 v[200:203], a[136:139], a[40:43], v[200:203]
    v_exp_f32 v193, v193
    v_mfma_f32_16x16x32_bf16 v[200:203], a[140:143], a[44:47], v[200:203]
    v_exp_f32 v194, v194
    v_mfma_f32_16x16x32_bf16 v[204:207], a[156:159], a[44:47], v[224:227]
    v_exp_f32 v195, v195
    v_mfma_f32_16x16x32_bf16 v[204:207], a[152:155], a[40:43], v[204:207]
    v_cvt_pk_bf16_f32 v240, v192, v193
    v_cvt_pk_bf16_f32 v241, v194, v195
    v_mfma_f32_16x16x32_bf16 v[204:207], a[148:151], a[36:39], v[204:207]
    v_exp_f32 v196, v196
    v_mfma_f32_16x16x32_bf16 v[204:207], a[144:147], a[32:35], v[204:207]
    v_exp_f32 v197, v197
    v_mfma_f32_16x16x32_bf16 a[232:235], a[224:227], v[208:211], a[232:235]
    s_waitcnt vmcnt(16)
    ds_read_b128 a[32:35], v249 offset:50688
    v_cvt_pk_bf16_f32 v242, v196, v197
    v_mfma_f32_16x16x32_bf16 a[232:235], a[224:227], v[212:215], a[232:235]
    v_exp_f32 v198, v198
    v_mfma_f32_16x16x32_bf16 v[32:35], a[192:195], v[212:215], v[32:35]
    ds_read_b128 a[36:39], v249 offset:50752
    v_cvt_pk_bf16_f32 v0, v0, v1
    v_mfma_f32_16x16x32_bf16 v[32:35], a[160:163], v[208:211], v[32:35]
    v_exp_f32 v199, v199
    v_mfma_f32_16x16x32_bf16 v[36:39], a[164:167], v[208:211], v[36:39]
    ds_read_b128 a[40:43], v249 offset:50816
    v_cvt_pk_bf16_f32 v243, v198, v199
    v_mfma_f32_16x16x32_bf16 v[36:39], a[196:199], v[212:215], v[36:39]
    v_exp_f32 v200, v200
    v_mfma_f32_16x16x32_bf16 v[40:43], a[200:203], v[212:215], v[40:43]
    ds_read_b128 a[44:47], v249 offset:50880
    v_cvt_pk_bf16_f32 v1, v2, v3
    v_mfma_f32_16x16x32_bf16 v[40:43], a[168:171], v[208:211], v[40:43]
    v_exp_f32 v201, v201
    v_mfma_f32_16x16x32_bf16 v[44:47], a[172:175], v[208:211], v[44:47]
    v_exp_f32 v202, v202
    v_mfma_f32_16x16x32_bf16 v[44:47], a[204:207], v[212:215], v[44:47]
    v_exp_f32 v203, v203
    v_mfma_f32_16x16x32_bf16 v[48:51], a[208:211], v[212:215], v[48:51]
    v_cvt_pk_bf16_f32 v252, v200, v201
    v_cvt_pk_bf16_f32 v253, v202, v203
    v_mfma_f32_16x16x32_bf16 v[48:51], a[176:179], v[208:211], v[48:51]
    v_exp_f32 v204, v204
    v_mfma_f32_16x16x32_bf16 v[52:55], a[180:183], v[208:211], v[52:55]
    v_exp_f32 v205, v205
    v_mfma_f32_16x16x32_bf16 v[52:55], a[212:215], v[212:215], v[52:55]
    v_exp_f32 v206, v206
    v_mfma_f32_16x16x32_bf16 v[56:59], a[216:219], v[212:215], v[56:59]
    v_exp_f32 v207, v207
    v_mfma_f32_16x16x32_bf16 v[56:59], a[184:187], v[208:211], v[56:59]
    v_cvt_pk_bf16_f32 v254, v204, v205
    v_cvt_pk_bf16_f32 v255, v206, v207
    v_mfma_f32_16x16x32_bf16 v[60:63], a[188:191], v[208:211], v[60:63]
    v_cvt_pk_bf16_f32 v2, v4, v5
    v_cvt_pk_bf16_f32 v3, v6, v7
    v_mfma_f32_16x16x32_bf16 v[60:63], a[220:223], v[212:215], v[60:63]
    s_mov_b32 m0, s27
    ds_write_b128 v250, v[0:3] offset:16896
    v_mfma_f32_16x16x32_bf16 v[192:195], a[96:99], a[48:51], v[228:231]
    buffer_load_dwordx4 v248, s[4:7], s28 offen nt lds
    v_mfma_f32_16x16x32_bf16 v[192:195], a[100:103], a[52:55], v[192:195]
    s_add_u32 m0, s27, 32
    v_cvt_pk_bf16_f32 v8, v8, v9
    v_cvt_pk_bf16_f32 v9, v10, v11
    v_accvgpr_read_b32 v220, a232
    v_rcp_f32 v222, v220
    v_cmp_ngt_f32 vcc, s22, v220
    v_pk_mul_f32 v[32:33], v[32:33], v[222:223] op_sel_hi:[1,0]
    v_pk_mul_f32 v[34:35], v[34:35], v[222:223] op_sel_hi:[1,0]
    v_pk_mul_f32 v[36:37], v[36:37], v[222:223] op_sel_hi:[1,0]
    v_pk_mul_f32 v[38:39], v[38:39], v[222:223] op_sel_hi:[1,0]
    v_pk_mul_f32 v[40:41], v[40:41], v[222:223] op_sel_hi:[1,0]
    v_pk_mul_f32 v[42:43], v[42:43], v[222:223] op_sel_hi:[1,0]
    v_pk_mul_f32 v[44:45], v[44:45], v[222:223] op_sel_hi:[1,0]
    v_pk_mul_f32 v[46:47], v[46:47], v[222:223] op_sel_hi:[1,0]
    v_pk_mul_f32 v[48:49], v[48:49], v[222:223] op_sel_hi:[1,0]
    v_pk_mul_f32 v[50:51], v[50:51], v[222:223] op_sel_hi:[1,0]
    v_pk_mul_f32 v[52:53], v[52:53], v[222:223] op_sel_hi:[1,0]
    v_pk_mul_f32 v[54:55], v[54:55], v[222:223] op_sel_hi:[1,0]
    v_pk_mul_f32 v[56:57], v[56:57], v[222:223] op_sel_hi:[1,0]
    v_pk_mul_f32 v[58:59], v[58:59], v[222:223] op_sel_hi:[1,0]
    v_pk_mul_f32 v[60:61], v[60:61], v[222:223] op_sel_hi:[1,0]
    v_pk_mul_f32 v[62:63], v[62:63], v[222:223] op_sel_hi:[1,0]
    v_mfma_f32_16x16x32_bf16 v[192:195], a[104:107], a[56:59], v[192:195]
    s_or_b64 s[76:77], s[76:77], vcc
    buffer_load_dwordx4 v248, s[4:7], s28 offen offset:1024 nt lds
    v_mfma_f32_16x16x32_bf16 v[192:195], a[108:111], a[60:63], v[192:195]
    s_add_u32 m0, s27, 64
    v_cvt_pk_bf16_f32 v10, v12, v13
    v_cvt_pk_bf16_f32 v11, v14, v15
    v_mfma_f32_16x16x32_bf16 v[196:199], a[124:127], a[60:63], v[228:231]
    ds_write_b128 v250, v[8:11] offset:16960
    v_mfma_f32_16x16x32_bf16 v[196:199], a[120:123], a[56:59], v[196:199]
    buffer_load_dwordx4 v248, s[4:7], s28 offen offset:2048 nt lds
    v_mfma_f32_16x16x32_bf16 v[196:199], a[116:119], a[52:55], v[196:199]
    s_add_u32 m0, s27, 96
    v_exp_f32 v192, v192
    v_mfma_f32_16x16x32_bf16 v[196:199], a[112:115], a[48:51], v[196:199]
    buffer_load_dwordx4 v248, s[4:7], s28 offen offset:3072 nt lds
    v_mfma_f32_16x16x32_bf16 v[200:203], a[128:131], a[48:51], v[228:231]
    s_add_u32 s28, s28, 77824
    v_exp_f32 v193, v193
    v_mfma_f32_16x16x32_bf16 v[200:203], a[132:135], a[52:55], v[200:203]
    v_exp_f32 v194, v194
    v_mfma_f32_16x16x32_bf16 v[200:203], a[136:139], a[56:59], v[200:203]
    v_exp_f32 v195, v195
    v_mfma_f32_16x16x32_bf16 v[200:203], a[140:143], a[60:63], v[200:203]
    v_cvt_pk_bf16_f32 v208, v192, v193
    v_cvt_pk_bf16_f32 v209, v194, v195
    v_mfma_f32_16x16x32_bf16 v[204:207], a[156:159], a[60:63], v[228:231]
    v_exp_f32 v196, v196
    v_mfma_f32_16x16x32_bf16 v[204:207], a[152:155], a[56:59], v[204:207]
    v_exp_f32 v197, v197
    v_mfma_f32_16x16x32_bf16 v[204:207], a[148:151], a[52:55], v[204:207]
    v_exp_f32 v198, v198
    v_mfma_f32_16x16x32_bf16 v[204:207], a[144:147], a[48:51], v[204:207]
    v_exp_f32 v199, v199
    v_mfma_f32_16x16x32_bf16 a[236:239], a[224:227], v[240:243], a[236:239]
    v_cvt_pk_bf16_f32 v210, v196, v197
    v_cvt_pk_bf16_f32 v211, v198, v199
    v_mfma_f32_16x16x32_bf16 a[236:239], a[224:227], v[252:255], a[236:239]
    v_exp_f32 v200, v200
    v_mfma_f32_16x16x32_bf16 v[64:67], a[192:195], v[252:255], v[64:67]
    v_exp_f32 v201, v201
    v_mfma_f32_16x16x32_bf16 v[64:67], a[160:163], v[240:243], v[64:67]
    v_exp_f32 v202, v202
    v_mfma_f32_16x16x32_bf16 v[68:71], a[164:167], v[240:243], v[68:71]
    v_exp_f32 v203, v203
    v_mfma_f32_16x16x32_bf16 v[68:71], a[196:199], v[252:255], v[68:71]
    v_cvt_pk_bf16_f32 v212, v200, v201
    v_cvt_pk_bf16_f32 v213, v202, v203
    v_mfma_f32_16x16x32_bf16 v[72:75], a[200:203], v[252:255], v[72:75]
    v_exp_f32 v204, v204
    v_mfma_f32_16x16x32_bf16 v[72:75], a[168:171], v[240:243], v[72:75]
    v_exp_f32 v205, v205
    v_mfma_f32_16x16x32_bf16 v[76:79], a[172:175], v[240:243], v[76:79]
    v_exp_f32 v206, v206
    v_mfma_f32_16x16x32_bf16 v[76:79], a[204:207], v[252:255], v[76:79]
    v_exp_f32 v207, v207
    v_mfma_f32_16x16x32_bf16 v[80:83], a[208:211], v[252:255], v[80:83]
    v_cvt_pk_bf16_f32 v214, v204, v205
    v_cvt_pk_bf16_f32 v215, v206, v207
    v_mfma_f32_16x16x32_bf16 v[80:83], a[176:179], v[240:243], v[80:83]
    v_cvt_pk_bf16_f32 v16, v16, v17
    v_cvt_pk_bf16_f32 v17, v18, v19
    v_mfma_f32_16x16x32_bf16 v[84:87], a[180:183], v[240:243], v[84:87]
    v_cvt_pk_bf16_f32 v18, v20, v21
    v_cvt_pk_bf16_f32 v19, v22, v23
    v_mfma_f32_16x16x32_bf16 v[84:87], a[212:215], v[252:255], v[84:87]
    ds_write_b128 v250, v[16:19] offset:17024
    v_mfma_f32_16x16x32_bf16 v[88:91], a[216:219], v[252:255], v[88:91]
    v_cvt_pk_bf16_f32 v24, v24, v25
    v_cvt_pk_bf16_f32 v25, v26, v27
    v_mfma_f32_16x16x32_bf16 v[88:91], a[184:187], v[240:243], v[88:91]
    v_cvt_pk_bf16_f32 v26, v28, v29
    v_cvt_pk_bf16_f32 v27, v30, v31
    v_mfma_f32_16x16x32_bf16 v[92:95], a[188:191], v[240:243], v[92:95]
    v_cvt_pk_bf16_f32 v32, v32, v33
    v_cvt_pk_bf16_f32 v33, v34, v35
    v_mfma_f32_16x16x32_bf16 v[92:95], a[220:223], v[252:255], v[92:95]
    ds_write_b128 v250, v[24:27] offset:17088
    v_mfma_f32_16x16x32_bf16 v[192:195], a[96:99], a[64:67], v[232:235]
    v_cvt_pk_bf16_f32 v34, v36, v37
    v_cvt_pk_bf16_f32 v35, v38, v39
    v_mfma_f32_16x16x32_bf16 v[192:195], a[100:103], a[68:71], v[192:195]
    v_cvt_pk_bf16_f32 v40, v40, v41
    v_cvt_pk_bf16_f32 v41, v42, v43
    v_mfma_f32_16x16x32_bf16 v[192:195], a[104:107], a[72:75], v[192:195]
    s_add_u32 m0, s27, 16896
    v_cvt_pk_bf16_f32 v42, v44, v45
    v_cvt_pk_bf16_f32 v43, v46, v47
    v_accvgpr_read_b32 v224, a236
    v_rcp_f32 v226, v224
    v_cmp_ngt_f32 vcc, s22, v224
    v_pk_mul_f32 v[64:65], v[64:65], v[226:227] op_sel_hi:[1,0]
    v_pk_mul_f32 v[66:67], v[66:67], v[226:227] op_sel_hi:[1,0]
    v_pk_mul_f32 v[68:69], v[68:69], v[226:227] op_sel_hi:[1,0]
    v_pk_mul_f32 v[70:71], v[70:71], v[226:227] op_sel_hi:[1,0]
    v_pk_mul_f32 v[72:73], v[72:73], v[226:227] op_sel_hi:[1,0]
    v_pk_mul_f32 v[74:75], v[74:75], v[226:227] op_sel_hi:[1,0]
    v_pk_mul_f32 v[76:77], v[76:77], v[226:227] op_sel_hi:[1,0]
    v_pk_mul_f32 v[78:79], v[78:79], v[226:227] op_sel_hi:[1,0]
    v_pk_mul_f32 v[80:81], v[80:81], v[226:227] op_sel_hi:[1,0]
    v_pk_mul_f32 v[82:83], v[82:83], v[226:227] op_sel_hi:[1,0]
    v_pk_mul_f32 v[84:85], v[84:85], v[226:227] op_sel_hi:[1,0]
    v_pk_mul_f32 v[86:87], v[86:87], v[226:227] op_sel_hi:[1,0]
    v_pk_mul_f32 v[88:89], v[88:89], v[226:227] op_sel_hi:[1,0]
    v_pk_mul_f32 v[90:91], v[90:91], v[226:227] op_sel_hi:[1,0]
    v_pk_mul_f32 v[92:93], v[92:93], v[226:227] op_sel_hi:[1,0]
    v_pk_mul_f32 v[94:95], v[94:95], v[226:227] op_sel_hi:[1,0]
    v_mfma_f32_16x16x32_bf16 v[192:195], a[108:111], a[76:79], v[192:195]
    s_or_b64 s[76:77], s[76:77], vcc
    ds_write_b128 v250, v[32:35] offset:33792
    v_mfma_f32_16x16x32_bf16 v[196:199], a[124:127], a[76:79], v[232:235]
    buffer_load_dwordx4 v248, s[8:11], s24 offen nt lds
    v_mfma_f32_16x16x32_bf16 v[196:199], a[120:123], a[72:75], v[196:199]
    s_add_u32 m0, s27, 16928
    v_cvt_pk_bf16_f32 v48, v48, v49
    v_cvt_pk_bf16_f32 v49, v50, v51
    v_mfma_f32_16x16x32_bf16 v[196:199], a[116:119], a[68:71], v[196:199]
    buffer_load_dwordx4 v248, s[8:11], s24 offen offset:1024 nt lds
    v_mfma_f32_16x16x32_bf16 v[196:199], a[112:115], a[64:67], v[196:199]
    s_add_u32 m0, s27, 16960
    ds_write_b128 v250, v[40:43] offset:33856
    v_mfma_f32_16x16x32_bf16 v[200:203], a[128:131], a[64:67], v[232:235]
    buffer_load_dwordx4 v248, s[8:11], s24 offen offset:2048 nt lds
    v_mfma_f32_16x16x32_bf16 v[200:203], a[132:135], a[68:71], v[200:203]
    s_add_u32 m0, s27, 16992
    v_exp_f32 v192, v192
    v_mfma_f32_16x16x32_bf16 v[200:203], a[136:139], a[72:75], v[200:203]
    ds_read_b128 v[216:219], v251 offset:16896
    v_cvt_pk_bf16_f32 v50, v52, v53
    v_mfma_f32_16x16x32_bf16 v[200:203], a[140:143], a[76:79], v[200:203]
    ds_read_b128 a[252:255], v251 offset:17952
    v_cvt_pk_bf16_f32 v51, v54, v55
    v_mfma_f32_16x16x32_bf16 v[204:207], a[156:159], a[76:79], v[232:235]
    ds_write_b128 v250, v[48:51] offset:33920
    v_mfma_f32_16x16x32_bf16 v[204:207], a[152:155], a[72:75], v[204:207]
    buffer_load_dwordx4 v248, s[8:11], s24 offen offset:3072 nt lds
    v_mfma_f32_16x16x32_bf16 v[204:207], a[148:151], a[68:71], v[204:207]
    s_add_u32 s24, s24, 8192
    v_exp_f32 v193, v193
    v_mfma_f32_16x16x32_bf16 v[204:207], a[144:147], a[64:67], v[204:207]
    v_exp_f32 v194, v194
    v_mfma_f32_16x16x32_bf16 a[240:243], a[224:227], v[208:211], a[240:243]
    s_waitcnt vmcnt(12)
    ds_read_b128 a[48:51], v249 offset:16896
    v_cvt_pk_bf16_f32 v240, v192, v193
    v_mfma_f32_16x16x32_bf16 a[240:243], a[224:227], v[212:215], a[240:243]
    v_exp_f32 v195, v195
    v_mfma_f32_16x16x32_bf16 v[96:99], a[192:195], v[212:215], v[96:99]
    ds_read_b128 a[52:55], v249 offset:16960
    v_cvt_pk_bf16_f32 v241, v194, v195
    v_mfma_f32_16x16x32_bf16 v[96:99], a[160:163], v[208:211], v[96:99]
    s_waitcnt lgkmcnt(3)
    buffer_store_dwordx4 v[216:219], v248, s[16:19], s25 offen sc1
    v_exp_f32 v196, v196
    v_exp_f32 v197, v197
    v_mfma_f32_16x16x32_bf16 v[100:103], a[164:167], v[208:211], v[100:103]
    ds_read_b128 a[56:59], v249 offset:17024
    v_cvt_pk_bf16_f32 v242, v196, v197
    v_mfma_f32_16x16x32_bf16 v[100:103], a[196:199], v[212:215], v[100:103]
    v_exp_f32 v198, v198
    v_mfma_f32_16x16x32_bf16 v[104:107], a[200:203], v[212:215], v[104:107]
    buffer_store_dwordx4 a[252:255], v248, s[16:19], s25 offen offset:1024 sc1
    v_exp_f32 v199, v199
    v_exp_f32 v200, v200
    v_mfma_f32_16x16x32_bf16 v[104:107], a[168:171], v[208:211], v[104:107]
    s_add_u32 s25, s25, 2048
    ds_read_b128 a[60:63], v249 offset:17088
    v_cvt_pk_bf16_f32 v243, v198, v199
    v_mfma_f32_16x16x32_bf16 v[108:111], a[172:175], v[208:211], v[108:111]
    v_exp_f32 v201, v201
    v_mfma_f32_16x16x32_bf16 v[108:111], a[204:207], v[212:215], v[108:111]
    v_exp_f32 v202, v202
    v_mfma_f32_16x16x32_bf16 v[112:115], a[208:211], v[212:215], v[112:115]
    v_exp_f32 v203, v203
    v_mfma_f32_16x16x32_bf16 v[112:115], a[176:179], v[208:211], v[112:115]
    v_cvt_pk_bf16_f32 v252, v200, v201
    v_cvt_pk_bf16_f32 v253, v202, v203
    v_mfma_f32_16x16x32_bf16 v[116:119], a[180:183], v[208:211], v[116:119]
    v_exp_f32 v204, v204
    v_mfma_f32_16x16x32_bf16 v[116:119], a[212:215], v[212:215], v[116:119]
    v_exp_f32 v205, v205
    v_mfma_f32_16x16x32_bf16 v[120:123], a[216:219], v[212:215], v[120:123]
    v_exp_f32 v206, v206
    v_mfma_f32_16x16x32_bf16 v[120:123], a[184:187], v[208:211], v[120:123]
    v_exp_f32 v207, v207
    v_mfma_f32_16x16x32_bf16 v[124:127], a[188:191], v[208:211], v[124:127]
    v_cvt_pk_bf16_f32 v254, v204, v205
    v_cvt_pk_bf16_f32 v255, v206, v207
    v_mfma_f32_16x16x32_bf16 v[124:127], a[220:223], v[212:215], v[124:127]
    v_cvt_pk_bf16_f32 v56, v56, v57
    v_cvt_pk_bf16_f32 v57, v58, v59
    v_mfma_f32_16x16x32_bf16 v[192:195], a[96:99], a[80:83], v[236:239]
    v_cvt_pk_bf16_f32 v58, v60, v61
    v_cvt_pk_bf16_f32 v59, v62, v63
    v_mfma_f32_16x16x32_bf16 v[192:195], a[100:103], a[84:87], v[192:195]
    ds_write_b128 v250, v[56:59] offset:33984
    v_add_u32 v250, 33792, v250
    v_accvgpr_read_b32 v228, a240
    v_rcp_f32 v230, v228
    v_cmp_ngt_f32 vcc, s22, v228
    v_pk_mul_f32 v[96:97], v[96:97], v[230:231] op_sel_hi:[1,0]
    v_pk_mul_f32 v[98:99], v[98:99], v[230:231] op_sel_hi:[1,0]
    v_pk_mul_f32 v[100:101], v[100:101], v[230:231] op_sel_hi:[1,0]
    v_pk_mul_f32 v[102:103], v[102:103], v[230:231] op_sel_hi:[1,0]
    v_pk_mul_f32 v[104:105], v[104:105], v[230:231] op_sel_hi:[1,0]
    v_pk_mul_f32 v[106:107], v[106:107], v[230:231] op_sel_hi:[1,0]
    v_pk_mul_f32 v[108:109], v[108:109], v[230:231] op_sel_hi:[1,0]
    v_pk_mul_f32 v[110:111], v[110:111], v[230:231] op_sel_hi:[1,0]
    v_pk_mul_f32 v[112:113], v[112:113], v[230:231] op_sel_hi:[1,0]
    v_pk_mul_f32 v[114:115], v[114:115], v[230:231] op_sel_hi:[1,0]
    v_pk_mul_f32 v[116:117], v[116:117], v[230:231] op_sel_hi:[1,0]
    v_pk_mul_f32 v[118:119], v[118:119], v[230:231] op_sel_hi:[1,0]
    v_pk_mul_f32 v[120:121], v[120:121], v[230:231] op_sel_hi:[1,0]
    v_pk_mul_f32 v[122:123], v[122:123], v[230:231] op_sel_hi:[1,0]
    v_pk_mul_f32 v[124:125], v[124:125], v[230:231] op_sel_hi:[1,0]
    v_pk_mul_f32 v[126:127], v[126:127], v[230:231] op_sel_hi:[1,0]
    v_mfma_f32_16x16x32_bf16 v[192:195], a[104:107], a[88:91], v[192:195]
    s_or_b64 s[76:77], s[76:77], vcc
    v_cvt_pk_bf16_f32 v64, v64, v65
    v_cvt_pk_bf16_f32 v65, v66, v67
    v_mfma_f32_16x16x32_bf16 v[192:195], a[108:111], a[92:95], v[192:195]
    v_cvt_pk_bf16_f32 v66, v68, v69
    v_cvt_pk_bf16_f32 v67, v70, v71
    v_mfma_f32_16x16x32_bf16 v[196:199], a[124:127], a[92:95], v[236:239]
    v_cvt_pk_bf16_f32 v72, v72, v73
    v_cvt_pk_bf16_f32 v73, v74, v75
    v_mfma_f32_16x16x32_bf16 v[196:199], a[120:123], a[88:91], v[196:199]
    ds_write_b128 v250, v[64:67] offset:50688
    v_mfma_f32_16x16x32_bf16 v[196:199], a[116:119], a[84:87], v[196:199]
    v_exp_f32 v192, v192
    v_mfma_f32_16x16x32_bf16 v[196:199], a[112:115], a[80:83], v[196:199]
    v_exp_f32 v193, v193
    v_mfma_f32_16x16x32_bf16 v[200:203], a[128:131], a[80:83], v[236:239]
    s_waitcnt vmcnt(18)
    ds_read_b128 v[216:219], v251 offset:19008
    v_cvt_pk_bf16_f32 v208, v192, v193
    v_mfma_f32_16x16x32_bf16 v[200:203], a[132:135], a[84:87], v[200:203]
    s_barrier
    ds_read_b128 a[252:255], v251 offset:20064
    v_mfma_f32_16x16x32_bf16 v[200:203], a[136:139], a[88:91], v[200:203]
    ds_read_b128 a[96:99], v246 offset:33792
    v_cvt_pk_bf16_f32 v74, v76, v77
    v_mfma_f32_16x16x32_bf16 v[200:203], a[140:143], a[92:95], v[200:203]
    ds_read_b128 a[100:103], v246 offset:33856
    v_cvt_pk_bf16_f32 v75, v78, v79
    v_mfma_f32_16x16x32_bf16 v[204:207], a[156:159], a[92:95], v[236:239]
    ds_write_b128 v250, v[72:75] offset:50752
    v_mfma_f32_16x16x32_bf16 v[204:207], a[152:155], a[88:91], v[204:207]
    v_exp_f32 v194, v194
    v_mfma_f32_16x16x32_bf16 v[204:207], a[148:151], a[84:87], v[204:207]
    v_exp_f32 v195, v195
    v_mfma_f32_16x16x32_bf16 v[204:207], a[144:147], a[80:83], v[204:207]
    ds_read_b128 a[104:107], v246 offset:33920
    ds_read_b128 a[108:111], v246 offset:33984
    v_mfma_f32_16x16x32_bf16 a[244:247], a[224:227], v[240:243], a[244:247]
    v_cvt_pk_bf16_f32 v209, v194, v195
    v_cvt_pk_bf16_f32 v80, v80, v81
    v_mfma_f32_16x16x32_bf16 a[244:247], a[224:227], v[252:255], a[244:247]
    s_waitcnt lgkmcnt(5)
    buffer_store_dwordx4 a[252:255], v248, s[16:19], s25 offen offset:1024 sc1
    ds_read_b128 a[124:127], v246 offset:34496
    v_exp_f32 v196, v196
    v_cvt_pk_bf16_f32 v81, v82, v83
    v_mfma_f32_16x16x32_bf16 v[128:131], a[192:195], v[252:255], v[128:131]
    ds_read_b128 a[128:131], v246 offset:50688
    v_cvt_pk_bf16_f32 v82, v84, v85
    v_mfma_f32_16x16x32_bf16 v[128:131], a[160:163], v[240:243], v[128:131]
    ds_read_b128 a[120:123], v246 offset:34432
    v_cvt_pk_bf16_f32 v83, v86, v87
    v_mfma_f32_16x16x32_bf16 v[132:135], a[164:167], v[240:243], v[132:135]
    buffer_store_dwordx4 v[216:219], v248, s[16:19], s25 offen sc1
    ds_read_b128 a[132:135], v246 offset:50752
    v_exp_f32 v197, v197
    v_cvt_pk_bf16_f32 v88, v88, v89
    v_mfma_f32_16x16x32_bf16 v[132:135], a[196:199], v[252:255], v[132:135]
    s_add_u32 s25, s25, 2048
    ds_write_b128 v250, v[80:83] offset:50816
    v_mfma_f32_16x16x32_bf16 v[136:139], a[200:203], v[252:255], v[136:139]
    s_waitcnt vmcnt(12)
    v_exp_f32 v198, v198
    v_mfma_f32_16x16x32_bf16 v[136:139], a[168:171], v[240:243], v[136:139]
    v_exp_f32 v199, v199
    v_mfma_f32_16x16x32_bf16 v[140:143], a[172:175], v[240:243], v[140:143]
    ds_read_b128 a[116:119], v246 offset:34368
    ds_read_b128 a[136:139], v246 offset:50816
    v_mfma_f32_16x16x32_bf16 v[140:143], a[204:207], v[252:255], v[140:143]
    v_cvt_pk_bf16_f32 v210, v196, v197
    v_cvt_pk_bf16_f32 v211, v198, v199
    v_mfma_f32_16x16x32_bf16 v[144:147], a[208:211], v[252:255], v[144:147]
    ds_read_b128 a[112:115], v246 offset:34304
    ds_read_b128 a[140:143], v246 offset:50880
    v_mfma_f32_16x16x32_bf16 v[144:147], a[176:179], v[240:243], v[144:147]
Lhop5:
    s_cbranch_execz Lret1
    v_exp_f32 v200, v200
    v_mfma_f32_16x16x32_bf16 v[148:151], a[180:183], v[240:243], v[148:151]
    ds_read_b128 a[156:159], v246 offset:51392
    ds_read_b128 a[64:67], v249 offset:33792
    v_mfma_f32_16x16x32_bf16 v[148:151], a[212:215], v[252:255], v[148:151]
    v_exp_f32 v201, v201
    v_mfma_f32_16x16x32_bf16 v[152:155], a[216:219], v[252:255], v[152:155]
    ds_read_b128 a[152:155], v246 offset:51328
    ds_read_b128 a[68:71], v249 offset:33856
    v_mfma_f32_16x16x32_bf16 v[152:155], a[184:187], v[240:243], v[152:155]
    s_waitcnt lgkmcnt(15)
    v_exp_f32 v202, v202
    v_mfma_f32_16x16x32_bf16 v[156:159], a[188:191], v[240:243], v[156:159]
    ds_read_b128 a[148:151], v246 offset:51264
    ds_read_b128 a[72:75], v249 offset:33920
    v_mfma_f32_16x16x32_bf16 v[156:159], a[220:223], v[252:255], v[156:159]
    s_waitcnt lgkmcnt(7)
    v_exp_f32 v203, v203
    v_mfma_f32_16x16x32_bf16 v[192:195], a[96:99], a[0:3], 0
    ds_read_b128 a[144:147], v246 offset:51200
    ds_read_b128 a[76:79], v249 offset:33984
    v_subrev_u32 v249, 84480, v249
    v_mfma_f32_16x16x32_bf16 v[192:195], a[100:103], a[4:7], v[192:195]
    v_cvt_pk_bf16_f32 v212, v200, v201
    v_cvt_pk_bf16_f32 v213, v202, v203
    v_accvgpr_read_b32 v239, a244
    v_rcp_f32 v238, v239
    v_cmp_ngt_f32 vcc, s22, v239
    v_pk_mul_f32 v[128:129], v[128:129], v[238:239] op_sel_hi:[1,0]
    v_pk_mul_f32 v[130:131], v[130:131], v[238:239] op_sel_hi:[1,0]
    v_pk_mul_f32 v[132:133], v[132:133], v[238:239] op_sel_hi:[1,0]
    v_pk_mul_f32 v[134:135], v[134:135], v[238:239] op_sel_hi:[1,0]
    v_pk_mul_f32 v[136:137], v[136:137], v[238:239] op_sel_hi:[1,0]
    v_pk_mul_f32 v[138:139], v[138:139], v[238:239] op_sel_hi:[1,0]
    v_pk_mul_f32 v[140:141], v[140:141], v[238:239] op_sel_hi:[1,0]
    v_pk_mul_f32 v[142:143], v[142:143], v[238:239] op_sel_hi:[1,0]
    v_pk_mul_f32 v[144:145], v[144:145], v[238:239] op_sel_hi:[1,0]
    v_pk_mul_f32 v[146:147], v[146:147], v[238:239] op_sel_hi:[1,0]
    v_pk_mul_f32 v[148:149], v[148:149], v[238:239] op_sel_hi:[1,0]
    v_pk_mul_f32 v[150:151], v[150:151], v[238:239] op_sel_hi:[1,0]
    v_pk_mul_f32 v[152:153], v[152:153], v[238:239] op_sel_hi:[1,0]
    v_pk_mul_f32 v[154:155], v[154:155], v[238:239] op_sel_hi:[1,0]
    v_pk_mul_f32 v[156:157], v[156:157], v[238:239] op_sel_hi:[1,0]
    v_pk_mul_f32 v[158:159], v[158:159], v[238:239] op_sel_hi:[1,0]
    v_cvt_pk_bf16_f32 v128, v128, v129
    v_cvt_pk_bf16_f32 v129, v130, v131
    v_cvt_pk_bf16_f32 v130, v132, v133
    v_cvt_pk_bf16_f32 v131, v134, v135
    v_cvt_pk_bf16_f32 v136, v136, v137
    v_cvt_pk_bf16_f32 v137, v138, v139
    v_cvt_pk_bf16_f32 v138, v140, v141
    v_cvt_pk_bf16_f32 v139, v142, v143
    v_cvt_pk_bf16_f32 v144, v144, v145
    v_cvt_pk_bf16_f32 v145, v146, v147
    v_cvt_pk_bf16_f32 v146, v148, v149
    v_cvt_pk_bf16_f32 v147, v150, v151
    v_cvt_pk_bf16_f32 v152, v152, v153
    v_cvt_pk_bf16_f32 v153, v154, v155
    v_cvt_pk_bf16_f32 v154, v156, v157
    v_cvt_pk_bf16_f32 v155, v158, v159
    v_mfma_f32_16x16x32_bf16 v[192:195], a[104:107], a[8:11], v[192:195]
    s_or_b64 s[76:77], s[76:77], vcc
    ds_write_b128 v250, v[128:131] offset:33792
    v_mfma_f32_16x16x32_bf16 v[192:195], a[108:111], a[12:15], v[192:195]
    v_exp_f32 v204, v204
    v_mfma_f32_16x16x32_bf16 v[196:199], a[124:127], a[12:15], 0
    v_exp_f32 v205, v205
    v_mfma_f32_16x16x32_bf16 v[196:199], a[120:123], a[8:11], v[196:199]
    s_waitcnt lgkmcnt(2)
    v_exp_f32 v206, v206
    v_mfma_f32_16x16x32_bf16 v[196:199], a[116:119], a[4:7], v[196:199]
    ds_write_b128 v250, v[136:139] offset:33856
    v_max3_f32 v244, v192, v193, v194
    v_mfma_f32_16x16x32_bf16 v[196:199], a[112:115], a[0:3], v[196:199]
    v_exp_f32 v207, v207
    v_mfma_f32_16x16x32_bf16 v[200:203], a[128:131], a[0:3], 0
    v_cvt_pk_bf16_f32 v214, v204, v205
    v_cvt_pk_bf16_f32 v215, v206, v207
    v_mfma_f32_16x16x32_bf16 v[200:203], a[132:135], a[4:7], v[200:203]
    v_cvt_pk_bf16_f32 v89, v90, v91
    v_cvt_pk_bf16_f32 v90, v92, v93
    v_mfma_f32_16x16x32_bf16 v[200:203], a[136:139], a[8:11], v[200:203]
    ds_write_b128 v250, v[144:147] offset:33920
    v_max3_f32 v244, v244, v195, v196
    v_max3_f32 v244, v244, v197, v198
    v_max_f32 v245, v244, v199
    v_max_f32 v244, v244, v199
    v_mfma_f32_16x16x32_bf16 v[200:203], a[140:143], a[12:15], v[200:203]
    v_cvt_pk_bf16_f32 v91, v94, v95
    v_permlane16_swap_b32 v244, v245
    v_max_f32 v244, v244, v245
    v_mov_b32 v245, v244
    v_mfma_f32_16x16x32_bf16 v[204:207], a[156:159], a[12:15], 0
    v_cvt_pk_bf16_f32 v96, v96, v97
    v_permlane32_swap_b32 v244, v245
    v_max_f32 v244, v244, v245
    v_mul_f32 v232, s35, v244
    v_mfma_f32_16x16x32_bf16 v[204:207], a[152:155], a[8:11], v[204:207]
    v_fma_f32 v192, v192, s21, v232
    v_fma_f32 v193, v193, s21, v232
    v_mfma_f32_16x16x32_bf16 v[204:207], a[148:151], a[4:7], v[204:207]
    ds_write_b128 v250, v[88:91] offset:50880
    v_mfma_f32_16x16x32_bf16 v[204:207], a[144:147], a[0:3], v[204:207]
    v_fma_f32 v194, v194, s21, v232
    v_fma_f32 v195, v195, s21, v232
    v_mfma_f32_16x16x32_bf16 a[248:251], a[224:227], v[208:211], a[248:251]
    v_exp_f32 v192, v192
    v_mfma_f32_16x16x32_bf16 a[248:251], a[224:227], v[212:215], a[248:251]
    v_exp_f32 v193, v193
    v_mfma_f32_16x16x32_bf16 v[160:163], a[192:195], v[212:215], v[160:163]
    ds_write_b128 v250, v[152:155] offset:33984
    v_mfma_f32_16x16x32_bf16 v[160:163], a[160:163], v[208:211], v[160:163]
    s_add_u32 m0, s27, 67584
    v_exp_f32 v194, v194
    v_mfma_f32_16x16x32_bf16 v[164:167], a[164:167], v[208:211], v[164:167]
    buffer_load_dwordx4 v248, s[8:11], s24 offen nt lds
    v_mfma_f32_16x16x32_bf16 v[164:167], a[196:199], v[212:215], v[164:167]
    s_add_u32 m0, s27, 67616
    ds_read_b64_tr_b16 a[160:161], v247 offset:42240
    ds_read_b64_tr_b16 a[162:163], v247 offset:42752
    v_mfma_f32_16x16x32_bf16 v[168:171], a[200:203], v[212:215], v[168:171]
    buffer_load_dwordx4 v248, s[8:11], s24 offen offset:1024 nt lds
    v_mfma_f32_16x16x32_bf16 v[168:171], a[168:171], v[208:211], v[168:171]
    s_add_u32 m0, s27, 67648
    ds_read_b64_tr_b16 a[192:193], v247 offset:59136
    ds_read_b64_tr_b16 a[194:195], v247 offset:59648
    v_mfma_f32_16x16x32_bf16 v[172:175], a[172:175], v[208:211], v[172:175]
    v_exp_f32 v195, v195
    v_mfma_f32_16x16x32_bf16 v[172:175], a[204:207], v[212:215], v[172:175]
    ds_read_b64_tr_b16 a[164:165], v247 offset:42248
    ds_read_b64_tr_b16 a[166:167], v247 offset:42760
    v_mfma_f32_16x16x32_bf16 v[176:179], a[208:211], v[212:215], v[176:179]
    v_cvt_pk_bf16_f32 v240, v192, v193
    v_cvt_pk_bf16_f32 v241, v194, v195
    v_mfma_f32_16x16x32_bf16 v[176:179], a[176:179], v[208:211], v[176:179]
    ds_read_b64_tr_b16 a[196:197], v247 offset:59144
    ds_read_b64_tr_b16 a[198:199], v247 offset:59656
    v_mfma_f32_16x16x32_bf16 v[180:183], a[180:183], v[208:211], v[180:183]
    buffer_load_dwordx4 v248, s[8:11], s24 offen offset:2048 nt lds
    v_mfma_f32_16x16x32_bf16 v[180:183], a[212:215], v[212:215], v[180:183]
    s_add_u32 m0, s27, 67680
    ds_read_b64_tr_b16 a[168:169], v247 offset:42304
    ds_read_b64_tr_b16 a[170:171], v247 offset:42816
    v_mfma_f32_16x16x32_bf16 v[184:187], a[216:219], v[212:215], v[184:187]
    v_fma_f32 v196, v196, s21, v232
    v_fma_f32 v197, v197, s21, v232
    v_mfma_f32_16x16x32_bf16 v[184:187], a[184:187], v[208:211], v[184:187]
    s_waitcnt lgkmcnt(15)
    ds_read_b64_tr_b16 a[200:201], v247 offset:59200
    ds_read_b64_tr_b16 a[202:203], v247 offset:59712
    v_mfma_f32_16x16x32_bf16 v[188:191], a[188:191], v[208:211], v[188:191]
    v_fma_f32 v198, v198, s21, v232
    v_fma_f32 v199, v199, s21, v232
    v_mfma_f32_16x16x32_bf16 v[188:191], a[220:223], v[212:215], v[188:191]
    v_exp_f32 v196, v196
    v_mfma_f32_16x16x32_bf16 v[192:195], a[96:99], a[16:19], 0
    v_exp_f32 v197, v197
    v_mfma_f32_16x16x32_bf16 v[192:195], a[100:103], a[20:23], v[192:195]
    s_waitcnt vmcnt(11)
    ds_read_b128 a[80:83], v249 offset:0
    ds_read_b64_tr_b16 a[172:173], v247 offset:42312
    v_mfma_f32_16x16x32_bf16 v[192:195], a[104:107], a[24:27], v[192:195]
    v_exp_f32 v198, v198
    v_exp_f32 v199, v199
    v_accvgpr_read_b32 v239, a248
    v_rcp_f32 v238, v239
    v_cmp_ngt_f32 vcc, s22, v239
    v_pk_mul_f32 v[160:161], v[160:161], v[238:239] op_sel_hi:[1,0]
    v_pk_mul_f32 v[162:163], v[162:163], v[238:239] op_sel_hi:[1,0]
    v_pk_mul_f32 v[164:165], v[164:165], v[238:239] op_sel_hi:[1,0]
    v_pk_mul_f32 v[166:167], v[166:167], v[238:239] op_sel_hi:[1,0]
    v_pk_mul_f32 v[168:169], v[168:169], v[238:239] op_sel_hi:[1,0]
    v_pk_mul_f32 v[170:171], v[170:171], v[238:239] op_sel_hi:[1,0]
    v_pk_mul_f32 v[172:173], v[172:173], v[238:239] op_sel_hi:[1,0]
    v_pk_mul_f32 v[174:175], v[174:175], v[238:239] op_sel_hi:[1,0]
    v_pk_mul_f32 v[176:177], v[176:177], v[238:239] op_sel_hi:[1,0]
    v_pk_mul_f32 v[178:179], v[178:179], v[238:239] op_sel_hi:[1,0]
    v_pk_mul_f32 v[180:181], v[180:181], v[238:239] op_sel_hi:[1,0]
    v_pk_mul_f32 v[182:183], v[182:183], v[238:239] op_sel_hi:[1,0]
    v_pk_mul_f32 v[184:185], v[184:185], v[238:239] op_sel_hi:[1,0]
    v_pk_mul_f32 v[186:187], v[186:187], v[238:239] op_sel_hi:[1,0]
    v_pk_mul_f32 v[188:189], v[188:189], v[238:239] op_sel_hi:[1,0]
    v_pk_mul_f32 v[190:191], v[190:191], v[238:239] op_sel_hi:[1,0]
    v_cvt_pk_bf16_f32 v160, v160, v161
    v_cvt_pk_bf16_f32 v161, v162, v163
    v_cvt_pk_bf16_f32 v162, v164, v165
    v_cvt_pk_bf16_f32 v163, v166, v167
    v_cvt_pk_bf16_f32 v168, v168, v169
    v_cvt_pk_bf16_f32 v169, v170, v171
    v_cvt_pk_bf16_f32 v170, v172, v173
    v_cvt_pk_bf16_f32 v171, v174, v175
    v_cvt_pk_bf16_f32 v176, v176, v177
    v_cvt_pk_bf16_f32 v177, v178, v179
    v_cvt_pk_bf16_f32 v178, v180, v181
    v_cvt_pk_bf16_f32 v179, v182, v183
    v_cvt_pk_bf16_f32 v184, v184, v185
    v_cvt_pk_bf16_f32 v185, v186, v187
    v_cvt_pk_bf16_f32 v186, v188, v189
    v_cvt_pk_bf16_f32 v187, v190, v191
    v_mfma_f32_16x16x32_bf16 v[192:195], a[108:111], a[28:31], v[192:195]
    s_or_b64 s[76:77], s[76:77], vcc
    ds_read_b64_tr_b16 a[174:175], v247 offset:42824
    buffer_load_dwordx4 v248, s[8:11], s24 offen offset:3072 nt lds
    v_cvt_pk_bf16_f32 v242, v196, v197
    v_cvt_pk_bf16_f32 v243, v198, v199
    v_mfma_f32_16x16x32_bf16 v[196:199], a[124:127], a[28:31], 0
    s_add_u32 s24, s24, 8192
    ds_read_b64_tr_b16 a[204:205], v247 offset:59208
    v_max3_f32 v244, v192, v193, v194
    v_mfma_f32_16x16x32_bf16 v[196:199], a[120:123], a[24:27], v[196:199]
    ds_read_b64_tr_b16 a[206:207], v247 offset:59720
    v_fma_f32 v200, v200, s21, v232
    v_fma_f32 v201, v201, s21, v232
    v_fma_f32 v202, v202, s21, v232
    v_fma_f32 v203, v203, s21, v232
    v_mfma_f32_16x16x32_bf16 v[196:199], a[116:119], a[20:23], v[196:199]
    ds_read_b64_tr_b16 a[176:177], v247 offset:42368
    v_exp_f32 v200, v200
    v_exp_f32 v201, v201
    v_exp_f32 v202, v202
    v_exp_f32 v203, v203
    v_mfma_f32_16x16x32_bf16 v[196:199], a[112:115], a[16:19], v[196:199]
    ds_read_b64_tr_b16 a[178:179], v247 offset:42880
    v_cvt_pk_bf16_f32 v252, v200, v201
    v_cvt_pk_bf16_f32 v253, v202, v203
    v_mfma_f32_16x16x32_bf16 v[200:203], a[128:131], a[16:19], 0
    ds_read_b64_tr_b16 a[208:209], v247 offset:59264
    v_fma_f32 v204, v204, s21, v232
    v_mfma_f32_16x16x32_bf16 v[200:203], a[132:135], a[20:23], v[200:203]
    ds_read_b128 v[220:223], v251 offset:33792
    v_fma_f32 v205, v205, s21, v232
    v_fma_f32 v206, v206, s21, v232
    v_fma_f32 v207, v207, s21, v232
    v_max3_f32 v244, v244, v195, v196
    v_max3_f32 v244, v244, v197, v198
    v_max_f32 v245, v244, v199
    v_max_f32 v244, v244, v199
    v_mfma_f32_16x16x32_bf16 v[200:203], a[136:139], a[24:27], v[200:203]
    ds_read_b64_tr_b16 a[210:211], v247 offset:59776
    v_exp_f32 v204, v204
    v_exp_f32 v205, v205
    v_exp_f32 v206, v206
    v_exp_f32 v207, v207
    v_permlane16_swap_b32 v244, v245
    v_max_f32 v244, v244, v245
    v_mov_b32 v245, v244
    v_mfma_f32_16x16x32_bf16 v[200:203], a[140:143], a[28:31], v[200:203]
    ds_read_b64_tr_b16 a[180:181], v247 offset:42376
    v_cvt_pk_bf16_f32 v254, v204, v205
    v_cvt_pk_bf16_f32 v255, v206, v207
    v_permlane32_swap_b32 v244, v245
    v_max_f32 v244, v244, v245
    v_mul_f32 v233, s35, v244
    v_mfma_f32_16x16x32_bf16 v[204:207], a[156:159], a[28:31], 0
    ds_read_b64_tr_b16 a[182:183], v247 offset:42888
    v_fma_f32 v192, v192, s21, v233
    v_mfma_f32_16x16x32_bf16 v[204:207], a[152:155], a[24:27], v[204:207]
    ds_read_b64_tr_b16 a[212:213], v247 offset:59272
    v_fma_f32 v193, v193, s21, v233
    v_mfma_f32_16x16x32_bf16 v[204:207], a[148:151], a[20:23], v[204:207]
    ds_read_b64_tr_b16 a[214:215], v247 offset:59784
    v_fma_f32 v194, v194, s21, v233
    v_mfma_f32_16x16x32_bf16 v[204:207], a[144:147], a[16:19], v[204:207]
    s_waitcnt lgkmcnt(15)
    ds_read_b64_tr_b16 a[184:185], v247 offset:42432
    v_fma_f32 v195, v195, s21, v233
    v_mfma_f32_16x16x32_bf16 a[228:231], a[224:227], v[240:243], 0
    ds_read_b128 a[252:255], v251 offset:34848
    v_fma_f32 v196, v196, s21, v233
    v_mfma_f32_16x16x32_bf16 a[228:231], a[224:227], v[252:255], a[228:231]
    ds_read_b64_tr_b16 a[186:187], v247 offset:42944
    v_fma_f32 v197, v197, s21, v233
    v_mfma_f32_16x16x32_bf16 v[0:3], a[192:195], v[252:255], 0
    ds_read_b64_tr_b16 a[216:217], v247 offset:59328
    v_fma_f32 v198, v198, s21, v233
    v_mfma_f32_16x16x32_bf16 v[0:3], a[160:163], v[240:243], v[0:3]
    s_waitcnt lgkmcnt(13)
    ds_read_b64_tr_b16 a[218:219], v247 offset:59840
    v_fma_f32 v199, v199, s21, v233
    v_mfma_f32_16x16x32_bf16 v[4:7], a[164:167], v[240:243], 0
    ds_read_b64_tr_b16 a[188:189], v247 offset:42440
    v_fma_f32 v200, v200, s21, v233
    v_mfma_f32_16x16x32_bf16 v[4:7], a[196:199], v[252:255], v[4:7]
    ds_read_b64_tr_b16 a[190:191], v247 offset:42952
    v_fma_f32 v201, v201, s21, v233
    v_mfma_f32_16x16x32_bf16 v[8:11], a[200:203], v[252:255], 0
    s_waitcnt lgkmcnt(5)
    ds_read_b64_tr_b16 a[220:221], v247 offset:59336
    ds_read_b64_tr_b16 a[222:223], v247 offset:59848
    v_add_u32 v247, 16896, v247
    v_mfma_f32_16x16x32_bf16 v[8:11], a[168:171], v[240:243], v[8:11]
    s_waitcnt lgkmcnt(9)
    buffer_store_dwordx4 v[220:223], v248, s[16:19], s25 offen sc1
    v_exp_f32 v192, v192
    v_exp_f32 v193, v193
    v_mfma_f32_16x16x32_bf16 v[12:15], a[172:175], v[240:243], 0
    ds_read_b128 a[84:87], v249 offset:64
    v_cvt_pk_bf16_f32 v208, v192, v193
    v_mfma_f32_16x16x32_bf16 v[12:15], a[204:207], v[252:255], v[12:15]
    v_exp_f32 v194, v194
    v_mfma_f32_16x16x32_bf16 v[16:19], a[208:211], v[252:255], 0
    ds_read_b128 a[88:91], v249 offset:128
    v_fma_f32 v202, v202, s21, v233
    v_mfma_f32_16x16x32_bf16 v[16:19], a[176:179], v[240:243], v[16:19]
    buffer_store_dwordx4 a[252:255], v248, s[16:19], s25 offen offset:1024 sc1
    v_exp_f32 v195, v195
    v_exp_f32 v196, v196
    v_mfma_f32_16x16x32_bf16 v[20:23], a[180:183], v[240:243], 0
    s_waitcnt lgkmcnt(2)
    ds_read_b128 a[92:95], v249 offset:192
    v_cvt_pk_bf16_f32 v209, v194, v195
    v_mfma_f32_16x16x32_bf16 v[20:23], a[212:215], v[252:255], v[20:23]
    s_add_u32 s25, s25, 2048
    v_exp_f32 v197, v197
    v_mfma_f32_16x16x32_bf16 v[24:27], a[216:219], v[252:255], 0
    v_exp_f32 v198, v198
    v_mfma_f32_16x16x32_bf16 v[24:27], a[184:187], v[240:243], v[24:27]
    s_waitcnt lgkmcnt(15)
    v_exp_f32 v199, v199
    v_mfma_f32_16x16x32_bf16 v[28:31], a[188:191], v[240:243], 0
    v_cvt_pk_bf16_f32 v210, v196, v197
    v_cvt_pk_bf16_f32 v211, v198, v199
    v_mfma_f32_16x16x32_bf16 v[28:31], a[220:223], v[252:255], v[28:31]
    s_waitcnt lgkmcnt(3)
    v_fma_f32 v203, v203, s21, v233
    v_fma_f32 v204, v204, s21, v233
    v_mfma_f32_16x16x32_bf16 v[192:195], a[96:99], a[32:35], 0
    s_barrier
    v_mfma_f32_16x16x32_bf16 v[192:195], a[100:103], a[36:39], v[192:195]
    v_exp_f32 v200, v200
    v_mfma_f32_16x16x32_bf16 v[192:195], a[104:107], a[40:43], v[192:195]
    v_exp_f32 v201, v201
    v_mfma_f32_16x16x32_bf16 v[192:195], a[108:111], a[44:47], v[192:195]
    v_exp_f32 v202, v202
    v_mfma_f32_16x16x32_bf16 v[196:199], a[124:127], a[44:47], 0
    v_exp_f32 v203, v203
    v_mfma_f32_16x16x32_bf16 v[196:199], a[120:123], a[40:43], v[196:199]
    v_cvt_pk_bf16_f32 v212, v200, v201
    v_cvt_pk_bf16_f32 v213, v202, v203
    v_mfma_f32_16x16x32_bf16 v[196:199], a[116:119], a[36:39], v[196:199]
    v_fma_f32 v205, v205, s21, v233
    v_max3_f32 v244, v192, v193, v194
    v_mfma_f32_16x16x32_bf16 v[196:199], a[112:115], a[32:35], v[196:199]
    v_fma_f32 v206, v206, s21, v233
    v_fma_f32 v207, v207, s21, v233
    v_mfma_f32_16x16x32_bf16 v[200:203], a[128:131], a[32:35], 0
    ds_read_b128 v[216:219], v251 offset:35904
    v_cvt_pk_bf16_f32 v97, v98, v99
    v_mfma_f32_16x16x32_bf16 v[200:203], a[132:135], a[36:39], v[200:203]
    ds_read_b128 v[220:223], v251 offset:36960
    v_cvt_pk_bf16_f32 v98, v100, v101
    v_max3_f32 v244, v244, v195, v196
    v_max3_f32 v244, v244, v197, v198
    v_max_f32 v245, v244, v199
    v_max_f32 v244, v244, v199
    v_mfma_f32_16x16x32_bf16 v[200:203], a[136:139], a[40:43], v[200:203]
    v_exp_f32 v204, v204
    v_exp_f32 v205, v205
    v_exp_f32 v206, v206
    v_exp_f32 v207, v207
    v_permlane16_swap_b32 v244, v245
    v_max_f32 v244, v244, v245
    v_mov_b32 v245, v244
    v_mfma_f32_16x16x32_bf16 v[200:203], a[140:143], a[44:47], v[200:203]
    v_cvt_pk_bf16_f32 v214, v204, v205
    v_cvt_pk_bf16_f32 v215, v206, v207
    v_permlane32_swap_b32 v244, v245
    v_max_f32 v244, v244, v245
    v_mul_f32 v234, s35, v244
    v_mfma_f32_16x16x32_bf16 v[204:207], a[156:159], a[44:47], 0
    s_waitcnt lgkmcnt(0)
    buffer_store_dwordx4 v[216:219], v248, s[16:19], s25 offen sc1
    v_fma_f32 v192, v192, s21, v234
    v_fma_f32 v193, v193, s21, v234
    v_fma_f32 v194, v194, s21, v234
    v_fma_f32 v195, v195, s21, v234
    v_mfma_f32_16x16x32_bf16 v[204:207], a[152:155], a[40:43], v[204:207]
    v_exp_f32 v192, v192
    v_mfma_f32_16x16x32_bf16 v[204:207], a[148:151], a[36:39], v[204:207]
    v_exp_f32 v193, v193
    v_mfma_f32_16x16x32_bf16 v[204:207], a[144:147], a[32:35], v[204:207]
    buffer_store_dwordx4 v[220:223], v248, s[16:19], s25 offen offset:1024 sc1
    v_exp_f32 v194, v194
    v_exp_f32 v195, v195
    v_mfma_f32_16x16x32_bf16 a[232:235], a[224:227], v[208:211], 0
    s_add_u32 s25, s25, 2048
    v_cvt_pk_bf16_f32 v240, v192, v193
    v_cvt_pk_bf16_f32 v241, v194, v195
    v_mfma_f32_16x16x32_bf16 a[232:235], a[224:227], v[212:215], a[232:235]
    v_fma_f32 v196, v196, s21, v234
    v_fma_f32 v197, v197, s21, v234
    v_mfma_f32_16x16x32_bf16 v[32:35], a[192:195], v[212:215], 0
    v_fma_f32 v198, v198, s21, v234
    v_fma_f32 v199, v199, s21, v234
    v_mfma_f32_16x16x32_bf16 v[32:35], a[160:163], v[208:211], v[32:35]
    v_exp_f32 v196, v196
    v_mfma_f32_16x16x32_bf16 v[36:39], a[164:167], v[208:211], 0
    v_exp_f32 v197, v197
    v_mfma_f32_16x16x32_bf16 v[36:39], a[196:199], v[212:215], v[36:39]
    v_exp_f32 v198, v198
    v_mfma_f32_16x16x32_bf16 v[40:43], a[200:203], v[212:215], 0
    v_exp_f32 v199, v199
    v_mfma_f32_16x16x32_bf16 v[40:43], a[168:171], v[208:211], v[40:43]
    v_cvt_pk_bf16_f32 v242, v196, v197
    v_cvt_pk_bf16_f32 v243, v198, v199
    v_mfma_f32_16x16x32_bf16 v[44:47], a[172:175], v[208:211], 0
    v_fma_f32 v200, v200, s21, v234
    v_fma_f32 v201, v201, s21, v234
    v_mfma_f32_16x16x32_bf16 v[44:47], a[204:207], v[212:215], v[44:47]
    v_fma_f32 v202, v202, s21, v234
    v_fma_f32 v203, v203, s21, v234
    v_mfma_f32_16x16x32_bf16 v[48:51], a[208:211], v[212:215], 0
    v_exp_f32 v200, v200
    v_mfma_f32_16x16x32_bf16 v[48:51], a[176:179], v[208:211], v[48:51]
    v_exp_f32 v201, v201
    v_mfma_f32_16x16x32_bf16 v[52:55], a[180:183], v[208:211], 0
    v_exp_f32 v202, v202
    v_mfma_f32_16x16x32_bf16 v[52:55], a[212:215], v[212:215], v[52:55]
    v_exp_f32 v203, v203
    v_mfma_f32_16x16x32_bf16 v[56:59], a[216:219], v[212:215], 0
    v_cvt_pk_bf16_f32 v252, v200, v201
    v_cvt_pk_bf16_f32 v253, v202, v203
    v_mfma_f32_16x16x32_bf16 v[56:59], a[184:187], v[208:211], v[56:59]
    s_waitcnt lgkmcnt(15)
    v_fma_f32 v204, v204, s21, v234
    v_fma_f32 v205, v205, s21, v234
    v_mfma_f32_16x16x32_bf16 v[60:63], a[188:191], v[208:211], 0
    v_fma_f32 v206, v206, s21, v234
    v_fma_f32 v207, v207, s21, v234
    v_mfma_f32_16x16x32_bf16 v[60:63], a[220:223], v[212:215], v[60:63]
    v_exp_f32 v204, v204
    v_mfma_f32_16x16x32_bf16 v[192:195], a[96:99], a[48:51], 0
    v_exp_f32 v205, v205
    v_mfma_f32_16x16x32_bf16 v[192:195], a[100:103], a[52:55], v[192:195]
    v_exp_f32 v206, v206
    v_mfma_f32_16x16x32_bf16 v[192:195], a[104:107], a[56:59], v[192:195]
    v_exp_f32 v207, v207
    v_mfma_f32_16x16x32_bf16 v[192:195], a[108:111], a[60:63], v[192:195]
    v_cvt_pk_bf16_f32 v254, v204, v205
    v_cvt_pk_bf16_f32 v255, v206, v207
    v_mfma_f32_16x16x32_bf16 v[196:199], a[124:127], a[60:63], 0
    v_cvt_pk_bf16_f32 v99, v102, v103
    v_cvt_pk_bf16_f32 v104, v104, v105
    v_mfma_f32_16x16x32_bf16 v[196:199], a[120:123], a[56:59], v[196:199]
    ds_write_b128 v250, v[96:99] offset:16896
    v_mfma_f32_16x16x32_bf16 v[196:199], a[116:119], a[52:55], v[196:199]
    s_add_u32 m0, s27, 84480
    v_max3_f32 v244, v192, v193, v194
    v_cvt_pk_bf16_f32 v105, v106, v107
    v_mfma_f32_16x16x32_bf16 v[196:199], a[112:115], a[48:51], v[196:199]
    buffer_load_dwordx4 v248, s[8:11], s24 offen nt lds
    v_mfma_f32_16x16x32_bf16 v[200:203], a[128:131], a[48:51], 0
    s_add_u32 m0, s27, 84512
    v_cvt_pk_bf16_f32 v106, v108, v109
    v_cvt_pk_bf16_f32 v107, v110, v111
    v_mfma_f32_16x16x32_bf16 v[200:203], a[132:135], a[52:55], v[200:203]
    ds_write_b128 v250, v[104:107] offset:16960
    v_mfma_f32_16x16x32_bf16 v[200:203], a[136:139], a[56:59], v[200:203]
    v_max3_f32 v244, v244, v195, v196
    v_max3_f32 v244, v244, v197, v198
    v_max_f32 v245, v244, v199
    v_max_f32 v244, v244, v199
    v_mfma_f32_16x16x32_bf16 v[200:203], a[140:143], a[60:63], v[200:203]
    buffer_load_dwordx4 v248, s[8:11], s24 offen offset:1024 nt lds
    v_permlane16_swap_b32 v244, v245
    v_max_f32 v244, v244, v245
    v_mov_b32 v245, v244
    v_mfma_f32_16x16x32_bf16 v[204:207], a[156:159], a[60:63], 0
    s_add_u32 m0, s27, 84544
    v_permlane32_swap_b32 v244, v245
    v_max_f32 v244, v244, v245
    v_mul_f32 v235, s35, v244
    v_mfma_f32_16x16x32_bf16 v[204:207], a[152:155], a[56:59], v[204:207]
    buffer_load_dwordx4 v248, s[8:11], s24 offen offset:2048 nt lds
    v_mfma_f32_16x16x32_bf16 v[204:207], a[148:151], a[52:55], v[204:207]
    s_add_u32 m0, s27, 84576
    v_fma_f32 v192, v192, s21, v235
    v_fma_f32 v193, v193, s21, v235
    v_mfma_f32_16x16x32_bf16 v[204:207], a[144:147], a[48:51], v[204:207]
    buffer_load_dwordx4 v248, s[8:11], s24 offen offset:3072 nt lds
    v_mfma_f32_16x16x32_bf16 a[236:239], a[224:227], v[240:243], 0
    s_add_u32 s24, s24, 8192
    v_fma_f32 v194, v194, s21, v235
    v_fma_f32 v195, v195, s21, v235
    v_mfma_f32_16x16x32_bf16 a[236:239], a[224:227], v[252:255], a[236:239]
    v_exp_f32 v192, v192
    v_mfma_f32_16x16x32_bf16 v[64:67], a[192:195], v[252:255], 0
    v_exp_f32 v193, v193
    v_mfma_f32_16x16x32_bf16 v[64:67], a[160:163], v[240:243], v[64:67]
    v_exp_f32 v194, v194
    v_mfma_f32_16x16x32_bf16 v[68:71], a[164:167], v[240:243], 0
    v_exp_f32 v195, v195
    v_mfma_f32_16x16x32_bf16 v[68:71], a[196:199], v[252:255], v[68:71]
    v_cvt_pk_bf16_f32 v208, v192, v193
    v_cvt_pk_bf16_f32 v209, v194, v195
    v_mfma_f32_16x16x32_bf16 v[72:75], a[200:203], v[252:255], 0
    v_fma_f32 v196, v196, s21, v235
    v_fma_f32 v197, v197, s21, v235
    v_mfma_f32_16x16x32_bf16 v[72:75], a[168:171], v[240:243], v[72:75]
    v_fma_f32 v198, v198, s21, v235
    v_fma_f32 v199, v199, s21, v235
    v_mfma_f32_16x16x32_bf16 v[76:79], a[172:175], v[240:243], 0
    v_exp_f32 v196, v196
    v_mfma_f32_16x16x32_bf16 v[76:79], a[204:207], v[252:255], v[76:79]
    v_exp_f32 v197, v197
    v_mfma_f32_16x16x32_bf16 v[80:83], a[208:211], v[252:255], 0
    v_exp_f32 v198, v198
    v_mfma_f32_16x16x32_bf16 v[80:83], a[176:179], v[240:243], v[80:83]
    v_exp_f32 v199, v199
    v_mfma_f32_16x16x32_bf16 v[84:87], a[180:183], v[240:243], 0
    v_cvt_pk_bf16_f32 v210, v196, v197
    v_cvt_pk_bf16_f32 v211, v198, v199
    v_mfma_f32_16x16x32_bf16 v[84:87], a[212:215], v[252:255], v[84:87]
    v_fma_f32 v200, v200, s21, v235
    v_fma_f32 v201, v201, s21, v235
    v_mfma_f32_16x16x32_bf16 v[88:91], a[216:219], v[252:255], 0
    v_fma_f32 v202, v202, s21, v235
    v_fma_f32 v203, v203, s21, v235
    v_mfma_f32_16x16x32_bf16 v[88:91], a[184:187], v[240:243], v[88:91]
    s_waitcnt lgkmcnt(15)
    v_fma_f32 v204, v204, s21, v235
    v_fma_f32 v205, v205, s21, v235
    v_mfma_f32_16x16x32_bf16 v[92:95], a[188:191], v[240:243], 0
    v_fma_f32 v206, v206, s21, v235
    v_fma_f32 v207, v207, s21, v235
    v_mfma_f32_16x16x32_bf16 v[92:95], a[220:223], v[252:255], v[92:95]
    v_exp_f32 v200, v200
    v_mfma_f32_16x16x32_bf16 v[224:227], a[96:99], a[64:67], 0
    v_exp_f32 v201, v201
    v_mfma_f32_16x16x32_bf16 v[224:227], a[100:103], a[68:71], v[224:227]
    v_exp_f32 v202, v202
    v_mfma_f32_16x16x32_bf16 v[224:227], a[104:107], a[72:75], v[224:227]
    v_exp_f32 v203, v203
    v_mfma_f32_16x16x32_bf16 v[224:227], a[108:111], a[76:79], v[224:227]
    v_exp_f32 v204, v204
    v_mfma_f32_16x16x32_bf16 v[228:231], a[124:127], a[76:79], 0
    v_exp_f32 v205, v205
    v_mfma_f32_16x16x32_bf16 v[228:231], a[120:123], a[72:75], v[228:231]
    v_exp_f32 v206, v206
    v_mfma_f32_16x16x32_bf16 v[228:231], a[116:119], a[68:71], v[228:231]
    v_exp_f32 v207, v207
    v_mfma_f32_16x16x32_bf16 v[228:231], a[112:115], a[64:67], v[228:231]
    v_max3_f32 v244, v224, v225, v226
    v_cvt_pk_bf16_f32 v212, v200, v201
    v_mfma_f32_16x16x32_bf16 v[192:195], a[128:131], a[64:67], 0
    v_cvt_pk_bf16_f32 v213, v202, v203
    v_cvt_pk_bf16_f32 v214, v204, v205
    v_mfma_f32_16x16x32_bf16 v[192:195], a[132:135], a[68:71], v[192:195]
    v_cvt_pk_bf16_f32 v215, v206, v207
    v_cvt_pk_bf16_f32 v112, v112, v113
    v_max3_f32 v244, v244, v227, v228
    v_max3_f32 v244, v244, v229, v230
    v_max_f32 v245, v244, v231
    v_max_f32 v244, v244, v231
    v_mfma_f32_16x16x32_bf16 v[192:195], a[136:139], a[72:75], v[192:195]
    v_cvt_pk_bf16_f32 v113, v114, v115
    v_permlane16_swap_b32 v244, v245
    v_max_f32 v244, v244, v245
    v_mov_b32 v245, v244
    v_mfma_f32_16x16x32_bf16 v[192:195], a[140:143], a[76:79], v[192:195]
    v_cvt_pk_bf16_f32 v114, v116, v117
    v_permlane32_swap_b32 v244, v245
    v_max_f32 v244, v244, v245
    v_mul_f32 v236, s35, v244
    v_mfma_f32_16x16x32_bf16 v[196:199], a[156:159], a[76:79], 0
    v_cvt_pk_bf16_f32 v115, v118, v119
    v_cvt_pk_bf16_f32 v120, v120, v121
    v_mfma_f32_16x16x32_bf16 v[196:199], a[152:155], a[72:75], v[196:199]
    ds_write_b128 v250, v[112:115] offset:17024
    v_mfma_f32_16x16x32_bf16 v[196:199], a[148:151], a[68:71], v[196:199]
    v_cvt_pk_bf16_f32 v121, v122, v123
    v_cvt_pk_bf16_f32 v122, v124, v125
    v_mfma_f32_16x16x32_bf16 v[196:199], a[144:147], a[64:67], v[196:199]
    v_cvt_pk_bf16_f32 v123, v126, v127
    v_fma_f32 v224, v224, s21, v236
    v_mfma_f32_16x16x32_bf16 a[240:243], a[224:227], v[208:211], 0
    v_fma_f32 v225, v225, s21, v236
    v_fma_f32 v226, v226, s21, v236
    v_mfma_f32_16x16x32_bf16 a[240:243], a[224:227], v[212:215], a[240:243]
Lhop6:
    s_cbranch_execz Lret1
    ds_write_b128 v250, v[120:123] offset:17088
    v_subrev_u32 v250, 84480, v250
    v_mfma_f32_16x16x32_bf16 v[96:99], a[192:195], v[212:215], 0
    v_fma_f32 v227, v227, s21, v236
    v_fma_f32 v228, v228, s21, v236
    v_mfma_f32_16x16x32_bf16 v[96:99], a[160:163], v[208:211], v[96:99]
    v_exp_f32 v224, v224
    v_mfma_f32_16x16x32_bf16 v[100:103], a[164:167], v[208:211], 0
    v_exp_f32 v225, v225
    v_mfma_f32_16x16x32_bf16 v[100:103], a[196:199], v[212:215], v[100:103]
    ds_write_b128 v250, v[160:163] offset:0
    v_mfma_f32_16x16x32_bf16 v[104:107], a[200:203], v[212:215], 0
    v_exp_f32 v226, v226
    v_mfma_f32_16x16x32_bf16 v[104:107], a[168:171], v[208:211], v[104:107]
    v_exp_f32 v227, v227
    v_mfma_f32_16x16x32_bf16 v[108:111], a[172:175], v[208:211], 0
    v_cvt_pk_bf16_f32 v240, v224, v225
    v_cvt_pk_bf16_f32 v241, v226, v227
    v_mfma_f32_16x16x32_bf16 v[108:111], a[204:207], v[212:215], v[108:111]
    ds_write_b128 v250, v[168:171] offset:64
    v_mfma_f32_16x16x32_bf16 v[112:115], a[208:211], v[212:215], 0
    v_fma_f32 v229, v229, s21, v236
    v_fma_f32 v230, v230, s21, v236
    v_mfma_f32_16x16x32_bf16 v[112:115], a[176:179], v[208:211], v[112:115]
    v_fma_f32 v231, v231, s21, v236
    v_fma_f32 v192, v192, s21, v236
    v_mfma_f32_16x16x32_bf16 v[116:119], a[180:183], v[208:211], 0
    v_exp_f32 v228, v228
    v_mfma_f32_16x16x32_bf16 v[116:119], a[212:215], v[212:215], v[116:119]
    ds_write_b128 v250, v[176:179] offset:128
    v_mfma_f32_16x16x32_bf16 v[120:123], a[216:219], v[212:215], 0
    v_exp_f32 v229, v229
    v_mfma_f32_16x16x32_bf16 v[120:123], a[184:187], v[208:211], v[120:123]
    s_waitcnt lgkmcnt(9)
    v_exp_f32 v230, v230
    v_mfma_f32_16x16x32_bf16 v[124:127], a[188:191], v[208:211], 0
    v_exp_f32 v231, v231
    v_mfma_f32_16x16x32_bf16 v[124:127], a[220:223], v[212:215], v[124:127]
    ds_write_b128 v250, v[184:187] offset:192
    v_mfma_f32_16x16x32_bf16 v[200:203], a[96:99], a[80:83], 0
    v_cvt_pk_bf16_f32 v242, v228, v229
    v_cvt_pk_bf16_f32 v243, v230, v231
    v_mfma_f32_16x16x32_bf16 v[200:203], a[100:103], a[84:87], v[200:203]
    v_fma_f32 v193, v193, s21, v236
    v_fma_f32 v194, v194, s21, v236
    v_mfma_f32_16x16x32_bf16 v[200:203], a[104:107], a[88:91], v[200:203]
    v_fma_f32 v195, v195, s21, v236
    v_fma_f32 v196, v196, s21, v236
    v_mfma_f32_16x16x32_bf16 v[200:203], a[108:111], a[92:95], v[200:203]
    v_fma_f32 v197, v197, s21, v236
    v_fma_f32 v198, v198, s21, v236
    v_mfma_f32_16x16x32_bf16 v[204:207], a[124:127], a[92:95], 0
    v_exp_f32 v192, v192
    v_mfma_f32_16x16x32_bf16 v[204:207], a[120:123], a[88:91], v[204:207]
    v_exp_f32 v193, v193
    v_mfma_f32_16x16x32_bf16 v[204:207], a[116:119], a[84:87], v[204:207]
    s_add_u32 m0, s27, 33792
    v_max3_f32 v244, v200, v201, v202
    v_fma_f32 v199, v199, s21, v236
    v_mfma_f32_16x16x32_bf16 v[204:207], a[112:115], a[80:83], v[204:207]
    buffer_load_dwordx4 v248, s[8:11], s24 offen nt lds
    v_mfma_f32_16x16x32_bf16 v[224:227], a[128:131], a[80:83], 0
    s_waitcnt vmcnt(9)
    v_exp_f32 v194, v194
    v_mfma_f32_16x16x32_bf16 v[224:227], a[132:135], a[84:87], v[224:227]
    s_barrier
    v_mfma_f32_16x16x32_bf16 v[224:227], a[136:139], a[88:91], v[224:227]
    s_add_u32 m0, s27, 33824
    v_max3_f32 v244, v244, v203, v204
    v_max3_f32 v244, v244, v205, v206
    v_max_f32 v245, v244, v207
    v_max_f32 v244, v244, v207
    v_mfma_f32_16x16x32_bf16 v[224:227], a[140:143], a[92:95], v[224:227]
    ds_read_b128 a[96:99], v246 offset:16896
    v_permlane16_swap_b32 v244, v245
    v_max_f32 v244, v244, v245
    v_mov_b32 v245, v244
    v_mfma_f32_16x16x32_bf16 v[228:231], a[156:159], a[92:95], 0
    v_exp_f32 v195, v195
    v_permlane32_swap_b32 v244, v245
    v_max_f32 v244, v244, v245
    v_mul_f32 v237, s35, v244
    v_mfma_f32_16x16x32_bf16 v[228:231], a[152:155], a[88:91], v[228:231]
    v_exp_f32 v196, v196
    v_mfma_f32_16x16x32_bf16 v[228:231], a[148:151], a[84:87], v[228:231]
    ds_read_b128 a[100:103], v246 offset:16960
    v_exp_f32 v197, v197
    v_exp_f32 v198, v198
    v_exp_f32 v199, v199
    v_mfma_f32_16x16x32_bf16 v[228:231], a[144:147], a[80:83], v[228:231]
    v_cvt_pk_bf16_f32 v252, v192, v193
    v_cvt_pk_bf16_f32 v253, v194, v195
    v_cvt_pk_bf16_f32 v254, v196, v197
    v_cvt_pk_bf16_f32 v255, v198, v199
    v_mfma_f32_16x16x32_bf16 a[244:247], a[224:227], v[240:243], 0
    ds_read_b128 a[104:107], v246 offset:17024
    buffer_load_dwordx4 v248, s[8:11], s24 offen offset:1024 nt lds
    v_mfma_f32_16x16x32_bf16 a[244:247], a[224:227], v[252:255], a[244:247]
    s_add_u32 m0, s27, 33856
    ds_read_b128 a[108:111], v246 offset:17088
    v_fma_f32 v200, v200, s21, v237
    v_mfma_f32_16x16x32_bf16 v[128:131], a[192:195], v[252:255], 0
    ds_read_b128 a[124:127], v246 offset:17600
    v_fma_f32 v201, v201, s21, v237
    v_mfma_f32_16x16x32_bf16 v[128:131], a[160:163], v[240:243], v[128:131]
    ds_read_b128 a[120:123], v246 offset:17536
    ds_read_b128 a[116:119], v246 offset:17472
    ds_read_b128 a[112:115], v246 offset:17408
    v_add_u32 v246, 16896, v246
    v_mfma_f32_16x16x32_bf16 v[132:135], a[164:167], v[240:243], 0
    ds_read_b128 a[128:131], v246 offset:50688
    buffer_load_dwordx4 v248, s[8:11], s24 offen offset:2048 nt lds
    v_mfma_f32_16x16x32_bf16 v[132:135], a[196:199], v[252:255], v[132:135]
    s_add_u32 m0, s27, 33888
    ds_read_b128 a[132:135], v246 offset:50752
    v_fma_f32 v202, v202, s21, v237
    v_mfma_f32_16x16x32_bf16 v[136:139], a[200:203], v[252:255], 0
    ds_read_b128 a[136:139], v246 offset:50816
    v_fma_f32 v203, v203, s21, v237
    v_mfma_f32_16x16x32_bf16 v[136:139], a[168:171], v[240:243], v[136:139]
    buffer_load_dwordx4 v248, s[8:11], s24 offen offset:3072 nt lds
    v_mfma_f32_16x16x32_bf16 v[140:143], a[172:175], v[240:243], 0
    s_add_u32 s24, s24, 8192
    ds_read_b128 a[140:143], v246 offset:50880
    ds_read_b128 a[156:159], v246 offset:51392
    v_mfma_f32_16x16x32_bf16 v[140:143], a[204:207], v[252:255], v[140:143]
    v_exp_f32 v200, v200
    v_mfma_f32_16x16x32_bf16 v[144:147], a[208:211], v[252:255], 0
    ds_read_b128 a[152:155], v246 offset:51328
    ds_read_b128 a[148:151], v246 offset:51264
    v_mfma_f32_16x16x32_bf16 v[144:147], a[176:179], v[240:243], v[144:147]
    v_exp_f32 v201, v201
    v_mfma_f32_16x16x32_bf16 v[148:151], a[180:183], v[240:243], 0
    ds_read_b128 a[144:147], v246 offset:51200
    v_cvt_pk_bf16_f32 v208, v200, v201
    v_mfma_f32_16x16x32_bf16 v[148:151], a[212:215], v[252:255], v[148:151]
    v_exp_f32 v202, v202
    v_mfma_f32_16x16x32_bf16 v[152:155], a[216:219], v[252:255], 0
    v_exp_f32 v203, v203
    v_mfma_f32_16x16x32_bf16 v[152:155], a[184:187], v[240:243], v[152:155]
    s_waitcnt lgkmcnt(8)
    v_cvt_pk_bf16_f32 v209, v202, v203
    v_fma_f32 v204, v204, s21, v237
    v_mfma_f32_16x16x32_bf16 v[156:159], a[188:191], v[240:243], 0
    v_fma_f32 v205, v205, s21, v237
    v_fma_f32 v206, v206, s21, v237
    v_mfma_f32_16x16x32_bf16 v[156:159], a[220:223], v[252:255], v[156:159]
    v_fma_f32 v207, v207, s21, v237
    v_fma_f32 v224, v224, s21, v237
    v_mfma_f32_16x16x32_bf16 v[192:195], a[96:99], a[0:3], 0
    v_exp_f32 v204, v204
    v_mfma_f32_16x16x32_bf16 v[192:195], a[100:103], a[4:7], v[192:195]
    v_exp_f32 v205, v205
    v_mfma_f32_16x16x32_bf16 v[192:195], a[104:107], a[8:11], v[192:195]
    v_exp_f32 v206, v206
    v_mfma_f32_16x16x32_bf16 v[192:195], a[108:111], a[12:15], v[192:195]
    v_exp_f32 v207, v207
    v_mfma_f32_16x16x32_bf16 v[196:199], a[124:127], a[12:15], 0
    v_cvt_pk_bf16_f32 v210, v204, v205
    v_cvt_pk_bf16_f32 v211, v206, v207
    v_mfma_f32_16x16x32_bf16 v[196:199], a[120:123], a[8:11], v[196:199]
    s_waitcnt lgkmcnt(0)
    v_fma_f32 v225, v225, s21, v237
    v_fma_f32 v226, v226, s21, v237
    v_mfma_f32_16x16x32_bf16 v[196:199], a[116:119], a[4:7], v[196:199]
    v_fma_f32 v227, v227, s21, v237
    v_fma_f32 v228, v228, s21, v237
    v_mfma_f32_16x16x32_bf16 v[196:199], a[112:115], a[0:3], v[196:199]
    v_fma_f32 v229, v229, s21, v237
    v_fma_f32 v230, v230, s21, v237
    v_mfma_f32_16x16x32_bf16 v[200:203], a[128:131], a[0:3], 0
    v_fma_f32 v231, v231, s21, v237
    v_fma_f32 v192, v192, s21, v232
    v_mfma_f32_16x16x32_bf16 v[200:203], a[132:135], a[4:7], v[200:203]
    v_exp_f32 v224, v224
    v_mfma_f32_16x16x32_bf16 v[200:203], a[136:139], a[8:11], v[200:203]
    v_exp_f32 v225, v225
    v_mfma_f32_16x16x32_bf16 v[200:203], a[140:143], a[12:15], v[200:203]
    v_exp_f32 v226, v226
    v_mfma_f32_16x16x32_bf16 v[204:207], a[156:159], a[12:15], 0
    v_exp_f32 v227, v227
    v_mfma_f32_16x16x32_bf16 v[204:207], a[152:155], a[8:11], v[204:207]
    v_exp_f32 v228, v228
    v_mfma_f32_16x16x32_bf16 v[204:207], a[148:151], a[4:7], v[204:207]
    v_exp_f32 v229, v229
    v_exp_f32 v230, v230
    v_exp_f32 v231, v231
    v_mfma_f32_16x16x32_bf16 v[204:207], a[144:147], a[0:3], v[204:207]
    v_cvt_pk_bf16_f32 v212, v224, v225
    v_cvt_pk_bf16_f32 v213, v226, v227
    v_cvt_pk_bf16_f32 v214, v228, v229
    v_cvt_pk_bf16_f32 v215, v230, v231
    v_mfma_f32_16x16x32_bf16 a[248:251], a[224:227], v[208:211], 0
    v_fma_f32 v193, v193, s21, v232
    v_fma_f32 v194, v194, s21, v232
    v_mfma_f32_16x16x32_bf16 a[248:251], a[224:227], v[212:215], a[248:251]
    v_fma_f32 v195, v195, s21, v232
    v_fma_f32 v196, v196, s21, v232
    v_mfma_f32_16x16x32_bf16 v[160:163], a[192:195], v[212:215], 0
    ds_read_b64_tr_b16 a[192:193], v247 offset:59136
    ds_read_b64_tr_b16 a[194:195], v247 offset:59648
    v_mfma_f32_16x16x32_bf16 v[160:163], a[160:163], v[208:211], v[160:163]
    v_exp_f32 v192, v192
    v_mfma_f32_16x16x32_bf16 v[164:167], a[164:167], v[208:211], 0
    ds_read_b64_tr_b16 a[160:161], v247 offset:8448
    ds_read_b64_tr_b16 a[162:163], v247 offset:8960
    v_mfma_f32_16x16x32_bf16 v[164:167], a[196:199], v[212:215], v[164:167]
    v_exp_f32 v193, v193
    v_mfma_f32_16x16x32_bf16 v[168:171], a[200:203], v[212:215], 0
    ds_read_b64_tr_b16 a[164:165], v247 offset:8456
    ds_read_b64_tr_b16 a[166:167], v247 offset:8968
    v_mfma_f32_16x16x32_bf16 v[168:171], a[168:171], v[208:211], v[168:171]
    v_exp_f32 v194, v194
    v_mfma_f32_16x16x32_bf16 v[172:175], a[172:175], v[208:211], 0
    ds_read_b64_tr_b16 a[196:197], v247 offset:59144
    ds_read_b64_tr_b16 a[198:199], v247 offset:59656
    v_mfma_f32_16x16x32_bf16 v[172:175], a[204:207], v[212:215], v[172:175]
    v_exp_f32 v195, v195
    v_mfma_f32_16x16x32_bf16 v[176:179], a[208:211], v[212:215], 0
    ds_read_b64_tr_b16 a[168:169], v247 offset:8512
    ds_read_b64_tr_b16 a[170:171], v247 offset:9024
    v_mfma_f32_16x16x32_bf16 v[176:179], a[176:179], v[208:211], v[176:179]
    v_cvt_pk_bf16_f32 v240, v192, v193
    v_cvt_pk_bf16_f32 v241, v194, v195
    v_mfma_f32_16x16x32_bf16 v[180:183], a[180:183], v[208:211], 0
    ds_read_b64_tr_b16 a[200:201], v247 offset:59200
    ds_read_b64_tr_b16 a[202:203], v247 offset:59712
    v_mfma_f32_16x16x32_bf16 v[180:183], a[212:215], v[212:215], v[180:183]
    v_fma_f32 v197, v197, s21, v232
    v_fma_f32 v198, v198, s21, v232
    v_mfma_f32_16x16x32_bf16 v[184:187], a[216:219], v[212:215], 0
    ds_read_b64_tr_b16 a[172:173], v247 offset:8520
    ds_read_b64_tr_b16 a[174:175], v247 offset:9032
    v_mfma_f32_16x16x32_bf16 v[184:187], a[184:187], v[208:211], v[184:187]
    v_fma_f32 v199, v199, s21, v232
    v_fma_f32 v200, v200, s21, v232
    v_mfma_f32_16x16x32_bf16 v[188:191], a[188:191], v[208:211], 0
    ds_read_b64_tr_b16 a[204:205], v247 offset:59208
    ds_read_b64_tr_b16 a[206:207], v247 offset:59720
    v_mfma_f32_16x16x32_bf16 v[188:191], a[220:223], v[212:215], v[188:191]
    v_exp_f32 v196, v196
    v_mfma_f32_16x16x32_bf16 v[224:227], a[96:99], a[16:19], 0
    ds_read_b64_tr_b16 a[176:177], v247 offset:8576
    ds_read_b64_tr_b16 a[178:179], v247 offset:9088
    v_mfma_f32_16x16x32_bf16 v[224:227], a[100:103], a[20:23], v[224:227]
    v_exp_f32 v197, v197
    v_mfma_f32_16x16x32_bf16 v[224:227], a[104:107], a[24:27], v[224:227]
    ds_read_b64_tr_b16 a[208:209], v247 offset:59264
    ds_read_b64_tr_b16 a[210:211], v247 offset:59776
    v_mfma_f32_16x16x32_bf16 v[224:227], a[108:111], a[28:31], v[224:227]
    v_exp_f32 v198, v198
    v_mfma_f32_16x16x32_bf16 v[228:231], a[124:127], a[28:31], 0
    v_exp_f32 v199, v199
    v_mfma_f32_16x16x32_bf16 v[228:231], a[120:123], a[24:27], v[228:231]
    v_cvt_pk_bf16_f32 v242, v196, v197
    v_cvt_pk_bf16_f32 v243, v198, v199
    v_mfma_f32_16x16x32_bf16 v[228:231], a[116:119], a[20:23], v[228:231]
    s_add_u32 m0, s27, 50688
    ds_read_b64_tr_b16 a[180:181], v247 offset:8584
    ds_read_b64_tr_b16 a[182:183], v247 offset:9096
    v_mfma_f32_16x16x32_bf16 v[228:231], a[112:115], a[16:19], v[228:231]
    buffer_load_dwordx4 v248, s[8:11], s24 offen nt lds
    v_mfma_f32_16x16x32_bf16 v[192:195], a[128:131], a[16:19], 0
    s_add_u32 m0, s27, 50720
    v_fma_f32 v201, v201, s21, v232
    v_fma_f32 v202, v202, s21, v232
    v_mfma_f32_16x16x32_bf16 v[192:195], a[132:135], a[20:23], v[192:195]
    v_fma_f32 v203, v203, s21, v232
    v_fma_f32 v204, v204, s21, v232
    v_mfma_f32_16x16x32_bf16 v[192:195], a[136:139], a[24:27], v[192:195]
    v_fma_f32 v205, v205, s21, v232
    v_fma_f32 v206, v206, s21, v232
    v_mfma_f32_16x16x32_bf16 v[192:195], a[140:143], a[28:31], v[192:195]
    ds_read_b64_tr_b16 a[212:213], v247 offset:59272
    v_fma_f32 v207, v207, s21, v232
    v_mfma_f32_16x16x32_bf16 v[196:199], a[156:159], a[28:31], 0
    v_exp_f32 v200, v200
    v_mfma_f32_16x16x32_bf16 v[196:199], a[152:155], a[24:27], v[196:199]
    v_exp_f32 v201, v201
    v_mfma_f32_16x16x32_bf16 v[196:199], a[148:151], a[20:23], v[196:199]
    ds_read_b64_tr_b16 a[214:215], v247 offset:59784
    v_exp_f32 v202, v202
    v_exp_f32 v203, v203
    v_exp_f32 v204, v204
    v_exp_f32 v205, v205
    v_exp_f32 v206, v206
    v_exp_f32 v207, v207
    v_mfma_f32_16x16x32_bf16 v[196:199], a[144:147], a[16:19], v[196:199]
    s_waitcnt lgkmcnt(15)
    ds_read_b64_tr_b16 a[184:185], v247 offset:8640
    v_cvt_pk_bf16_f32 v252, v200, v201
    v_cvt_pk_bf16_f32 v253, v202, v203
    v_cvt_pk_bf16_f32 v254, v204, v205
    v_cvt_pk_bf16_f32 v255, v206, v207
    v_mfma_f32_16x16x32_bf16 a[228:231], a[224:227], v[240:243], a[228:231]
    buffer_load_dwordx4 v248, s[8:11], s24 offen offset:1024 nt lds
    v_mfma_f32_16x16x32_bf16 a[228:231], a[224:227], v[252:255], a[228:231]
    s_add_u32 m0, s27, 50752
    ds_read_b64_tr_b16 a[186:187], v247 offset:9152
    ds_read_b64_tr_b16 a[216:217], v247 offset:59328
    v_mfma_f32_16x16x32_bf16 v[0:3], a[192:195], v[252:255], v[0:3]
    buffer_load_dwordx4 v248, s[8:11], s24 offen offset:2048 nt lds
    v_mfma_f32_16x16x32_bf16 v[0:3], a[160:163], v[240:243], v[0:3]
    s_waitcnt lgkmcnt(11)
    ds_read_b64_tr_b16 a[218:219], v247 offset:59840
    ds_read_b64_tr_b16 a[188:189], v247 offset:8648
    v_mfma_f32_16x16x32_bf16 v[4:7], a[164:167], v[240:243], v[4:7]
    s_add_u32 m0, s27, 50784
    v_fma_f32 v224, v224, s21, v233
    v_fma_f32 v225, v225, s21, v233
    v_mfma_f32_16x16x32_bf16 v[4:7], a[196:199], v[252:255], v[4:7]
    ds_read_b64_tr_b16 a[190:191], v247 offset:9160
    ds_read_b64_tr_b16 a[220:221], v247 offset:59336
    v_mfma_f32_16x16x32_bf16 v[8:11], a[200:203], v[252:255], v[8:11]
    ds_read_b64_tr_b16 a[222:223], v247 offset:59848
    v_fma_f32 v226, v226, s21, v233
    v_mfma_f32_16x16x32_bf16 v[8:11], a[168:171], v[240:243], v[8:11]
    s_waitcnt lgkmcnt(8)
    buffer_load_dwordx4 v248, s[8:11], s24 offen offset:3072 nt lds
    v_mfma_f32_16x16x32_bf16 v[12:15], a[172:175], v[240:243], v[12:15]
    s_add_u32 s24, s24, 8192
    v_fma_f32 v227, v227, s21, v233
    v_fma_f32 v228, v228, s21, v233
    v_mfma_f32_16x16x32_bf16 v[12:15], a[204:207], v[252:255], v[12:15]
    v_exp_f32 v224, v224
    v_mfma_f32_16x16x32_bf16 v[16:19], a[208:211], v[252:255], v[16:19]
    v_exp_f32 v225, v225
    v_mfma_f32_16x16x32_bf16 v[16:19], a[176:179], v[240:243], v[16:19]
    v_exp_f32 v226, v226
    v_mfma_f32_16x16x32_bf16 v[20:23], a[180:183], v[240:243], v[20:23]
    v_exp_f32 v227, v227
    v_mfma_f32_16x16x32_bf16 v[20:23], a[212:215], v[252:255], v[20:23]
    s_waitcnt lgkmcnt(0)
    v_cvt_pk_bf16_f32 v208, v224, v225
    v_cvt_pk_bf16_f32 v209, v226, v227
    v_mfma_f32_16x16x32_bf16 v[24:27], a[216:219], v[252:255], v[24:27]
    v_fma_f32 v229, v229, s21, v233
    v_fma_f32 v230, v230, s21, v233
    v_mfma_f32_16x16x32_bf16 v[24:27], a[184:187], v[240:243], v[24:27]
    v_fma_f32 v231, v231, s21, v233
    v_fma_f32 v192, v192, s21, v233
    v_mfma_f32_16x16x32_bf16 v[28:31], a[188:191], v[240:243], v[28:31]
    v_exp_f32 v228, v228
    v_mfma_f32_16x16x32_bf16 v[28:31], a[220:223], v[252:255], v[28:31]
    s_waitcnt lgkmcnt(0)
    v_exp_f32 v229, v229
    v_mfma_f32_16x16x32_bf16 v[200:203], a[96:99], a[32:35], 0
    s_barrier
    v_mfma_f32_16x16x32_bf16 v[200:203], a[100:103], a[36:39], v[200:203]
    v_exp_f32 v230, v230
    v_mfma_f32_16x16x32_bf16 v[200:203], a[104:107], a[40:43], v[200:203]
    v_exp_f32 v231, v231
    v_mfma_f32_16x16x32_bf16 v[200:203], a[108:111], a[44:47], v[200:203]
    v_cvt_pk_bf16_f32 v210, v228, v229
    v_cvt_pk_bf16_f32 v211, v230, v231
    v_mfma_f32_16x16x32_bf16 v[204:207], a[124:127], a[44:47], 0
    v_fma_f32 v193, v193, s21, v233
    v_fma_f32 v194, v194, s21, v233
    v_mfma_f32_16x16x32_bf16 v[204:207], a[120:123], a[40:43], v[204:207]
    v_fma_f32 v195, v195, s21, v233
    v_fma_f32 v196, v196, s21, v233
    v_mfma_f32_16x16x32_bf16 v[204:207], a[116:119], a[36:39], v[204:207]
    v_fma_f32 v197, v197, s21, v233
    v_fma_f32 v198, v198, s21, v233
    v_mfma_f32_16x16x32_bf16 v[204:207], a[112:115], a[32:35], v[204:207]
    v_fma_f32 v199, v199, s21, v233
    v_fma_f32 v200, v200, s21, v234
    v_mfma_f32_16x16x32_bf16 v[224:227], a[128:131], a[32:35], 0
    v_exp_f32 v192, v192
    v_mfma_f32_16x16x32_bf16 v[224:227], a[132:135], a[36:39], v[224:227]
    v_exp_f32 v193, v193
    v_mfma_f32_16x16x32_bf16 v[224:227], a[136:139], a[40:43], v[224:227]
    v_exp_f32 v194, v194
    v_mfma_f32_16x16x32_bf16 v[224:227], a[140:143], a[44:47], v[224:227]
    v_exp_f32 v195, v195
    v_mfma_f32_16x16x32_bf16 v[228:231], a[156:159], a[44:47], 0
    v_exp_f32 v196, v196
    v_mfma_f32_16x16x32_bf16 v[228:231], a[152:155], a[40:43], v[228:231]
    v_exp_f32 v197, v197
    v_mfma_f32_16x16x32_bf16 v[228:231], a[148:151], a[36:39], v[228:231]
    v_exp_f32 v198, v198
    v_exp_f32 v199, v199
    v_mfma_f32_16x16x32_bf16 v[228:231], a[144:147], a[32:35], v[228:231]
    v_cvt_pk_bf16_f32 v212, v192, v193
    v_cvt_pk_bf16_f32 v213, v194, v195
    v_cvt_pk_bf16_f32 v214, v196, v197
    v_cvt_pk_bf16_f32 v215, v198, v199
    v_mfma_f32_16x16x32_bf16 a[232:235], a[224:227], v[208:211], a[232:235]
    v_fma_f32 v201, v201, s21, v234
    v_fma_f32 v202, v202, s21, v234
    v_mfma_f32_16x16x32_bf16 a[232:235], a[224:227], v[212:215], a[232:235]
    v_fma_f32 v203, v203, s21, v234
    v_fma_f32 v204, v204, s21, v234
    v_mfma_f32_16x16x32_bf16 v[32:35], a[192:195], v[212:215], v[32:35]
    v_fma_f32 v205, v205, s21, v234
    v_fma_f32 v206, v206, s21, v234
    v_mfma_f32_16x16x32_bf16 v[32:35], a[160:163], v[208:211], v[32:35]
    v_fma_f32 v207, v207, s21, v234
    v_fma_f32 v224, v224, s21, v234
    v_mfma_f32_16x16x32_bf16 v[36:39], a[164:167], v[208:211], v[36:39]
    v_fma_f32 v225, v225, s21, v234
    v_fma_f32 v226, v226, s21, v234
    v_mfma_f32_16x16x32_bf16 v[36:39], a[196:199], v[212:215], v[36:39]
    v_fma_f32 v227, v227, s21, v234
    v_fma_f32 v228, v228, s21, v234
    v_mfma_f32_16x16x32_bf16 v[40:43], a[200:203], v[212:215], v[40:43]
    v_fma_f32 v229, v229, s21, v234
    v_fma_f32 v230, v230, s21, v234
    v_mfma_f32_16x16x32_bf16 v[40:43], a[168:171], v[208:211], v[40:43]
    v_exp_f32 v200, v200
    v_mfma_f32_16x16x32_bf16 v[44:47], a[172:175], v[208:211], v[44:47]
    v_exp_f32 v201, v201
    v_mfma_f32_16x16x32_bf16 v[44:47], a[204:207], v[212:215], v[44:47]
    v_fma_f32 v231, v231, s21, v234
    v_cvt_pk_bf16_f32 v240, v200, v201
    v_mfma_f32_16x16x32_bf16 v[48:51], a[208:211], v[212:215], v[48:51]
    v_exp_f32 v202, v202
    v_mfma_f32_16x16x32_bf16 v[48:51], a[176:179], v[208:211], v[48:51]
    v_exp_f32 v203, v203
    v_mfma_f32_16x16x32_bf16 v[52:55], a[180:183], v[208:211], v[52:55]
    v_exp_f32 v204, v204
    v_mfma_f32_16x16x32_bf16 v[52:55], a[212:215], v[212:215], v[52:55]
    v_exp_f32 v205, v205
    v_mfma_f32_16x16x32_bf16 v[56:59], a[216:219], v[212:215], v[56:59]
    v_exp_f32 v206, v206
    v_mfma_f32_16x16x32_bf16 v[56:59], a[184:187], v[208:211], v[56:59]
    v_exp_f32 v207, v207
    v_mfma_f32_16x16x32_bf16 v[60:63], a[188:191], v[208:211], v[60:63]
    v_exp_f32 v224, v224
    v_mfma_f32_16x16x32_bf16 v[60:63], a[220:223], v[212:215], v[60:63]
    v_exp_f32 v225, v225
    v_mfma_f32_16x16x32_bf16 v[192:195], a[96:99], a[48:51], 0
    v_exp_f32 v226, v226
    v_mfma_f32_16x16x32_bf16 v[192:195], a[100:103], a[52:55], v[192:195]
    v_exp_f32 v227, v227
    v_mfma_f32_16x16x32_bf16 v[192:195], a[104:107], a[56:59], v[192:195]
    v_exp_f32 v228, v228
    v_mfma_f32_16x16x32_bf16 v[192:195], a[108:111], a[60:63], v[192:195]
    v_exp_f32 v229, v229
    v_mfma_f32_16x16x32_bf16 v[196:199], a[124:127], a[60:63], 0
    v_exp_f32 v230, v230
    v_mfma_f32_16x16x32_bf16 v[196:199], a[120:123], a[56:59], v[196:199]
    v_exp_f32 v231, v231
    v_mfma_f32_16x16x32_bf16 v[196:199], a[116:119], a[52:55], v[196:199]
    v_cvt_pk_bf16_f32 v241, v202, v203
    v_cvt_pk_bf16_f32 v242, v204, v205
    v_mfma_f32_16x16x32_bf16 v[196:199], a[112:115], a[48:51], v[196:199]
    v_cvt_pk_bf16_f32 v243, v206, v207
    v_cvt_pk_bf16_f32 v252, v224, v225
    v_cvt_pk_bf16_f32 v253, v226, v227
    v_cvt_pk_bf16_f32 v254, v228, v229
    v_cvt_pk_bf16_f32 v255, v230, v231
    v_mfma_f32_16x16x32_bf16 v[200:203], a[128:131], a[48:51], 0
    s_add_u32 m0, s27, 16896
    v_add_u32 v246, 16896, v246
    v_add_u32 v247, 16896, v247
    v_add_u32 v251, 33792, v251
    v_mfma_f32_16x16x32_bf16 v[200:203], a[132:135], a[52:55], v[200:203]
    buffer_load_dwordx4 v248, s[8:11], s24 offen nt lds
    v_mfma_f32_16x16x32_bf16 v[200:203], a[136:139], a[56:59], v[200:203]
    s_add_u32 m0, s27, 16928
    v_fma_f32 v192, v192, s21, v235
    v_fma_f32 v193, v193, s21, v235
    v_mfma_f32_16x16x32_bf16 v[200:203], a[140:143], a[60:63], v[200:203]
    buffer_load_dwordx4 v248, s[8:11], s24 offen offset:1024 nt lds
    v_mfma_f32_16x16x32_bf16 v[204:207], a[156:159], a[60:63], 0
    s_add_u32 m0, s27, 16960
    v_fma_f32 v194, v194, s21, v235
    v_fma_f32 v195, v195, s21, v235
    v_mfma_f32_16x16x32_bf16 v[204:207], a[152:155], a[56:59], v[204:207]
    buffer_load_dwordx4 v248, s[8:11], s24 offen offset:2048 nt lds
    v_mfma_f32_16x16x32_bf16 v[204:207], a[148:151], a[52:55], v[204:207]
    s_add_u32 m0, s27, 16992
    v_exp_f32 v192, v192
    v_mfma_f32_16x16x32_bf16 v[204:207], a[144:147], a[48:51], v[204:207]
    buffer_load_dwordx4 v248, s[8:11], s24 offen offset:3072 nt lds
    v_mfma_f32_16x16x32_bf16 a[236:239], a[224:227], v[240:243], a[236:239]
    s_add_u32 s24, s24, 8192
    v_exp_f32 v193, v193
    v_mfma_f32_16x16x32_bf16 a[236:239], a[224:227], v[252:255], a[236:239]
    v_exp_f32 v194, v194
    v_mfma_f32_16x16x32_bf16 v[64:67], a[192:195], v[252:255], v[64:67]
    v_exp_f32 v195, v195
    v_mfma_f32_16x16x32_bf16 v[64:67], a[160:163], v[240:243], v[64:67]
    v_cvt_pk_bf16_f32 v208, v192, v193
    v_cvt_pk_bf16_f32 v209, v194, v195
    v_mfma_f32_16x16x32_bf16 v[68:71], a[164:167], v[240:243], v[68:71]
    v_fma_f32 v196, v196, s21, v235
    v_fma_f32 v197, v197, s21, v235
    v_mfma_f32_16x16x32_bf16 v[68:71], a[196:199], v[252:255], v[68:71]
    v_fma_f32 v198, v198, s21, v235
    v_fma_f32 v199, v199, s21, v235
    v_mfma_f32_16x16x32_bf16 v[72:75], a[200:203], v[252:255], v[72:75]
    v_exp_f32 v196, v196
    v_mfma_f32_16x16x32_bf16 v[72:75], a[168:171], v[240:243], v[72:75]
    v_exp_f32 v197, v197
    v_mfma_f32_16x16x32_bf16 v[76:79], a[172:175], v[240:243], v[76:79]
    v_exp_f32 v198, v198
    v_mfma_f32_16x16x32_bf16 v[76:79], a[204:207], v[252:255], v[76:79]
    v_exp_f32 v199, v199
    v_mfma_f32_16x16x32_bf16 v[80:83], a[208:211], v[252:255], v[80:83]
    v_cvt_pk_bf16_f32 v210, v196, v197
    v_cvt_pk_bf16_f32 v211, v198, v199
    v_mfma_f32_16x16x32_bf16 v[80:83], a[176:179], v[240:243], v[80:83]
    v_fma_f32 v200, v200, s21, v235
    v_fma_f32 v201, v201, s21, v235
    v_mfma_f32_16x16x32_bf16 v[84:87], a[180:183], v[240:243], v[84:87]
    v_fma_f32 v202, v202, s21, v235
    v_fma_f32 v203, v203, s21, v235
    v_mfma_f32_16x16x32_bf16 v[84:87], a[212:215], v[252:255], v[84:87]
    v_fma_f32 v204, v204, s21, v235
    v_fma_f32 v205, v205, s21, v235
    v_mfma_f32_16x16x32_bf16 v[88:91], a[216:219], v[252:255], v[88:91]
    v_fma_f32 v206, v206, s21, v235
    v_fma_f32 v207, v207, s21, v235
    v_mfma_f32_16x16x32_bf16 v[88:91], a[184:187], v[240:243], v[88:91]
    v_exp_f32 v200, v200
    v_mfma_f32_16x16x32_bf16 v[92:95], a[188:191], v[240:243], v[92:95]
    v_exp_f32 v201, v201
    v_mfma_f32_16x16x32_bf16 v[92:95], a[220:223], v[252:255], v[92:95]
    v_exp_f32 v202, v202
    v_mfma_f32_16x16x32_bf16 v[224:227], a[96:99], a[64:67], 0
    v_exp_f32 v203, v203
    v_mfma_f32_16x16x32_bf16 v[224:227], a[100:103], a[68:71], v[224:227]
    v_exp_f32 v204, v204
    v_mfma_f32_16x16x32_bf16 v[224:227], a[104:107], a[72:75], v[224:227]
    v_exp_f32 v205, v205
    v_mfma_f32_16x16x32_bf16 v[224:227], a[108:111], a[76:79], v[224:227]
    v_exp_f32 v206, v206
    v_mfma_f32_16x16x32_bf16 v[228:231], a[124:127], a[76:79], 0
    v_exp_f32 v207, v207
    v_mfma_f32_16x16x32_bf16 v[228:231], a[120:123], a[72:75], v[228:231]
    v_cvt_pk_bf16_f32 v212, v200, v201
    v_cvt_pk_bf16_f32 v213, v202, v203
    v_mfma_f32_16x16x32_bf16 v[228:231], a[116:119], a[68:71], v[228:231]
    v_cvt_pk_bf16_f32 v214, v204, v205
    v_cvt_pk_bf16_f32 v215, v206, v207
    v_mfma_f32_16x16x32_bf16 v[228:231], a[112:115], a[64:67], v[228:231]
    v_fma_f32 v224, v224, s21, v236
    v_fma_f32 v225, v225, s21, v236
    v_mfma_f32_16x16x32_bf16 v[192:195], a[128:131], a[64:67], 0
    v_fma_f32 v226, v226, s21, v236
    v_fma_f32 v227, v227, s21, v236
    v_mfma_f32_16x16x32_bf16 v[192:195], a[132:135], a[68:71], v[192:195]
    v_exp_f32 v224, v224
    v_mfma_f32_16x16x32_bf16 v[192:195], a[136:139], a[72:75], v[192:195]
    v_exp_f32 v225, v225
    v_mfma_f32_16x16x32_bf16 v[192:195], a[140:143], a[76:79], v[192:195]
    v_exp_f32 v226, v226
    v_mfma_f32_16x16x32_bf16 v[196:199], a[156:159], a[76:79], 0
    v_exp_f32 v227, v227
    v_mfma_f32_16x16x32_bf16 v[196:199], a[152:155], a[72:75], v[196:199]
    v_cvt_pk_bf16_f32 v240, v224, v225
    v_cvt_pk_bf16_f32 v241, v226, v227
    v_mfma_f32_16x16x32_bf16 v[196:199], a[148:151], a[68:71], v[196:199]
    v_fma_f32 v228, v228, s21, v236
    v_fma_f32 v229, v229, s21, v236
    v_mfma_f32_16x16x32_bf16 v[196:199], a[144:147], a[64:67], v[196:199]
    v_fma_f32 v230, v230, s21, v236
    v_fma_f32 v231, v231, s21, v236
    v_mfma_f32_16x16x32_bf16 a[240:243], a[224:227], v[208:211], a[240:243]
    v_exp_f32 v228, v228
    v_mfma_f32_16x16x32_bf16 a[240:243], a[224:227], v[212:215], a[240:243]
    v_exp_f32 v229, v229
    v_mfma_f32_16x16x32_bf16 v[96:99], a[192:195], v[212:215], v[96:99]
    v_exp_f32 v230, v230
    v_mfma_f32_16x16x32_bf16 v[96:99], a[160:163], v[208:211], v[96:99]
    v_exp_f32 v231, v231
    v_mfma_f32_16x16x32_bf16 v[100:103], a[164:167], v[208:211], v[100:103]
    v_cvt_pk_bf16_f32 v242, v228, v229
    v_cvt_pk_bf16_f32 v243, v230, v231
    v_mfma_f32_16x16x32_bf16 v[100:103], a[196:199], v[212:215], v[100:103]
Lhop7:
    s_cbranch_execz Lret1
    v_fma_f32 v192, v192, s21, v236
    v_fma_f32 v193, v193, s21, v236
    v_mfma_f32_16x16x32_bf16 v[104:107], a[200:203], v[212:215], v[104:107]
    v_fma_f32 v194, v194, s21, v236
    v_fma_f32 v195, v195, s21, v236
    v_mfma_f32_16x16x32_bf16 v[104:107], a[168:171], v[208:211], v[104:107]
    v_fma_f32 v196, v196, s21, v236
    v_fma_f32 v197, v197, s21, v236
    v_mfma_f32_16x16x32_bf16 v[108:111], a[172:175], v[208:211], v[108:111]
    v_fma_f32 v198, v198, s21, v236
    v_fma_f32 v199, v199, s21, v236
    v_mfma_f32_16x16x32_bf16 v[108:111], a[204:207], v[212:215], v[108:111]
    v_exp_f32 v192, v192
    v_mfma_f32_16x16x32_bf16 v[112:115], a[208:211], v[212:215], v[112:115]
    v_exp_f32 v193, v193
    v_mfma_f32_16x16x32_bf16 v[112:115], a[176:179], v[208:211], v[112:115]
    v_exp_f32 v194, v194
    v_mfma_f32_16x16x32_bf16 v[116:119], a[180:183], v[208:211], v[116:119]
    v_exp_f32 v195, v195
    v_mfma_f32_16x16x32_bf16 v[116:119], a[212:215], v[212:215], v[116:119]
    v_exp_f32 v196, v196
    v_mfma_f32_16x16x32_bf16 v[120:123], a[216:219], v[212:215], v[120:123]
    v_exp_f32 v197, v197
    v_mfma_f32_16x16x32_bf16 v[120:123], a[184:187], v[208:211], v[120:123]
    v_exp_f32 v198, v198
    v_mfma_f32_16x16x32_bf16 v[124:127], a[188:191], v[208:211], v[124:127]
    v_exp_f32 v199, v199
    v_mfma_f32_16x16x32_bf16 v[124:127], a[220:223], v[212:215], v[124:127]
    v_cvt_pk_bf16_f32 v252, v192, v193
    v_cvt_pk_bf16_f32 v253, v194, v195
    v_mfma_f32_16x16x32_bf16 v[200:203], a[96:99], a[80:83], 0
    v_cvt_pk_bf16_f32 v254, v196, v197
    v_cvt_pk_bf16_f32 v255, v198, v199
    v_mfma_f32_16x16x32_bf16 v[200:203], a[100:103], a[84:87], v[200:203]
    v_mfma_f32_16x16x32_bf16 v[200:203], a[104:107], a[88:91], v[200:203]
    v_mfma_f32_16x16x32_bf16 v[200:203], a[108:111], a[92:95], v[200:203]
    v_mfma_f32_16x16x32_bf16 v[204:207], a[124:127], a[92:95], 0
    v_mfma_f32_16x16x32_bf16 v[204:207], a[120:123], a[88:91], v[204:207]
    v_mfma_f32_16x16x32_bf16 v[204:207], a[116:119], a[84:87], v[204:207]
    v_mfma_f32_16x16x32_bf16 v[204:207], a[112:115], a[80:83], v[204:207]
    v_mfma_f32_16x16x32_bf16 v[224:227], a[128:131], a[80:83], 0
    s_waitcnt vmcnt(8)
    v_mfma_f32_16x16x32_bf16 v[224:227], a[132:135], a[84:87], v[224:227]
    s_barrier
    v_mfma_f32_16x16x32_bf16 v[224:227], a[136:139], a[88:91], v[224:227]
    ds_read_b128 a[96:99], v246 offset:50688
    ds_read_b128 a[100:103], v246 offset:50752
    v_mfma_f32_16x16x32_bf16 v[224:227], a[140:143], a[92:95], v[224:227]
    v_fma_f32 v200, v200, s21, v237
    v_fma_f32 v201, v201, s21, v237
    v_mfma_f32_16x16x32_bf16 v[228:231], a[156:159], a[92:95], 0
    ds_read_b128 a[104:107], v246 offset:50816
    ds_read_b128 a[108:111], v246 offset:50880
    v_mfma_f32_16x16x32_bf16 v[228:231], a[152:155], a[88:91], v[228:231]
    v_fma_f32 v202, v202, s21, v237
    v_fma_f32 v203, v203, s21, v237
    v_mfma_f32_16x16x32_bf16 v[228:231], a[148:151], a[84:87], v[228:231]
    ds_read_b128 a[124:127], v246 offset:51392
    ds_read_b128 a[128:131], v246 offset:0
    v_mfma_f32_16x16x32_bf16 v[228:231], a[144:147], a[80:83], v[228:231]
    v_exp_f32 v200, v200
    v_mfma_f32_16x16x32_bf16 a[244:247], a[224:227], v[240:243], a[244:247]
    ds_read_b128 a[120:123], v246 offset:51328
    ds_read_b128 a[132:135], v246 offset:64
    v_mfma_f32_16x16x32_bf16 a[244:247], a[224:227], v[252:255], a[244:247]
    v_exp_f32 v201, v201
    v_mfma_f32_16x16x32_bf16 v[128:131], a[192:195], v[252:255], v[128:131]
    ds_read_b128 a[116:119], v246 offset:51264
    ds_read_b128 a[136:139], v246 offset:128
    v_mfma_f32_16x16x32_bf16 v[128:131], a[160:163], v[240:243], v[128:131]
    v_exp_f32 v202, v202
    v_mfma_f32_16x16x32_bf16 v[132:135], a[164:167], v[240:243], v[132:135]
    ds_read_b128 a[112:115], v246 offset:51200
    ds_read_b128 a[140:143], v246 offset:192
    v_mfma_f32_16x16x32_bf16 v[132:135], a[196:199], v[252:255], v[132:135]
    v_exp_f32 v203, v203
    v_mfma_f32_16x16x32_bf16 v[136:139], a[200:203], v[252:255], v[136:139]
    ds_read_b128 a[156:159], v246 offset:704
    ds_read_b128 a[152:155], v246 offset:640
    v_mfma_f32_16x16x32_bf16 v[136:139], a[168:171], v[240:243], v[136:139]
    s_add_u32 m0, s27, 67584
    v_cvt_pk_bf16_f32 v208, v200, v201
    v_cvt_pk_bf16_f32 v209, v202, v203
    v_mfma_f32_16x16x32_bf16 v[140:143], a[172:175], v[240:243], v[140:143]
    buffer_load_dwordx4 v248, s[8:11], s24 offen nt lds
    v_mfma_f32_16x16x32_bf16 v[140:143], a[204:207], v[252:255], v[140:143]
    s_add_u32 m0, s27, 67616
    ds_read_b128 a[148:151], v246 offset:576
    ds_read_b128 a[144:147], v246 offset:512
    v_mfma_f32_16x16x32_bf16 v[144:147], a[208:211], v[252:255], v[144:147]
    buffer_load_dwordx4 v248, s[8:11], s24 offen offset:1024 nt lds
    v_mfma_f32_16x16x32_bf16 v[144:147], a[176:179], v[240:243], v[144:147]
    s_add_u32 m0, s27, 67648
    v_fma_f32 v204, v204, s21, v237
    v_fma_f32 v205, v205, s21, v237
    v_mfma_f32_16x16x32_bf16 v[148:151], a[180:183], v[240:243], v[148:151]
    buffer_load_dwordx4 v248, s[8:11], s24 offen offset:2048 nt lds
    v_mfma_f32_16x16x32_bf16 v[148:151], a[212:215], v[252:255], v[148:151]
    s_add_u32 m0, s27, 67680
    v_fma_f32 v206, v206, s21, v237
    v_fma_f32 v207, v207, s21, v237
    v_mfma_f32_16x16x32_bf16 v[152:155], a[216:219], v[252:255], v[152:155]
    buffer_load_dwordx4 v248, s[8:11], s24 offen offset:3072 nt lds
    v_mfma_f32_16x16x32_bf16 v[152:155], a[184:187], v[240:243], v[152:155]
    s_waitcnt lgkmcnt(5)
    v_exp_f32 v204, v204
    v_mfma_f32_16x16x32_bf16 v[156:159], a[188:191], v[240:243], v[156:159]
    s_add_u32 s24, s24, 8192
    v_exp_f32 v205, v205
    v_mfma_f32_16x16x32_bf16 v[156:159], a[220:223], v[252:255], v[156:159]
    v_exp_f32 v206, v206
    v_mfma_f32_16x16x32_bf16 v[192:195], a[96:99], a[0:3], 0
    v_exp_f32 v207, v207
    v_mfma_f32_16x16x32_bf16 v[192:195], a[100:103], a[4:7], v[192:195]
    v_cvt_pk_bf16_f32 v210, v204, v205
    v_cvt_pk_bf16_f32 v211, v206, v207
    v_mfma_f32_16x16x32_bf16 v[192:195], a[104:107], a[8:11], v[192:195]
    v_fma_f32 v224, v224, s21, v237
    v_fma_f32 v225, v225, s21, v237
    v_mfma_f32_16x16x32_bf16 v[192:195], a[108:111], a[12:15], v[192:195]
    v_fma_f32 v226, v226, s21, v237
    v_fma_f32 v227, v227, s21, v237
    v_mfma_f32_16x16x32_bf16 v[196:199], a[124:127], a[12:15], 0
    v_fma_f32 v228, v228, s21, v237
    v_fma_f32 v229, v229, s21, v237
    v_mfma_f32_16x16x32_bf16 v[196:199], a[120:123], a[8:11], v[196:199]
    s_waitcnt lgkmcnt(0)
    v_fma_f32 v230, v230, s21, v237
    v_fma_f32 v231, v231, s21, v237
    v_mfma_f32_16x16x32_bf16 v[196:199], a[116:119], a[4:7], v[196:199]
    v_exp_f32 v224, v224
    v_mfma_f32_16x16x32_bf16 v[196:199], a[112:115], a[0:3], v[196:199]
    v_exp_f32 v225, v225
    v_mfma_f32_16x16x32_bf16 v[200:203], a[128:131], a[0:3], 0
    v_exp_f32 v226, v226
    v_mfma_f32_16x16x32_bf16 v[200:203], a[132:135], a[4:7], v[200:203]
    v_exp_f32 v227, v227
    v_mfma_f32_16x16x32_bf16 v[200:203], a[136:139], a[8:11], v[200:203]
    v_exp_f32 v228, v228
    v_mfma_f32_16x16x32_bf16 v[200:203], a[140:143], a[12:15], v[200:203]
    v_exp_f32 v229, v229
    v_mfma_f32_16x16x32_bf16 v[204:207], a[156:159], a[12:15], 0
    v_exp_f32 v230, v230
    v_mfma_f32_16x16x32_bf16 v[204:207], a[152:155], a[8:11], v[204:207]
    v_exp_f32 v231, v231
    v_mfma_f32_16x16x32_bf16 v[204:207], a[148:151], a[4:7], v[204:207]
    v_cvt_pk_bf16_f32 v212, v224, v225
    v_cvt_pk_bf16_f32 v213, v226, v227
    v_mfma_f32_16x16x32_bf16 v[204:207], a[144:147], a[0:3], v[204:207]
    v_cvt_pk_bf16_f32 v214, v228, v229
    v_cvt_pk_bf16_f32 v215, v230, v231
    v_mfma_f32_16x16x32_bf16 a[248:251], a[224:227], v[208:211], a[248:251]
    v_fma_f32 v192, v192, s21, v232
    v_fma_f32 v193, v193, s21, v232
    v_mfma_f32_16x16x32_bf16 a[248:251], a[224:227], v[212:215], a[248:251]
    v_fma_f32 v194, v194, s21, v232
    v_fma_f32 v195, v195, s21, v232
    v_mfma_f32_16x16x32_bf16 v[160:163], a[192:195], v[212:215], v[160:163]
    ds_read_b64_tr_b16 a[192:193], v247 offset:8448
    ds_read_b64_tr_b16 a[194:195], v247 offset:8960
    v_mfma_f32_16x16x32_bf16 v[160:163], a[160:163], v[208:211], v[160:163]
    v_exp_f32 v192, v192
    v_mfma_f32_16x16x32_bf16 v[164:167], a[164:167], v[208:211], v[164:167]
    ds_read_b64_tr_b16 a[160:161], v247 offset:59136
    ds_read_b64_tr_b16 a[162:163], v247 offset:59648
    v_mfma_f32_16x16x32_bf16 v[164:167], a[196:199], v[212:215], v[164:167]
    v_exp_f32 v193, v193
    v_mfma_f32_16x16x32_bf16 v[168:171], a[200:203], v[212:215], v[168:171]
    ds_read_b64_tr_b16 a[164:165], v247 offset:59144
    ds_read_b64_tr_b16 a[166:167], v247 offset:59656
    v_mfma_f32_16x16x32_bf16 v[168:171], a[168:171], v[208:211], v[168:171]
    v_exp_f32 v194, v194
    v_mfma_f32_16x16x32_bf16 v[172:175], a[172:175], v[208:211], v[172:175]
    ds_read_b64_tr_b16 a[196:197], v247 offset:8456
    ds_read_b64_tr_b16 a[198:199], v247 offset:8968
    v_mfma_f32_16x16x32_bf16 v[172:175], a[204:207], v[212:215], v[172:175]
    v_exp_f32 v195, v195
    v_mfma_f32_16x16x32_bf16 v[176:179], a[208:211], v[212:215], v[176:179]
    ds_read_b64_tr_b16 a[168:169], v247 offset:59200
    ds_read_b64_tr_b16 a[170:171], v247 offset:59712
    v_mfma_f32_16x16x32_bf16 v[176:179], a[176:179], v[208:211], v[176:179]
    v_cvt_pk_bf16_f32 v240, v192, v193
    v_cvt_pk_bf16_f32 v241, v194, v195
    v_mfma_f32_16x16x32_bf16 v[180:183], a[180:183], v[208:211], v[180:183]
    ds_read_b64_tr_b16 a[200:201], v247 offset:8512
    ds_read_b64_tr_b16 a[202:203], v247 offset:9024
    v_mfma_f32_16x16x32_bf16 v[180:183], a[212:215], v[212:215], v[180:183]
    v_fma_f32 v196, v196, s21, v232
    v_fma_f32 v197, v197, s21, v232
    v_mfma_f32_16x16x32_bf16 v[184:187], a[216:219], v[212:215], v[184:187]
    ds_read_b64_tr_b16 a[172:173], v247 offset:59208
    ds_read_b64_tr_b16 a[174:175], v247 offset:59720
    v_mfma_f32_16x16x32_bf16 v[184:187], a[184:187], v[208:211], v[184:187]
    v_fma_f32 v198, v198, s21, v232
    v_fma_f32 v199, v199, s21, v232
    v_mfma_f32_16x16x32_bf16 v[188:191], a[188:191], v[208:211], v[188:191]
    ds_read_b64_tr_b16 a[204:205], v247 offset:8520
    ds_read_b64_tr_b16 a[206:207], v247 offset:9032
    v_mfma_f32_16x16x32_bf16 v[188:191], a[220:223], v[212:215], v[188:191]
    v_exp_f32 v196, v196
    v_mfma_f32_16x16x32_bf16 v[224:227], a[96:99], a[16:19], 0
    ds_read_b64_tr_b16 a[176:177], v247 offset:59264
    ds_read_b64_tr_b16 a[178:179], v247 offset:59776
    v_mfma_f32_16x16x32_bf16 v[224:227], a[100:103], a[20:23], v[224:227]
    v_exp_f32 v197, v197
    v_mfma_f32_16x16x32_bf16 v[224:227], a[104:107], a[24:27], v[224:227]
    ds_read_b64_tr_b16 a[208:209], v247 offset:8576
    ds_read_b64_tr_b16 a[210:211], v247 offset:9088
    v_mfma_f32_16x16x32_bf16 v[224:227], a[108:111], a[28:31], v[224:227]
    v_exp_f32 v198, v198
    v_mfma_f32_16x16x32_bf16 v[228:231], a[124:127], a[28:31], 0
    v_exp_f32 v199, v199
    v_mfma_f32_16x16x32_bf16 v[228:231], a[120:123], a[24:27], v[228:231]
    v_cvt_pk_bf16_f32 v242, v196, v197
    v_cvt_pk_bf16_f32 v243, v198, v199
    v_mfma_f32_16x16x32_bf16 v[228:231], a[116:119], a[20:23], v[228:231]
    ds_read_b64_tr_b16 a[180:181], v247 offset:59272
    ds_read_b64_tr_b16 a[182:183], v247 offset:59784
    v_mfma_f32_16x16x32_bf16 v[228:231], a[112:115], a[16:19], v[228:231]
    v_fma_f32 v200, v200, s21, v232
    v_fma_f32 v201, v201, s21, v232
    v_mfma_f32_16x16x32_bf16 v[192:195], a[128:131], a[16:19], 0
    v_fma_f32 v202, v202, s21, v232
    v_fma_f32 v203, v203, s21, v232
    v_mfma_f32_16x16x32_bf16 v[192:195], a[132:135], a[20:23], v[192:195]
    v_fma_f32 v204, v204, s21, v232
    v_fma_f32 v205, v205, s21, v232
    v_mfma_f32_16x16x32_bf16 v[192:195], a[136:139], a[24:27], v[192:195]
    v_fma_f32 v206, v206, s21, v232
    v_fma_f32 v207, v207, s21, v232
    v_mfma_f32_16x16x32_bf16 v[192:195], a[140:143], a[28:31], v[192:195]
    ds_read_b64_tr_b16 a[212:213], v247 offset:8584
    ds_read_b64_tr_b16 a[214:215], v247 offset:9096
    v_mfma_f32_16x16x32_bf16 v[196:199], a[156:159], a[28:31], 0
    v_exp_f32 v200, v200
    v_mfma_f32_16x16x32_bf16 v[196:199], a[152:155], a[24:27], v[196:199]
    v_exp_f32 v201, v201
    v_mfma_f32_16x16x32_bf16 v[196:199], a[148:151], a[20:23], v[196:199]
    v_exp_f32 v202, v202
    v_exp_f32 v203, v203
    v_exp_f32 v204, v204
    v_exp_f32 v205, v205
    v_exp_f32 v206, v206
    v_exp_f32 v207, v207
    v_mfma_f32_16x16x32_bf16 v[196:199], a[144:147], a[16:19], v[196:199]
    s_waitcnt lgkmcnt(15)
    ds_read_b64_tr_b16 a[184:185], v247 offset:59328
    v_cvt_pk_bf16_f32 v252, v200, v201
    v_cvt_pk_bf16_f32 v253, v202, v203
    v_cvt_pk_bf16_f32 v254, v204, v205
    v_cvt_pk_bf16_f32 v255, v206, v207
    v_mfma_f32_16x16x32_bf16 a[228:231], a[224:227], v[240:243], a[228:231]
    ds_read_b64_tr_b16 a[186:187], v247 offset:59840
    v_fma_f32 v224, v224, s21, v233
    v_mfma_f32_16x16x32_bf16 a[228:231], a[224:227], v[252:255], a[228:231]
    ds_read_b64_tr_b16 a[216:217], v247 offset:8640
    v_fma_f32 v225, v225, s21, v233
    v_mfma_f32_16x16x32_bf16 v[0:3], a[192:195], v[252:255], v[0:3]
    ds_read_b64_tr_b16 a[218:219], v247 offset:9152
    v_fma_f32 v226, v226, s21, v233
    v_mfma_f32_16x16x32_bf16 v[0:3], a[160:163], v[240:243], v[0:3]
    s_waitcnt lgkmcnt(12)
    ds_read_b64_tr_b16 a[188:189], v247 offset:59336
    v_fma_f32 v227, v227, s21, v233
    v_mfma_f32_16x16x32_bf16 v[4:7], a[164:167], v[240:243], v[4:7]
    ds_read_b64_tr_b16 a[190:191], v247 offset:59848
    v_fma_f32 v228, v228, s21, v233
    v_mfma_f32_16x16x32_bf16 v[4:7], a[196:199], v[252:255], v[4:7]
    ds_read_b64_tr_b16 a[220:221], v247 offset:8648
    v_fma_f32 v229, v229, s21, v233
    v_mfma_f32_16x16x32_bf16 v[8:11], a[200:203], v[252:255], v[8:11]
    ds_read_b64_tr_b16 a[222:223], v247 offset:9160
    v_subrev_u32 v247, 16896, v247
    v_mfma_f32_16x16x32_bf16 v[8:11], a[168:171], v[240:243], v[8:11]
    s_waitcnt lgkmcnt(8)
    v_exp_f32 v224, v224
    v_mfma_f32_16x16x32_bf16 v[12:15], a[172:175], v[240:243], v[12:15]
    v_exp_f32 v225, v225
    v_mfma_f32_16x16x32_bf16 v[12:15], a[204:207], v[252:255], v[12:15]
    v_exp_f32 v226, v226
    v_mfma_f32_16x16x32_bf16 v[16:19], a[208:211], v[252:255], v[16:19]
    v_exp_f32 v227, v227
    v_mfma_f32_16x16x32_bf16 v[16:19], a[176:179], v[240:243], v[16:19]
    v_cvt_pk_bf16_f32 v208, v224, v225
    v_cvt_pk_bf16_f32 v209, v226, v227
    v_mfma_f32_16x16x32_bf16 v[20:23], a[180:183], v[240:243], v[20:23]
    v_fma_f32 v230, v230, s21, v233
    v_fma_f32 v231, v231, s21, v233
    v_mfma_f32_16x16x32_bf16 v[20:23], a[212:215], v[252:255], v[20:23]
    s_waitcnt lgkmcnt(0)
    v_exp_f32 v228, v228
    v_mfma_f32_16x16x32_bf16 v[24:27], a[216:219], v[252:255], v[24:27]
    v_exp_f32 v229, v229
    v_mfma_f32_16x16x32_bf16 v[24:27], a[184:187], v[240:243], v[24:27]
    v_exp_f32 v230, v230
    v_mfma_f32_16x16x32_bf16 v[28:31], a[188:191], v[240:243], v[28:31]
    v_exp_f32 v231, v231
    v_mfma_f32_16x16x32_bf16 v[28:31], a[220:223], v[252:255], v[28:31]
    s_waitcnt lgkmcnt(0)
    v_cvt_pk_bf16_f32 v210, v228, v229
    v_cvt_pk_bf16_f32 v211, v230, v231
    v_mfma_f32_16x16x32_bf16 v[200:203], a[96:99], a[32:35], 0
    s_barrier
    v_mfma_f32_16x16x32_bf16 v[200:203], a[100:103], a[36:39], v[200:203]
    v_fma_f32 v192, v192, s21, v233
    v_fma_f32 v193, v193, s21, v233
    v_mfma_f32_16x16x32_bf16 v[200:203], a[104:107], a[40:43], v[200:203]
    v_fma_f32 v194, v194, s21, v233
    v_fma_f32 v195, v195, s21, v233
    v_mfma_f32_16x16x32_bf16 v[200:203], a[108:111], a[44:47], v[200:203]
    v_fma_f32 v196, v196, s21, v233
    v_fma_f32 v197, v197, s21, v233
    v_mfma_f32_16x16x32_bf16 v[204:207], a[124:127], a[44:47], 0
    v_fma_f32 v198, v198, s21, v233
    v_fma_f32 v199, v199, s21, v233
    v_mfma_f32_16x16x32_bf16 v[204:207], a[120:123], a[40:43], v[204:207]
    v_exp_f32 v192, v192
    v_mfma_f32_16x16x32_bf16 v[204:207], a[116:119], a[36:39], v[204:207]
    s_add_u32 m0, s27, 84480
    v_exp_f32 v193, v193
    v_mfma_f32_16x16x32_bf16 v[204:207], a[112:115], a[32:35], v[204:207]
    buffer_load_dwordx4 v248, s[8:11], s24 offen nt lds
    v_mfma_f32_16x16x32_bf16 v[224:227], a[128:131], a[32:35], 0
    s_add_u32 m0, s27, 84512
    v_exp_f32 v194, v194
    v_mfma_f32_16x16x32_bf16 v[224:227], a[132:135], a[36:39], v[224:227]
    v_exp_f32 v195, v195
    v_mfma_f32_16x16x32_bf16 v[224:227], a[136:139], a[40:43], v[224:227]
    v_exp_f32 v196, v196
    v_mfma_f32_16x16x32_bf16 v[224:227], a[140:143], a[44:47], v[224:227]
    v_exp_f32 v197, v197
    v_mfma_f32_16x16x32_bf16 v[228:231], a[156:159], a[44:47], 0
    v_exp_f32 v198, v198
    v_mfma_f32_16x16x32_bf16 v[228:231], a[152:155], a[40:43], v[228:231]
    v_exp_f32 v199, v199
    v_mfma_f32_16x16x32_bf16 v[228:231], a[148:151], a[36:39], v[228:231]
    v_cvt_pk_bf16_f32 v212, v192, v193
    v_cvt_pk_bf16_f32 v213, v194, v195
    v_mfma_f32_16x16x32_bf16 v[228:231], a[144:147], a[32:35], v[228:231]
    v_cvt_pk_bf16_f32 v214, v196, v197
    v_cvt_pk_bf16_f32 v215, v198, v199
    v_mfma_f32_16x16x32_bf16 a[232:235], a[224:227], v[208:211], a[232:235]
    buffer_load_dwordx4 v248, s[8:11], s24 offen offset:1024 nt lds
    v_mfma_f32_16x16x32_bf16 a[232:235], a[224:227], v[212:215], a[232:235]
    s_add_u32 m0, s27, 84544
    v_fma_f32 v200, v200, s21, v234
    v_fma_f32 v201, v201, s21, v234
    v_mfma_f32_16x16x32_bf16 v[32:35], a[192:195], v[212:215], v[32:35]
    buffer_load_dwordx4 v248, s[8:11], s24 offen offset:2048 nt lds
    v_mfma_f32_16x16x32_bf16 v[32:35], a[160:163], v[208:211], v[32:35]
    s_add_u32 m0, s27, 84576
    v_fma_f32 v202, v202, s21, v234
    v_fma_f32 v203, v203, s21, v234
    v_mfma_f32_16x16x32_bf16 v[36:39], a[164:167], v[208:211], v[36:39]
    buffer_load_dwordx4 v248, s[8:11], s24 offen offset:3072 nt lds
    v_mfma_f32_16x16x32_bf16 v[36:39], a[196:199], v[212:215], v[36:39]
    s_add_u32 s24, s24, 8192
    v_exp_f32 v200, v200
    v_mfma_f32_16x16x32_bf16 v[40:43], a[200:203], v[212:215], v[40:43]
    v_exp_f32 v201, v201
    v_mfma_f32_16x16x32_bf16 v[40:43], a[168:171], v[208:211], v[40:43]
    v_exp_f32 v202, v202
    v_mfma_f32_16x16x32_bf16 v[44:47], a[172:175], v[208:211], v[44:47]
    v_exp_f32 v203, v203
    v_mfma_f32_16x16x32_bf16 v[44:47], a[204:207], v[212:215], v[44:47]
    v_cvt_pk_bf16_f32 v240, v200, v201
    v_cvt_pk_bf16_f32 v241, v202, v203
    v_mfma_f32_16x16x32_bf16 v[48:51], a[208:211], v[212:215], v[48:51]
    v_fma_f32 v204, v204, s21, v234
    v_fma_f32 v205, v205, s21, v234
    v_mfma_f32_16x16x32_bf16 v[48:51], a[176:179], v[208:211], v[48:51]
    v_fma_f32 v206, v206, s21, v234
    v_fma_f32 v207, v207, s21, v234
    v_mfma_f32_16x16x32_bf16 v[52:55], a[180:183], v[208:211], v[52:55]
    v_exp_f32 v204, v204
    v_mfma_f32_16x16x32_bf16 v[52:55], a[212:215], v[212:215], v[52:55]
    v_exp_f32 v205, v205
    v_mfma_f32_16x16x32_bf16 v[56:59], a[216:219], v[212:215], v[56:59]
    v_exp_f32 v206, v206
    v_mfma_f32_16x16x32_bf16 v[56:59], a[184:187], v[208:211], v[56:59]
    v_exp_f32 v207, v207
    v_mfma_f32_16x16x32_bf16 v[60:63], a[188:191], v[208:211], v[60:63]
    v_cvt_pk_bf16_f32 v242, v204, v205
    v_cvt_pk_bf16_f32 v243, v206, v207
    v_mfma_f32_16x16x32_bf16 v[60:63], a[220:223], v[212:215], v[60:63]
    v_fma_f32 v224, v224, s21, v234
    v_fma_f32 v225, v225, s21, v234
    v_mfma_f32_16x16x32_bf16 v[192:195], a[96:99], a[48:51], 0
    v_fma_f32 v226, v226, s21, v234
    v_fma_f32 v227, v227, s21, v234
    v_mfma_f32_16x16x32_bf16 v[192:195], a[100:103], a[52:55], v[192:195]
    v_fma_f32 v228, v228, s21, v234
    v_fma_f32 v229, v229, s21, v234
    v_mfma_f32_16x16x32_bf16 v[192:195], a[104:107], a[56:59], v[192:195]
    v_fma_f32 v230, v230, s21, v234
    v_fma_f32 v231, v231, s21, v234
    v_mfma_f32_16x16x32_bf16 v[192:195], a[108:111], a[60:63], v[192:195]
    v_exp_f32 v224, v224
    v_mfma_f32_16x16x32_bf16 v[196:199], a[124:127], a[60:63], 0
    v_exp_f32 v225, v225
    v_mfma_f32_16x16x32_bf16 v[196:199], a[120:123], a[56:59], v[196:199]
    v_exp_f32 v226, v226
    v_mfma_f32_16x16x32_bf16 v[196:199], a[116:119], a[52:55], v[196:199]
    v_exp_f32 v227, v227
    v_mfma_f32_16x16x32_bf16 v[196:199], a[112:115], a[48:51], v[196:199]
    v_exp_f32 v228, v228
    v_mfma_f32_16x16x32_bf16 v[200:203], a[128:131], a[48:51], 0
    v_exp_f32 v229, v229
    v_mfma_f32_16x16x32_bf16 v[200:203], a[132:135], a[52:55], v[200:203]
    v_exp_f32 v230, v230
    v_mfma_f32_16x16x32_bf16 v[200:203], a[136:139], a[56:59], v[200:203]
    v_exp_f32 v231, v231
    v_mfma_f32_16x16x32_bf16 v[200:203], a[140:143], a[60:63], v[200:203]
    v_cvt_pk_bf16_f32 v252, v224, v225
    v_cvt_pk_bf16_f32 v253, v226, v227
    v_mfma_f32_16x16x32_bf16 v[204:207], a[156:159], a[60:63], 0
    v_cvt_pk_bf16_f32 v254, v228, v229
    v_cvt_pk_bf16_f32 v255, v230, v231
    v_mfma_f32_16x16x32_bf16 v[204:207], a[152:155], a[56:59], v[204:207]
    v_fma_f32 v192, v192, s21, v235
    v_fma_f32 v193, v193, s21, v235
    v_mfma_f32_16x16x32_bf16 v[204:207], a[148:151], a[52:55], v[204:207]
    v_fma_f32 v194, v194, s21, v235
    v_fma_f32 v195, v195, s21, v235
    v_mfma_f32_16x16x32_bf16 v[204:207], a[144:147], a[48:51], v[204:207]
    v_exp_f32 v192, v192
    v_mfma_f32_16x16x32_bf16 a[236:239], a[224:227], v[240:243], a[236:239]
    v_exp_f32 v193, v193
    v_mfma_f32_16x16x32_bf16 a[236:239], a[224:227], v[252:255], a[236:239]
    v_exp_f32 v194, v194
    v_mfma_f32_16x16x32_bf16 v[64:67], a[192:195], v[252:255], v[64:67]
    v_exp_f32 v195, v195
    v_mfma_f32_16x16x32_bf16 v[64:67], a[160:163], v[240:243], v[64:67]
    v_cvt_pk_bf16_f32 v208, v192, v193
    v_cvt_pk_bf16_f32 v209, v194, v195
    v_mfma_f32_16x16x32_bf16 v[68:71], a[164:167], v[240:243], v[68:71]
    v_fma_f32 v196, v196, s21, v235
    v_fma_f32 v197, v197, s21, v235
    v_mfma_f32_16x16x32_bf16 v[68:71], a[196:199], v[252:255], v[68:71]
    v_fma_f32 v198, v198, s21, v235
    v_fma_f32 v199, v199, s21, v235
    v_mfma_f32_16x16x32_bf16 v[72:75], a[200:203], v[252:255], v[72:75]
    v_exp_f32 v196, v196
    v_mfma_f32_16x16x32_bf16 v[72:75], a[168:171], v[240:243], v[72:75]
    v_exp_f32 v197, v197
    v_mfma_f32_16x16x32_bf16 v[76:79], a[172:175], v[240:243], v[76:79]
    v_exp_f32 v198, v198
    v_mfma_f32_16x16x32_bf16 v[76:79], a[204:207], v[252:255], v[76:79]
    v_exp_f32 v199, v199
    v_mfma_f32_16x16x32_bf16 v[80:83], a[208:211], v[252:255], v[80:83]
    v_cvt_pk_bf16_f32 v210, v196, v197
    v_cvt_pk_bf16_f32 v211, v198, v199
    v_mfma_f32_16x16x32_bf16 v[80:83], a[176:179], v[240:243], v[80:83]
    v_fma_f32 v200, v200, s21, v235
    v_fma_f32 v201, v201, s21, v235
    v_mfma_f32_16x16x32_bf16 v[84:87], a[180:183], v[240:243], v[84:87]
    v_fma_f32 v202, v202, s21, v235
    v_fma_f32 v203, v203, s21, v235
    v_mfma_f32_16x16x32_bf16 v[84:87], a[212:215], v[252:255], v[84:87]
    v_fma_f32 v204, v204, s21, v235
    v_fma_f32 v205, v205, s21, v235
    v_mfma_f32_16x16x32_bf16 v[88:91], a[216:219], v[252:255], v[88:91]
    v_fma_f32 v206, v206, s21, v235
    v_fma_f32 v207, v207, s21, v235
    v_mfma_f32_16x16x32_bf16 v[88:91], a[184:187], v[240:243], v[88:91]
    v_exp_f32 v200, v200
    v_mfma_f32_16x16x32_bf16 v[92:95], a[188:191], v[240:243], v[92:95]
    v_exp_f32 v201, v201
    v_mfma_f32_16x16x32_bf16 v[92:95], a[220:223], v[252:255], v[92:95]
    v_exp_f32 v202, v202
    v_mfma_f32_16x16x32_bf16 v[224:227], a[96:99], a[64:67], 0
    v_exp_f32 v203, v203
    v_mfma_f32_16x16x32_bf16 v[224:227], a[100:103], a[68:71], v[224:227]
    v_exp_f32 v204, v204
    v_mfma_f32_16x16x32_bf16 v[224:227], a[104:107], a[72:75], v[224:227]
    v_exp_f32 v205, v205
    v_mfma_f32_16x16x32_bf16 v[224:227], a[108:111], a[76:79], v[224:227]
    v_exp_f32 v206, v206
    v_mfma_f32_16x16x32_bf16 v[228:231], a[124:127], a[76:79], 0
    v_exp_f32 v207, v207
    v_mfma_f32_16x16x32_bf16 v[228:231], a[120:123], a[72:75], v[228:231]
    v_cvt_pk_bf16_f32 v212, v200, v201
    v_cvt_pk_bf16_f32 v213, v202, v203
    v_mfma_f32_16x16x32_bf16 v[228:231], a[116:119], a[68:71], v[228:231]
    v_cvt_pk_bf16_f32 v214, v204, v205
    v_cvt_pk_bf16_f32 v215, v206, v207
    v_mfma_f32_16x16x32_bf16 v[228:231], a[112:115], a[64:67], v[228:231]
    v_fma_f32 v224, v224, s21, v236
    v_fma_f32 v225, v225, s21, v236
    v_mfma_f32_16x16x32_bf16 v[192:195], a[128:131], a[64:67], 0
    v_fma_f32 v226, v226, s21, v236
    v_fma_f32 v227, v227, s21, v236
    v_mfma_f32_16x16x32_bf16 v[192:195], a[132:135], a[68:71], v[192:195]
    v_exp_f32 v224, v224
    v_mfma_f32_16x16x32_bf16 v[192:195], a[136:139], a[72:75], v[192:195]
    v_exp_f32 v225, v225
    v_mfma_f32_16x16x32_bf16 v[192:195], a[140:143], a[76:79], v[192:195]
    v_exp_f32 v226, v226
    v_mfma_f32_16x16x32_bf16 v[196:199], a[156:159], a[76:79], 0
    v_exp_f32 v227, v227
    v_mfma_f32_16x16x32_bf16 v[196:199], a[152:155], a[72:75], v[196:199]
    v_cvt_pk_bf16_f32 v240, v224, v225
    v_cvt_pk_bf16_f32 v241, v226, v227
    v_mfma_f32_16x16x32_bf16 v[196:199], a[148:151], a[68:71], v[196:199]
    v_fma_f32 v228, v228, s21, v236
    v_fma_f32 v229, v229, s21, v236
    v_mfma_f32_16x16x32_bf16 v[196:199], a[144:147], a[64:67], v[196:199]
    v_fma_f32 v230, v230, s21, v236
    v_fma_f32 v231, v231, s21, v236
    v_mfma_f32_16x16x32_bf16 a[240:243], a[224:227], v[208:211], a[240:243]
    v_exp_f32 v228, v228
    v_mfma_f32_16x16x32_bf16 a[240:243], a[224:227], v[212:215], a[240:243]
    v_exp_f32 v229, v229
    v_mfma_f32_16x16x32_bf16 v[96:99], a[192:195], v[212:215], v[96:99]
    v_exp_f32 v230, v230
    v_mfma_f32_16x16x32_bf16 v[96:99], a[160:163], v[208:211], v[96:99]
    v_exp_f32 v231, v231
    v_mfma_f32_16x16x32_bf16 v[100:103], a[164:167], v[208:211], v[100:103]
    v_cvt_pk_bf16_f32 v242, v228, v229
    v_cvt_pk_bf16_f32 v243, v230, v231
    v_mfma_f32_16x16x32_bf16 v[100:103], a[196:199], v[212:215], v[100:103]
    v_fma_f32 v192, v192, s21, v236
    v_fma_f32 v193, v193, s21, v236
    v_mfma_f32_16x16x32_bf16 v[104:107], a[200:203], v[212:215], v[104:107]
    v_fma_f32 v194, v194, s21, v236
    v_fma_f32 v195, v195, s21, v236
    v_mfma_f32_16x16x32_bf16 v[104:107], a[168:171], v[208:211], v[104:107]
    s_add_u32 m0, s27, 33792
    v_fma_f32 v196, v196, s21, v236
    v_fma_f32 v197, v197, s21, v236
    v_mfma_f32_16x16x32_bf16 v[108:111], a[172:175], v[208:211], v[108:111]
    buffer_load_dwordx4 v248, s[8:11], s24 offen nt lds
    v_mfma_f32_16x16x32_bf16 v[108:111], a[204:207], v[212:215], v[108:111]
    s_add_u32 m0, s27, 33824
    v_fma_f32 v198, v198, s21, v236
    v_fma_f32 v199, v199, s21, v236
    v_mfma_f32_16x16x32_bf16 v[112:115], a[208:211], v[212:215], v[112:115]
    buffer_load_dwordx4 v248, s[8:11], s24 offen offset:1024 nt lds
    v_mfma_f32_16x16x32_bf16 v[112:115], a[176:179], v[208:211], v[112:115]
    s_add_u32 m0, s27, 33856
    v_exp_f32 v192, v192
    v_mfma_f32_16x16x32_bf16 v[116:119], a[180:183], v[208:211], v[116:119]
    buffer_load_dwordx4 v248, s[8:11], s24 offen offset:2048 nt lds
    v_mfma_f32_16x16x32_bf16 v[116:119], a[212:215], v[212:215], v[116:119]
    s_add_u32 m0, s27, 33888
    v_exp_f32 v193, v193
    v_mfma_f32_16x16x32_bf16 v[120:123], a[216:219], v[212:215], v[120:123]
    buffer_load_dwordx4 v248, s[8:11], s24 offen offset:3072 nt lds
    v_mfma_f32_16x16x32_bf16 v[120:123], a[184:187], v[208:211], v[120:123]
    s_add_u32 s24, s24, 8192
    v_exp_f32 v194, v194
    v_mfma_f32_16x16x32_bf16 v[124:127], a[188:191], v[208:211], v[124:127]
    v_exp_f32 v195, v195
    v_mfma_f32_16x16x32_bf16 v[124:127], a[220:223], v[212:215], v[124:127]
    v_exp_f32 v196, v196
    v_mfma_f32_16x16x32_bf16 v[200:203], a[96:99], a[80:83], 0
    v_exp_f32 v197, v197
    v_mfma_f32_16x16x32_bf16 v[200:203], a[100:103], a[84:87], v[200:203]
    v_exp_f32 v198, v198
    v_mfma_f32_16x16x32_bf16 v[200:203], a[104:107], a[88:91], v[200:203]
    v_exp_f32 v199, v199
    v_mfma_f32_16x16x32_bf16 v[200:203], a[108:111], a[92:95], v[200:203]
    v_cvt_pk_bf16_f32 v252, v192, v193
    v_cvt_pk_bf16_f32 v253, v194, v195
    v_mfma_f32_16x16x32_bf16 v[204:207], a[124:127], a[92:95], 0
    v_cvt_pk_bf16_f32 v254, v196, v197
    v_cvt_pk_bf16_f32 v255, v198, v199
    v_mfma_f32_16x16x32_bf16 v[204:207], a[120:123], a[88:91], v[204:207]
Lhop8:
    s_cbranch_execz Lret2
    v_mfma_f32_16x16x32_bf16 v[204:207], a[116:119], a[84:87], v[204:207]
    v_mfma_f32_16x16x32_bf16 v[204:207], a[112:115], a[80:83], v[204:207]
    v_fma_f32 v200, v200, s21, v237
    v_fma_f32 v201, v201, s21, v237
    v_mfma_f32_16x16x32_bf16 v[224:227], a[128:131], a[80:83], 0
    s_waitcnt vmcnt(12)
    v_fma_f32 v202, v202, s21, v237
    v_fma_f32 v203, v203, s21, v237
    v_mfma_f32_16x16x32_bf16 v[224:227], a[132:135], a[84:87], v[224:227]
    s_barrier
    v_mfma_f32_16x16x32_bf16 v[224:227], a[136:139], a[88:91], v[224:227]
    ds_read_b128 a[96:99], v246 offset:16896
    ds_read_b128 a[100:103], v246 offset:16960
    v_mfma_f32_16x16x32_bf16 v[224:227], a[140:143], a[92:95], v[224:227]
    v_exp_f32 v200, v200
    v_mfma_f32_16x16x32_bf16 v[228:231], a[156:159], a[92:95], 0
    ds_read_b128 a[104:107], v246 offset:17024
    ds_read_b128 a[108:111], v246 offset:17088
    v_mfma_f32_16x16x32_bf16 v[228:231], a[152:155], a[88:91], v[228:231]
    v_exp_f32 v201, v201
    v_mfma_f32_16x16x32_bf16 v[228:231], a[148:151], a[84:87], v[228:231]
    ds_read_b128 a[124:127], v246 offset:17600
    ds_read_b128 a[120:123], v246 offset:17536
    v_mfma_f32_16x16x32_bf16 v[228:231], a[144:147], a[80:83], v[228:231]
    v_exp_f32 v202, v202
    v_mfma_f32_16x16x32_bf16 a[244:247], a[224:227], v[240:243], a[244:247]
    ds_read_b128 a[116:119], v246 offset:17472
    ds_read_b128 a[112:115], v246 offset:17408
    v_subrev_u32 v246, 16896, v246
    v_mfma_f32_16x16x32_bf16 a[244:247], a[224:227], v[252:255], a[244:247]
    v_exp_f32 v203, v203
    v_mfma_f32_16x16x32_bf16 v[128:131], a[192:195], v[252:255], v[128:131]
    ds_read_b128 a[128:131], v246 offset:0
    ds_read_b128 a[132:135], v246 offset:64
    v_mfma_f32_16x16x32_bf16 v[128:131], a[160:163], v[240:243], v[128:131]
    v_cvt_pk_bf16_f32 v208, v200, v201
    v_cvt_pk_bf16_f32 v209, v202, v203
    v_mfma_f32_16x16x32_bf16 v[132:135], a[164:167], v[240:243], v[132:135]
    ds_read_b128 a[136:139], v246 offset:128
    ds_read_b128 a[140:143], v246 offset:192
    v_mfma_f32_16x16x32_bf16 v[132:135], a[196:199], v[252:255], v[132:135]
    v_fma_f32 v204, v204, s21, v237
    v_fma_f32 v205, v205, s21, v237
    v_mfma_f32_16x16x32_bf16 v[136:139], a[200:203], v[252:255], v[136:139]
    ds_read_b128 a[156:159], v246 offset:704
    ds_read_b128 a[152:155], v246 offset:640
    v_mfma_f32_16x16x32_bf16 v[136:139], a[168:171], v[240:243], v[136:139]
    v_fma_f32 v206, v206, s21, v237
    v_fma_f32 v207, v207, s21, v237
    v_mfma_f32_16x16x32_bf16 v[140:143], a[172:175], v[240:243], v[140:143]
    ds_read_b128 a[148:151], v246 offset:576
    ds_read_b128 a[144:147], v246 offset:512
    v_mfma_f32_16x16x32_bf16 v[140:143], a[204:207], v[252:255], v[140:143]
    v_exp_f32 v204, v204
    v_mfma_f32_16x16x32_bf16 v[144:147], a[208:211], v[252:255], v[144:147]
    v_exp_f32 v205, v205
    v_mfma_f32_16x16x32_bf16 v[144:147], a[176:179], v[240:243], v[144:147]
    v_exp_f32 v206, v206
    v_mfma_f32_16x16x32_bf16 v[148:151], a[180:183], v[240:243], v[148:151]
    v_exp_f32 v207, v207
    v_mfma_f32_16x16x32_bf16 v[148:151], a[212:215], v[252:255], v[148:151]
    v_cvt_pk_bf16_f32 v210, v204, v205
    v_cvt_pk_bf16_f32 v211, v206, v207
    v_mfma_f32_16x16x32_bf16 v[152:155], a[216:219], v[252:255], v[152:155]
    v_fma_f32 v224, v224, s21, v237
    v_fma_f32 v225, v225, s21, v237
    v_mfma_f32_16x16x32_bf16 v[152:155], a[184:187], v[240:243], v[152:155]
    s_waitcnt lgkmcnt(8)
    v_fma_f32 v226, v226, s21, v237
    v_fma_f32 v227, v227, s21, v237
    v_mfma_f32_16x16x32_bf16 v[156:159], a[188:191], v[240:243], v[156:159]
    v_fma_f32 v228, v228, s21, v237
    v_fma_f32 v229, v229, s21, v237
    v_mfma_f32_16x16x32_bf16 v[156:159], a[220:223], v[252:255], v[156:159]
    v_fma_f32 v230, v230, s21, v237
    v_fma_f32 v231, v231, s21, v237
    v_mfma_f32_16x16x32_bf16 v[192:195], a[96:99], a[0:3], 0
    v_exp_f32 v224, v224
    v_mfma_f32_16x16x32_bf16 v[192:195], a[100:103], a[4:7], v[192:195]
    v_exp_f32 v225, v225
    v_mfma_f32_16x16x32_bf16 v[192:195], a[104:107], a[8:11], v[192:195]
    v_exp_f32 v226, v226
    v_mfma_f32_16x16x32_bf16 v[192:195], a[108:111], a[12:15], v[192:195]
    v_exp_f32 v227, v227
    v_mfma_f32_16x16x32_bf16 v[196:199], a[124:127], a[12:15], 0
    v_exp_f32 v228, v228
    v_mfma_f32_16x16x32_bf16 v[196:199], a[120:123], a[8:11], v[196:199]
    s_waitcnt lgkmcnt(0)
    v_exp_f32 v229, v229
    v_mfma_f32_16x16x32_bf16 v[196:199], a[116:119], a[4:7], v[196:199]
    v_exp_f32 v230, v230
    v_mfma_f32_16x16x32_bf16 v[196:199], a[112:115], a[0:3], v[196:199]
    v_exp_f32 v231, v231
    v_mfma_f32_16x16x32_bf16 v[200:203], a[128:131], a[0:3], 0
    v_cvt_pk_bf16_f32 v212, v224, v225
    v_cvt_pk_bf16_f32 v213, v226, v227
    v_mfma_f32_16x16x32_bf16 v[200:203], a[132:135], a[4:7], v[200:203]
    v_cvt_pk_bf16_f32 v214, v228, v229
    v_cvt_pk_bf16_f32 v215, v230, v231
    v_mfma_f32_16x16x32_bf16 v[200:203], a[136:139], a[8:11], v[200:203]
    v_fma_f32 v192, v192, s21, v232
    v_fma_f32 v193, v193, s21, v232
    v_mfma_f32_16x16x32_bf16 v[200:203], a[140:143], a[12:15], v[200:203]
    v_fma_f32 v194, v194, s21, v232
    v_fma_f32 v195, v195, s21, v232
    v_mfma_f32_16x16x32_bf16 v[204:207], a[156:159], a[12:15], 0
    v_exp_f32 v192, v192
    v_mfma_f32_16x16x32_bf16 v[204:207], a[152:155], a[8:11], v[204:207]
    v_exp_f32 v193, v193
    v_mfma_f32_16x16x32_bf16 v[204:207], a[148:151], a[4:7], v[204:207]
    v_exp_f32 v194, v194
    v_mfma_f32_16x16x32_bf16 v[204:207], a[144:147], a[0:3], v[204:207]
    v_exp_f32 v195, v195
    v_mfma_f32_16x16x32_bf16 a[248:251], a[224:227], v[208:211], a[248:251]
    v_cvt_pk_bf16_f32 v240, v192, v193
    v_cvt_pk_bf16_f32 v241, v194, v195
    v_mfma_f32_16x16x32_bf16 a[248:251], a[224:227], v[212:215], a[248:251]
    v_fma_f32 v196, v196, s21, v232
    v_fma_f32 v197, v197, s21, v232
    v_mfma_f32_16x16x32_bf16 v[160:163], a[192:195], v[212:215], v[160:163]
    ds_read_b64_tr_b16 a[192:193], v247 offset:8448
    ds_read_b64_tr_b16 a[194:195], v247 offset:8960
    v_mfma_f32_16x16x32_bf16 v[160:163], a[160:163], v[208:211], v[160:163]
    v_fma_f32 v198, v198, s21, v232
    v_fma_f32 v199, v199, s21, v232
    v_mfma_f32_16x16x32_bf16 v[164:167], a[164:167], v[208:211], v[164:167]
    ds_read_b64_tr_b16 a[160:161], v247 offset:42240
    ds_read_b64_tr_b16 a[162:163], v247 offset:42752
    v_mfma_f32_16x16x32_bf16 v[164:167], a[196:199], v[212:215], v[164:167]
    v_exp_f32 v196, v196
    v_mfma_f32_16x16x32_bf16 v[168:171], a[200:203], v[212:215], v[168:171]
    ds_read_b64_tr_b16 a[164:165], v247 offset:42248
    ds_read_b64_tr_b16 a[166:167], v247 offset:42760
    v_mfma_f32_16x16x32_bf16 v[168:171], a[168:171], v[208:211], v[168:171]
    v_exp_f32 v197, v197
    v_mfma_f32_16x16x32_bf16 v[172:175], a[172:175], v[208:211], v[172:175]
    ds_read_b64_tr_b16 a[196:197], v247 offset:8456
    ds_read_b64_tr_b16 a[198:199], v247 offset:8968
    v_mfma_f32_16x16x32_bf16 v[172:175], a[204:207], v[212:215], v[172:175]
    v_exp_f32 v198, v198
    v_mfma_f32_16x16x32_bf16 v[176:179], a[208:211], v[212:215], v[176:179]
    ds_read_b64_tr_b16 a[168:169], v247 offset:42304
    ds_read_b64_tr_b16 a[170:171], v247 offset:42816
    v_mfma_f32_16x16x32_bf16 v[176:179], a[176:179], v[208:211], v[176:179]
    v_exp_f32 v199, v199
    v_mfma_f32_16x16x32_bf16 v[180:183], a[180:183], v[208:211], v[180:183]
    ds_read_b64_tr_b16 a[200:201], v247 offset:8512
    ds_read_b64_tr_b16 a[202:203], v247 offset:9024
    v_mfma_f32_16x16x32_bf16 v[180:183], a[212:215], v[212:215], v[180:183]
    v_cvt_pk_bf16_f32 v242, v196, v197
    v_cvt_pk_bf16_f32 v243, v198, v199
    v_mfma_f32_16x16x32_bf16 v[184:187], a[216:219], v[212:215], v[184:187]
    ds_read_b64_tr_b16 a[172:173], v247 offset:42312
    ds_read_b64_tr_b16 a[174:175], v247 offset:42824
    v_mfma_f32_16x16x32_bf16 v[184:187], a[184:187], v[208:211], v[184:187]
    v_fma_f32 v200, v200, s21, v232
    v_fma_f32 v201, v201, s21, v232
    v_mfma_f32_16x16x32_bf16 v[188:191], a[188:191], v[208:211], v[188:191]
    ds_read_b64_tr_b16 a[204:205], v247 offset:8520
    ds_read_b64_tr_b16 a[206:207], v247 offset:9032
    v_mfma_f32_16x16x32_bf16 v[188:191], a[220:223], v[212:215], v[188:191]
    v_fma_f32 v202, v202, s21, v232
    v_fma_f32 v203, v203, s21, v232
    v_mfma_f32_16x16x32_bf16 v[224:227], a[96:99], a[16:19], 0
    ds_read_b64_tr_b16 a[176:177], v247 offset:42368
    ds_read_b64_tr_b16 a[178:179], v247 offset:42880
    v_mfma_f32_16x16x32_bf16 v[224:227], a[100:103], a[20:23], v[224:227]
    v_fma_f32 v204, v204, s21, v232
    v_fma_f32 v205, v205, s21, v232
    v_mfma_f32_16x16x32_bf16 v[224:227], a[104:107], a[24:27], v[224:227]
    ds_read_b64_tr_b16 a[208:209], v247 offset:8576
    ds_read_b64_tr_b16 a[210:211], v247 offset:9088
    v_mfma_f32_16x16x32_bf16 v[224:227], a[108:111], a[28:31], v[224:227]
    v_fma_f32 v206, v206, s21, v232
    v_fma_f32 v207, v207, s21, v232
    v_mfma_f32_16x16x32_bf16 v[228:231], a[124:127], a[28:31], 0
    ds_read_b64_tr_b16 a[180:181], v247 offset:42376
    ds_read_b64_tr_b16 a[182:183], v247 offset:42888
    v_mfma_f32_16x16x32_bf16 v[228:231], a[120:123], a[24:27], v[228:231]
    v_exp_f32 v200, v200
    v_mfma_f32_16x16x32_bf16 v[228:231], a[116:119], a[20:23], v[228:231]
    ds_read_b64_tr_b16 a[212:213], v247 offset:8584
    ds_read_b64_tr_b16 a[214:215], v247 offset:9096
    v_mfma_f32_16x16x32_bf16 v[228:231], a[112:115], a[16:19], v[228:231]
    v_exp_f32 v201, v201
    v_mfma_f32_16x16x32_bf16 v[192:195], a[128:131], a[16:19], 0
    v_exp_f32 v202, v202
    v_mfma_f32_16x16x32_bf16 v[192:195], a[132:135], a[20:23], v[192:195]
    v_exp_f32 v203, v203
    v_mfma_f32_16x16x32_bf16 v[192:195], a[136:139], a[24:27], v[192:195]
    v_exp_f32 v204, v204
    v_mfma_f32_16x16x32_bf16 v[192:195], a[140:143], a[28:31], v[192:195]
    v_exp_f32 v205, v205
    v_mfma_f32_16x16x32_bf16 v[196:199], a[156:159], a[28:31], 0
    v_exp_f32 v206, v206
    v_mfma_f32_16x16x32_bf16 v[196:199], a[152:155], a[24:27], v[196:199]
    v_exp_f32 v207, v207
    v_mfma_f32_16x16x32_bf16 v[196:199], a[148:151], a[20:23], v[196:199]
    v_cvt_pk_bf16_f32 v252, v200, v201
    v_cvt_pk_bf16_f32 v253, v202, v203
    v_mfma_f32_16x16x32_bf16 v[196:199], a[144:147], a[16:19], v[196:199]
    s_waitcnt lgkmcnt(15)
    ds_read_b64_tr_b16 a[184:185], v247 offset:42432
    v_cvt_pk_bf16_f32 v254, v204, v205
    v_cvt_pk_bf16_f32 v255, v206, v207
    v_mfma_f32_16x16x32_bf16 a[228:231], a[224:227], v[240:243], a[228:231]
    ds_read_b64_tr_b16 a[186:187], v247 offset:42944
    v_fma_f32 v224, v224, s21, v233
    v_mfma_f32_16x16x32_bf16 a[228:231], a[224:227], v[252:255], a[228:231]
    ds_read_b64_tr_b16 a[216:217], v247 offset:8640
    v_fma_f32 v225, v225, s21, v233
    v_mfma_f32_16x16x32_bf16 v[0:3], a[192:195], v[252:255], v[0:3]
    ds_read_b64_tr_b16 a[218:219], v247 offset:9152
    v_fma_f32 v226, v226, s21, v233
    v_mfma_f32_16x16x32_bf16 v[0:3], a[160:163], v[240:243], v[0:3]
    s_waitcnt lgkmcnt(12)
    ds_read_b64_tr_b16 a[188:189], v247 offset:42440
    v_fma_f32 v227, v227, s21, v233
    v_mfma_f32_16x16x32_bf16 v[4:7], a[164:167], v[240:243], v[4:7]
    ds_read_b64_tr_b16 a[190:191], v247 offset:42952
    v_fma_f32 v228, v228, s21, v233
    v_mfma_f32_16x16x32_bf16 v[4:7], a[196:199], v[252:255], v[4:7]
    ds_read_b64_tr_b16 a[220:221], v247 offset:8648
    v_fma_f32 v229, v229, s21, v233
    v_mfma_f32_16x16x32_bf16 v[8:11], a[200:203], v[252:255], v[8:11]
    ds_read_b64_tr_b16 a[222:223], v247 offset:9160
    v_add_u32 v247, 16896, v247
    v_mfma_f32_16x16x32_bf16 v[8:11], a[168:171], v[240:243], v[8:11]
    s_waitcnt lgkmcnt(8)
    v_exp_f32 v224, v224
    v_mfma_f32_16x16x32_bf16 v[12:15], a[172:175], v[240:243], v[12:15]
    v_exp_f32 v225, v225
    v_mfma_f32_16x16x32_bf16 v[12:15], a[204:207], v[252:255], v[12:15]
    v_exp_f32 v226, v226
    v_mfma_f32_16x16x32_bf16 v[16:19], a[208:211], v[252:255], v[16:19]
    v_exp_f32 v227, v227
    v_mfma_f32_16x16x32_bf16 v[16:19], a[176:179], v[240:243], v[16:19]
    v_cvt_pk_bf16_f32 v208, v224, v225
    v_cvt_pk_bf16_f32 v209, v226, v227
    v_mfma_f32_16x16x32_bf16 v[20:23], a[180:183], v[240:243], v[20:23]
    v_fma_f32 v230, v230, s21, v233
    v_fma_f32 v231, v231, s21, v233
    v_mfma_f32_16x16x32_bf16 v[20:23], a[212:215], v[252:255], v[20:23]
    s_waitcnt lgkmcnt(0)
    v_exp_f32 v228, v228
    v_mfma_f32_16x16x32_bf16 v[24:27], a[216:219], v[252:255], v[24:27]
    v_exp_f32 v229, v229
    v_mfma_f32_16x16x32_bf16 v[24:27], a[184:187], v[240:243], v[24:27]
    v_exp_f32 v230, v230
    v_mfma_f32_16x16x32_bf16 v[28:31], a[188:191], v[240:243], v[28:31]
    v_exp_f32 v231, v231
    v_mfma_f32_16x16x32_bf16 v[28:31], a[220:223], v[252:255], v[28:31]
    s_waitcnt lgkmcnt(0)
    v_cvt_pk_bf16_f32 v210, v228, v229
    v_cvt_pk_bf16_f32 v211, v230, v231
    v_mfma_f32_16x16x32_bf16 v[200:203], a[96:99], a[32:35], 0
    s_barrier
    v_mfma_f32_16x16x32_bf16 v[200:203], a[100:103], a[36:39], v[200:203]
    v_fma_f32 v192, v192, s21, v233
    v_fma_f32 v193, v193, s21, v233
    v_mfma_f32_16x16x32_bf16 v[200:203], a[104:107], a[40:43], v[200:203]
    v_fma_f32 v194, v194, s21, v233
    v_fma_f32 v195, v195, s21, v233
    v_mfma_f32_16x16x32_bf16 v[200:203], a[108:111], a[44:47], v[200:203]
    v_fma_f32 v196, v196, s21, v233
    v_fma_f32 v197, v197, s21, v233
    v_mfma_f32_16x16x32_bf16 v[204:207], a[124:127], a[44:47], 0
    v_fma_f32 v198, v198, s21, v233
    v_fma_f32 v199, v199, s21, v233
    v_mfma_f32_16x16x32_bf16 v[204:207], a[120:123], a[40:43], v[204:207]
    v_exp_f32 v192, v192
    v_mfma_f32_16x16x32_bf16 v[204:207], a[116:119], a[36:39], v[204:207]
    s_add_u32 m0, s27, 50688
    v_exp_f32 v193, v193
    v_mfma_f32_16x16x32_bf16 v[204:207], a[112:115], a[32:35], v[204:207]
    buffer_load_dwordx4 v248, s[8:11], s24 offen nt lds
    v_mfma_f32_16x16x32_bf16 v[224:227], a[128:131], a[32:35], 0
    s_add_u32 m0, s27, 50720
    v_exp_f32 v194, v194
    v_mfma_f32_16x16x32_bf16 v[224:227], a[132:135], a[36:39], v[224:227]
    v_exp_f32 v195, v195
    v_mfma_f32_16x16x32_bf16 v[224:227], a[136:139], a[40:43], v[224:227]
    v_exp_f32 v196, v196
    v_mfma_f32_16x16x32_bf16 v[224:227], a[140:143], a[44:47], v[224:227]
    v_exp_f32 v197, v197
    v_mfma_f32_16x16x32_bf16 v[228:231], a[156:159], a[44:47], 0
    v_exp_f32 v198, v198
    v_mfma_f32_16x16x32_bf16 v[228:231], a[152:155], a[40:43], v[228:231]
    v_exp_f32 v199, v199
    v_mfma_f32_16x16x32_bf16 v[228:231], a[148:151], a[36:39], v[228:231]
    v_cvt_pk_bf16_f32 v212, v192, v193
    v_cvt_pk_bf16_f32 v213, v194, v195
    v_mfma_f32_16x16x32_bf16 v[228:231], a[144:147], a[32:35], v[228:231]
    v_cvt_pk_bf16_f32 v214, v196, v197
    v_cvt_pk_bf16_f32 v215, v198, v199
    v_mfma_f32_16x16x32_bf16 a[232:235], a[224:227], v[208:211], a[232:235]
    buffer_load_dwordx4 v248, s[8:11], s24 offen offset:1024 nt lds
    v_mfma_f32_16x16x32_bf16 a[232:235], a[224:227], v[212:215], a[232:235]
    s_add_u32 m0, s27, 50752
    v_fma_f32 v200, v200, s21, v234
    v_fma_f32 v201, v201, s21, v234
    v_mfma_f32_16x16x32_bf16 v[32:35], a[192:195], v[212:215], v[32:35]
    buffer_load_dwordx4 v248, s[8:11], s24 offen offset:2048 nt lds
    v_mfma_f32_16x16x32_bf16 v[32:35], a[160:163], v[208:211], v[32:35]
    s_add_u32 m0, s27, 50784
    v_fma_f32 v202, v202, s21, v234
    v_fma_f32 v203, v203, s21, v234
    v_mfma_f32_16x16x32_bf16 v[36:39], a[164:167], v[208:211], v[36:39]
    buffer_load_dwordx4 v248, s[8:11], s24 offen offset:3072 nt lds
    v_mfma_f32_16x16x32_bf16 v[36:39], a[196:199], v[212:215], v[36:39]
    s_add_u32 s24, s24, 8192
    v_exp_f32 v200, v200
    v_mfma_f32_16x16x32_bf16 v[40:43], a[200:203], v[212:215], v[40:43]
    v_exp_f32 v201, v201
    v_mfma_f32_16x16x32_bf16 v[40:43], a[168:171], v[208:211], v[40:43]
    v_exp_f32 v202, v202
    v_mfma_f32_16x16x32_bf16 v[44:47], a[172:175], v[208:211], v[44:47]
    v_exp_f32 v203, v203
    v_mfma_f32_16x16x32_bf16 v[44:47], a[204:207], v[212:215], v[44:47]
    v_cvt_pk_bf16_f32 v240, v200, v201
    v_cvt_pk_bf16_f32 v241, v202, v203
    v_mfma_f32_16x16x32_bf16 v[48:51], a[208:211], v[212:215], v[48:51]
    v_fma_f32 v204, v204, s21, v234
    v_fma_f32 v205, v205, s21, v234
    v_mfma_f32_16x16x32_bf16 v[48:51], a[176:179], v[208:211], v[48:51]
    v_fma_f32 v206, v206, s21, v234
    v_fma_f32 v207, v207, s21, v234
    v_mfma_f32_16x16x32_bf16 v[52:55], a[180:183], v[208:211], v[52:55]
    v_exp_f32 v204, v204
    v_mfma_f32_16x16x32_bf16 v[52:55], a[212:215], v[212:215], v[52:55]
    v_exp_f32 v205, v205
    v_mfma_f32_16x16x32_bf16 v[56:59], a[216:219], v[212:215], v[56:59]
    v_exp_f32 v206, v206
    v_mfma_f32_16x16x32_bf16 v[56:59], a[184:187], v[208:211], v[56:59]
    v_exp_f32 v207, v207
    v_mfma_f32_16x16x32_bf16 v[60:63], a[188:191], v[208:211], v[60:63]
    v_cvt_pk_bf16_f32 v242, v204, v205
    v_cvt_pk_bf16_f32 v243, v206, v207
    v_mfma_f32_16x16x32_bf16 v[60:63], a[220:223], v[212:215], v[60:63]
    v_fma_f32 v224, v224, s21, v234
    v_fma_f32 v225, v225, s21, v234
    v_mfma_f32_16x16x32_bf16 v[192:195], a[96:99], a[48:51], 0
    v_fma_f32 v226, v226, s21, v234
    v_fma_f32 v227, v227, s21, v234
    v_mfma_f32_16x16x32_bf16 v[192:195], a[100:103], a[52:55], v[192:195]
    v_fma_f32 v228, v228, s21, v234
    v_fma_f32 v229, v229, s21, v234
    v_mfma_f32_16x16x32_bf16 v[192:195], a[104:107], a[56:59], v[192:195]
    v_fma_f32 v230, v230, s21, v234
    v_fma_f32 v231, v231, s21, v234
    v_mfma_f32_16x16x32_bf16 v[192:195], a[108:111], a[60:63], v[192:195]
    v_exp_f32 v224, v224
    v_mfma_f32_16x16x32_bf16 v[196:199], a[124:127], a[60:63], 0
    v_exp_f32 v225, v225
    v_mfma_f32_16x16x32_bf16 v[196:199], a[120:123], a[56:59], v[196:199]
    v_exp_f32 v226, v226
    v_mfma_f32_16x16x32_bf16 v[196:199], a[116:119], a[52:55], v[196:199]
    v_exp_f32 v227, v227
    v_mfma_f32_16x16x32_bf16 v[196:199], a[112:115], a[48:51], v[196:199]
    v_exp_f32 v228, v228
    v_mfma_f32_16x16x32_bf16 v[200:203], a[128:131], a[48:51], 0
    v_exp_f32 v229, v229
    v_mfma_f32_16x16x32_bf16 v[200:203], a[132:135], a[52:55], v[200:203]
    v_exp_f32 v230, v230
    v_mfma_f32_16x16x32_bf16 v[200:203], a[136:139], a[56:59], v[200:203]
    v_exp_f32 v231, v231
    v_mfma_f32_16x16x32_bf16 v[200:203], a[140:143], a[60:63], v[200:203]
    v_cvt_pk_bf16_f32 v252, v224, v225
    v_cvt_pk_bf16_f32 v253, v226, v227
    v_mfma_f32_16x16x32_bf16 v[204:207], a[156:159], a[60:63], 0
    v_cvt_pk_bf16_f32 v254, v228, v229
    v_cvt_pk_bf16_f32 v255, v230, v231
    v_mfma_f32_16x16x32_bf16 v[204:207], a[152:155], a[56:59], v[204:207]
    v_fma_f32 v192, v192, s21, v235
    v_fma_f32 v193, v193, s21, v235
    v_mfma_f32_16x16x32_bf16 v[204:207], a[148:151], a[52:55], v[204:207]
    v_fma_f32 v194, v194, s21, v235
    v_fma_f32 v195, v195, s21, v235
    v_mfma_f32_16x16x32_bf16 v[204:207], a[144:147], a[48:51], v[204:207]
    v_exp_f32 v192, v192
    v_mfma_f32_16x16x32_bf16 a[236:239], a[224:227], v[240:243], a[236:239]
    v_exp_f32 v193, v193
    v_mfma_f32_16x16x32_bf16 a[236:239], a[224:227], v[252:255], a[236:239]
    v_exp_f32 v194, v194
    v_mfma_f32_16x16x32_bf16 v[64:67], a[192:195], v[252:255], v[64:67]
    v_exp_f32 v195, v195
    v_mfma_f32_16x16x32_bf16 v[64:67], a[160:163], v[240:243], v[64:67]
    v_cvt_pk_bf16_f32 v208, v192, v193
    v_cvt_pk_bf16_f32 v209, v194, v195
    v_mfma_f32_16x16x32_bf16 v[68:71], a[164:167], v[240:243], v[68:71]
    v_fma_f32 v196, v196, s21, v235
    v_fma_f32 v197, v197, s21, v235
    v_mfma_f32_16x16x32_bf16 v[68:71], a[196:199], v[252:255], v[68:71]
    v_fma_f32 v198, v198, s21, v235
    v_fma_f32 v199, v199, s21, v235
    v_mfma_f32_16x16x32_bf16 v[72:75], a[200:203], v[252:255], v[72:75]
    v_exp_f32 v196, v196
    v_mfma_f32_16x16x32_bf16 v[72:75], a[168:171], v[240:243], v[72:75]
    v_exp_f32 v197, v197
    v_mfma_f32_16x16x32_bf16 v[76:79], a[172:175], v[240:243], v[76:79]
    v_exp_f32 v198, v198
    v_mfma_f32_16x16x32_bf16 v[76:79], a[204:207], v[252:255], v[76:79]
    v_exp_f32 v199, v199
    v_mfma_f32_16x16x32_bf16 v[80:83], a[208:211], v[252:255], v[80:83]
    v_cvt_pk_bf16_f32 v210, v196, v197
    v_cvt_pk_bf16_f32 v211, v198, v199
    v_mfma_f32_16x16x32_bf16 v[80:83], a[176:179], v[240:243], v[80:83]
    v_fma_f32 v200, v200, s21, v235
    v_fma_f32 v201, v201, s21, v235
    v_mfma_f32_16x16x32_bf16 v[84:87], a[180:183], v[240:243], v[84:87]
    v_fma_f32 v202, v202, s21, v235
    v_fma_f32 v203, v203, s21, v235
    v_mfma_f32_16x16x32_bf16 v[84:87], a[212:215], v[252:255], v[84:87]
    v_fma_f32 v204, v204, s21, v235
    v_fma_f32 v205, v205, s21, v235
    v_mfma_f32_16x16x32_bf16 v[88:91], a[216:219], v[252:255], v[88:91]
    v_fma_f32 v206, v206, s21, v235
    v_fma_f32 v207, v207, s21, v235
    v_mfma_f32_16x16x32_bf16 v[88:91], a[184:187], v[240:243], v[88:91]
    v_exp_f32 v200, v200
    v_mfma_f32_16x16x32_bf16 v[92:95], a[188:191], v[240:243], v[92:95]
    v_exp_f32 v201, v201
    v_mfma_f32_16x16x32_bf16 v[92:95], a[220:223], v[252:255], v[92:95]
    v_exp_f32 v202, v202
    v_mfma_f32_16x16x32_bf16 v[224:227], a[96:99], a[64:67], 0
    v_exp_f32 v203, v203
    v_mfma_f32_16x16x32_bf16 v[224:227], a[100:103], a[68:71], v[224:227]
    v_exp_f32 v204, v204
    v_mfma_f32_16x16x32_bf16 v[224:227], a[104:107], a[72:75], v[224:227]
    v_exp_f32 v205, v205
    v_mfma_f32_16x16x32_bf16 v[224:227], a[108:111], a[76:79], v[224:227]
    v_exp_f32 v206, v206
    v_mfma_f32_16x16x32_bf16 v[228:231], a[124:127], a[76:79], 0
    v_exp_f32 v207, v207
    v_mfma_f32_16x16x32_bf16 v[228:231], a[120:123], a[72:75], v[228:231]
    v_cvt_pk_bf16_f32 v212, v200, v201
    v_cvt_pk_bf16_f32 v213, v202, v203
    v_mfma_f32_16x16x32_bf16 v[228:231], a[116:119], a[68:71], v[228:231]
    v_cvt_pk_bf16_f32 v214, v204, v205
    v_cvt_pk_bf16_f32 v215, v206, v207
    v_mfma_f32_16x16x32_bf16 v[228:231], a[112:115], a[64:67], v[228:231]
    v_fma_f32 v224, v224, s21, v236
    v_fma_f32 v225, v225, s21, v236
    v_mfma_f32_16x16x32_bf16 v[192:195], a[128:131], a[64:67], 0
    ds_read_b128 a[252:255], v251 offset:50688
    v_fma_f32 v226, v226, s21, v236
    v_mfma_f32_16x16x32_bf16 v[192:195], a[132:135], a[68:71], v[192:195]
    ds_read_b128 v[216:219], v251 offset:51744
    v_fma_f32 v227, v227, s21, v236
    v_mfma_f32_16x16x32_bf16 v[192:195], a[136:139], a[72:75], v[192:195]
    v_exp_f32 v224, v224
    v_mfma_f32_16x16x32_bf16 v[192:195], a[140:143], a[76:79], v[192:195]
    v_exp_f32 v225, v225
    v_mfma_f32_16x16x32_bf16 v[196:199], a[156:159], a[76:79], 0
    v_exp_f32 v226, v226
    v_mfma_f32_16x16x32_bf16 v[196:199], a[152:155], a[72:75], v[196:199]
    v_exp_f32 v227, v227
    v_mfma_f32_16x16x32_bf16 v[196:199], a[148:151], a[68:71], v[196:199]
    v_cvt_pk_bf16_f32 v240, v224, v225
    v_cvt_pk_bf16_f32 v241, v226, v227
    v_mfma_f32_16x16x32_bf16 v[196:199], a[144:147], a[64:67], v[196:199]
    v_fma_f32 v228, v228, s21, v236
    v_fma_f32 v229, v229, s21, v236
    v_mfma_f32_16x16x32_bf16 a[240:243], a[224:227], v[208:211], a[240:243]
    v_fma_f32 v230, v230, s21, v236
    v_fma_f32 v231, v231, s21, v236
    v_mfma_f32_16x16x32_bf16 a[240:243], a[224:227], v[212:215], a[240:243]
    s_waitcnt lgkmcnt(0)
    buffer_store_dwordx4 a[252:255], v248, s[16:19], s25 offen sc1
    v_exp_f32 v228, v228
    v_exp_f32 v229, v229
    v_mfma_f32_16x16x32_bf16 v[96:99], a[192:195], v[212:215], v[96:99]
    v_exp_f32 v230, v230
    v_mfma_f32_16x16x32_bf16 v[96:99], a[160:163], v[208:211], v[96:99]
    v_exp_f32 v231, v231
    v_mfma_f32_16x16x32_bf16 v[100:103], a[164:167], v[208:211], v[100:103]
    buffer_store_dwordx4 v[216:219], v248, s[16:19], s25 offen offset:1024 sc1
    v_cvt_pk_bf16_f32 v242, v228, v229
    v_cvt_pk_bf16_f32 v243, v230, v231
    v_fma_f32 v192, v192, s21, v236
    v_fma_f32 v193, v193, s21, v236
    v_mfma_f32_16x16x32_bf16 v[100:103], a[196:199], v[212:215], v[100:103]
    s_add_u32 s25, s25, 2048
    v_fma_f32 v194, v194, s21, v236
    v_fma_f32 v195, v195, s21, v236
    v_mfma_f32_16x16x32_bf16 v[104:107], a[200:203], v[212:215], v[104:107]
    v_fma_f32 v196, v196, s21, v236
    v_fma_f32 v197, v197, s21, v236
    v_mfma_f32_16x16x32_bf16 v[104:107], a[168:171], v[208:211], v[104:107]
    v_fma_f32 v198, v198, s21, v236
    v_fma_f32 v199, v199, s21, v236
    v_mfma_f32_16x16x32_bf16 v[108:111], a[172:175], v[208:211], v[108:111]
    v_exp_f32 v192, v192
    v_mfma_f32_16x16x32_bf16 v[108:111], a[204:207], v[212:215], v[108:111]
    v_exp_f32 v193, v193
    v_mfma_f32_16x16x32_bf16 v[112:115], a[208:211], v[212:215], v[112:115]
    v_exp_f32 v194, v194
    v_mfma_f32_16x16x32_bf16 v[112:115], a[176:179], v[208:211], v[112:115]
    v_exp_f32 v195, v195
    v_mfma_f32_16x16x32_bf16 v[116:119], a[180:183], v[208:211], v[116:119]
    v_exp_f32 v196, v196
    v_mfma_f32_16x16x32_bf16 v[116:119], a[212:215], v[212:215], v[116:119]
    v_exp_f32 v197, v197
    v_mfma_f32_16x16x32_bf16 v[120:123], a[216:219], v[212:215], v[120:123]
    v_exp_f32 v198, v198
    v_mfma_f32_16x16x32_bf16 v[120:123], a[184:187], v[208:211], v[120:123]
    v_exp_f32 v199, v199
    v_mfma_f32_16x16x32_bf16 v[124:127], a[188:191], v[208:211], v[124:127]
    v_cvt_pk_bf16_f32 v252, v192, v193
    v_cvt_pk_bf16_f32 v253, v194, v195
    v_mfma_f32_16x16x32_bf16 v[124:127], a[220:223], v[212:215], v[124:127]
    v_cvt_pk_bf16_f32 v254, v196, v197
    v_cvt_pk_bf16_f32 v255, v198, v199
    v_mfma_f32_16x16x32_bf16 v[200:203], a[96:99], a[80:83], 0
    v_mfma_f32_16x16x32_bf16 v[200:203], a[100:103], a[84:87], v[200:203]
    v_mfma_f32_16x16x32_bf16 v[200:203], a[104:107], a[88:91], v[200:203]
    v_mfma_f32_16x16x32_bf16 v[200:203], a[108:111], a[92:95], v[200:203]
    v_mfma_f32_16x16x32_bf16 v[204:207], a[124:127], a[92:95], 0
    v_mfma_f32_16x16x32_bf16 v[204:207], a[120:123], a[88:91], v[204:207]
    v_mfma_f32_16x16x32_bf16 v[204:207], a[116:119], a[84:87], v[204:207]
    v_mfma_f32_16x16x32_bf16 v[204:207], a[112:115], a[80:83], v[204:207]
    v_mfma_f32_16x16x32_bf16 v[224:227], a[128:131], a[80:83], 0
    s_waitcnt vmcnt(10)
    ds_read_b128 v[220:223], v251 offset:52800
    v_mfma_f32_16x16x32_bf16 v[224:227], a[132:135], a[84:87], v[224:227]
    s_barrier
    ds_read_b128 a[252:255], v251 offset:53856
    v_mfma_f32_16x16x32_bf16 v[224:227], a[136:139], a[88:91], v[224:227]
    ds_read_b128 a[96:99], v246 offset:50688
    v_fma_f32 v200, v200, s21, v237
    v_mfma_f32_16x16x32_bf16 v[224:227], a[140:143], a[92:95], v[224:227]
    ds_read_b128 a[100:103], v246 offset:50752
    v_fma_f32 v201, v201, s21, v237
    v_mfma_f32_16x16x32_bf16 v[228:231], a[156:159], a[92:95], 0
    ds_read_b128 a[104:107], v246 offset:50816
    v_fma_f32 v202, v202, s21, v237
    v_mfma_f32_16x16x32_bf16 v[228:231], a[152:155], a[88:91], v[228:231]
    ds_read_b128 a[108:111], v246 offset:50880
    v_fma_f32 v203, v203, s21, v237
    v_mfma_f32_16x16x32_bf16 v[228:231], a[148:151], a[84:87], v[228:231]
    ds_read_b128 a[124:127], v246 offset:51392
    v_fma_f32 v204, v204, s21, v237
    v_mfma_f32_16x16x32_bf16 v[228:231], a[144:147], a[80:83], v[228:231]
    ds_read_b128 a[120:123], v246 offset:51328
    v_fma_f32 v205, v205, s21, v237
    v_mfma_f32_16x16x32_bf16 a[244:247], a[224:227], v[240:243], a[244:247]
    s_waitcnt lgkmcnt(6)
    buffer_store_dwordx4 v[220:223], v248, s[16:19], s25 offen sc1
    ds_read_b128 a[116:119], v246 offset:51264
    v_exp_f32 v200, v200
    v_fma_f32 v206, v206, s21, v237
    v_mfma_f32_16x16x32_bf16 a[244:247], a[224:227], v[252:255], a[244:247]
    ds_read_b128 a[112:115], v246 offset:51200
    v_add_u32 v246, 16896, v246
    v_mfma_f32_16x16x32_bf16 v[128:131], a[192:195], v[252:255], v[128:131]
    ds_read_b128 a[128:131], v246 offset:50688
    v_fma_f32 v207, v207, s21, v237
    v_mfma_f32_16x16x32_bf16 v[128:131], a[160:163], v[240:243], v[128:131]
    buffer_store_dwordx4 a[252:255], v248, s[16:19], s25 offen offset:1024 sc1
    ds_read_b128 a[132:135], v246 offset:50752
    v_exp_f32 v201, v201
    v_fma_f32 v224, v224, s21, v237
    v_mfma_f32_16x16x32_bf16 v[132:135], a[164:167], v[240:243], v[132:135]
    s_add_u32 s25, s25, 2048
    ds_read_b128 a[136:139], v246 offset:50816
    v_cvt_pk_bf16_f32 v208, v200, v201
    v_mfma_f32_16x16x32_bf16 v[132:135], a[196:199], v[252:255], v[132:135]
Lhop9:
    s_cbranch_execz Lret2
    ds_read_b128 a[140:143], v246 offset:50880
    v_fma_f32 v225, v225, s21, v237
    v_mfma_f32_16x16x32_bf16 v[136:139], a[200:203], v[252:255], v[136:139]
    ds_read_b128 a[156:159], v246 offset:51392
    v_fma_f32 v226, v226, s21, v237
    v_mfma_f32_16x16x32_bf16 v[136:139], a[168:171], v[240:243], v[136:139]
    ds_read_b128 a[152:155], v246 offset:51328
    v_fma_f32 v227, v227, s21, v237
    v_mfma_f32_16x16x32_bf16 v[140:143], a[172:175], v[240:243], v[140:143]
    ds_read_b128 a[148:151], v246 offset:51264
    v_fma_f32 v228, v228, s21, v237
    v_mfma_f32_16x16x32_bf16 v[140:143], a[204:207], v[252:255], v[140:143]
    ds_read_b128 a[144:147], v246 offset:51200
    v_fma_f32 v229, v229, s21, v237
    v_mfma_f32_16x16x32_bf16 v[144:147], a[208:211], v[252:255], v[144:147]
    v_exp_f32 v202, v202
    v_mfma_f32_16x16x32_bf16 v[144:147], a[176:179], v[240:243], v[144:147]
    v_exp_f32 v203, v203
    v_mfma_f32_16x16x32_bf16 v[148:151], a[180:183], v[240:243], v[148:151]
    v_cvt_pk_bf16_f32 v209, v202, v203
    v_fma_f32 v230, v230, s21, v237
    v_mfma_f32_16x16x32_bf16 v[148:151], a[212:215], v[252:255], v[148:151]
    v_exp_f32 v204, v204
    v_mfma_f32_16x16x32_bf16 v[152:155], a[216:219], v[252:255], v[152:155]
    v_exp_f32 v205, v205
    v_mfma_f32_16x16x32_bf16 v[152:155], a[184:187], v[240:243], v[152:155]
    s_waitcnt lgkmcnt(8)
    v_exp_f32 v206, v206
    v_mfma_f32_16x16x32_bf16 v[156:159], a[188:191], v[240:243], v[156:159]
    v_exp_f32 v207, v207
    v_mfma_f32_16x16x32_bf16 v[156:159], a[220:223], v[252:255], v[156:159]
    v_cvt_pk_bf16_f32 v210, v204, v205
    v_cvt_pk_bf16_f32 v211, v206, v207
    v_mfma_f32_16x16x32_bf16 v[192:195], a[96:99], a[0:3], 0
    v_exp_f32 v224, v224
    v_mfma_f32_16x16x32_bf16 v[192:195], a[100:103], a[4:7], v[192:195]
    v_exp_f32 v225, v225
    v_mfma_f32_16x16x32_bf16 v[192:195], a[104:107], a[8:11], v[192:195]
    v_fma_f32 v231, v231, s21, v237
    v_cvt_pk_bf16_f32 v212, v224, v225
    v_mfma_f32_16x16x32_bf16 v[192:195], a[108:111], a[12:15], v[192:195]
    v_exp_f32 v226, v226
    v_mfma_f32_16x16x32_bf16 v[196:199], a[124:127], a[12:15], 0
    v_exp_f32 v227, v227
    v_mfma_f32_16x16x32_bf16 v[196:199], a[120:123], a[8:11], v[196:199]
    s_waitcnt lgkmcnt(0)
    v_exp_f32 v228, v228
    v_mfma_f32_16x16x32_bf16 v[196:199], a[116:119], a[4:7], v[196:199]
    v_exp_f32 v229, v229
    v_mfma_f32_16x16x32_bf16 v[196:199], a[112:115], a[0:3], v[196:199]
    v_exp_f32 v230, v230
    v_mfma_f32_16x16x32_bf16 v[200:203], a[128:131], a[0:3], 0
    ds_read_b128 v[216:219], v251 offset:16896
    v_cvt_pk_bf16_f32 v213, v226, v227
    v_mfma_f32_16x16x32_bf16 v[200:203], a[132:135], a[4:7], v[200:203]
    ds_read_b128 v[220:223], v251 offset:17952
    v_cvt_pk_bf16_f32 v214, v228, v229
    v_mfma_f32_16x16x32_bf16 v[200:203], a[136:139], a[8:11], v[200:203]
    v_exp_f32 v231, v231
    v_mfma_f32_16x16x32_bf16 v[200:203], a[140:143], a[12:15], v[200:203]
    v_cvt_pk_bf16_f32 v215, v230, v231
    v_fma_f32 v192, v192, s21, v232
    v_mfma_f32_16x16x32_bf16 v[204:207], a[156:159], a[12:15], 0
    v_fma_f32 v193, v193, s21, v232
    v_fma_f32 v194, v194, s21, v232
    v_mfma_f32_16x16x32_bf16 v[204:207], a[152:155], a[8:11], v[204:207]
    v_fma_f32 v195, v195, s21, v232
    v_fma_f32 v196, v196, s21, v232
    v_mfma_f32_16x16x32_bf16 v[204:207], a[148:151], a[4:7], v[204:207]
    v_exp_f32 v192, v192
    v_mfma_f32_16x16x32_bf16 v[204:207], a[144:147], a[0:3], v[204:207]
    v_exp_f32 v193, v193
    v_mfma_f32_16x16x32_bf16 a[248:251], a[224:227], v[208:211], a[248:251]
    v_exp_f32 v194, v194
    v_mfma_f32_16x16x32_bf16 a[248:251], a[224:227], v[212:215], a[248:251]
    s_waitcnt lgkmcnt(0)
    buffer_store_dwordx4 v[216:219], v248, s[16:19], s25 offen sc1
    v_exp_f32 v195, v195
    v_cvt_pk_bf16_f32 v240, v192, v193
    v_cvt_pk_bf16_f32 v241, v194, v195
    v_mfma_f32_16x16x32_bf16 v[160:163], a[192:195], v[212:215], v[160:163]
    ds_read_b64_tr_b16 a[192:193], v247 offset:59136
    ds_read_b64_tr_b16 a[194:195], v247 offset:59648
    v_mfma_f32_16x16x32_bf16 v[160:163], a[160:163], v[208:211], v[160:163]
    v_fma_f32 v197, v197, s21, v232
    v_fma_f32 v198, v198, s21, v232
    v_mfma_f32_16x16x32_bf16 v[164:167], a[164:167], v[208:211], v[164:167]
    buffer_store_dwordx4 v[220:223], v248, s[16:19], s25 offen offset:1024 sc1
    ds_read_b64_tr_b16 a[160:161], v247 offset:42240
    v_fma_f32 v199, v199, s21, v232
    v_exp_f32 v196, v196
    v_mfma_f32_16x16x32_bf16 v[164:167], a[196:199], v[212:215], v[164:167]
    s_add_u32 s25, s25, 2048
    ds_read_b64_tr_b16 a[162:163], v247 offset:42752
    v_fma_f32 v200, v200, s21, v232
    v_mfma_f32_16x16x32_bf16 v[168:171], a[200:203], v[212:215], v[168:171]
    ds_read_b64_tr_b16 a[164:165], v247 offset:42248
    v_fma_f32 v201, v201, s21, v232
    v_mfma_f32_16x16x32_bf16 v[168:171], a[168:171], v[208:211], v[168:171]
    ds_read_b64_tr_b16 a[166:167], v247 offset:42760
    v_fma_f32 v202, v202, s21, v232
    v_mfma_f32_16x16x32_bf16 v[172:175], a[172:175], v[208:211], v[172:175]
    ds_read_b64_tr_b16 a[196:197], v247 offset:59144
    v_fma_f32 v203, v203, s21, v232
    v_mfma_f32_16x16x32_bf16 v[172:175], a[204:207], v[212:215], v[172:175]
    ds_read_b64_tr_b16 a[198:199], v247 offset:59656
    v_fma_f32 v204, v204, s21, v232
    v_mfma_f32_16x16x32_bf16 v[176:179], a[208:211], v[212:215], v[176:179]
    ds_read_b64_tr_b16 a[168:169], v247 offset:42304
    v_fma_f32 v205, v205, s21, v232
    v_mfma_f32_16x16x32_bf16 v[176:179], a[176:179], v[208:211], v[176:179]
    ds_read_b64_tr_b16 a[170:171], v247 offset:42816
    v_fma_f32 v206, v206, s21, v232
    v_mfma_f32_16x16x32_bf16 v[180:183], a[180:183], v[208:211], v[180:183]
    ds_read_b64_tr_b16 a[200:201], v247 offset:59200
    v_fma_f32 v207, v207, s21, v232
    v_mfma_f32_16x16x32_bf16 v[180:183], a[212:215], v[212:215], v[180:183]
    v_exp_f32 v197, v197
    v_mfma_f32_16x16x32_bf16 v[184:187], a[216:219], v[212:215], v[184:187]
    ds_read_b64_tr_b16 a[202:203], v247 offset:59712
    ds_read_b64_tr_b16 a[172:173], v247 offset:42312
    v_mfma_f32_16x16x32_bf16 v[184:187], a[184:187], v[208:211], v[184:187]
    v_exp_f32 v198, v198
    v_mfma_f32_16x16x32_bf16 v[188:191], a[188:191], v[208:211], v[188:191]
    ds_read_b64_tr_b16 a[174:175], v247 offset:42824
    ds_read_b64_tr_b16 a[204:205], v247 offset:59208
    v_mfma_f32_16x16x32_bf16 v[188:191], a[220:223], v[212:215], v[188:191]
    v_exp_f32 v199, v199
    v_mfma_f32_16x16x32_bf16 v[224:227], a[96:99], a[16:19], 0
    ds_read_b64_tr_b16 a[206:207], v247 offset:59720
    ds_read_b64_tr_b16 a[176:177], v247 offset:42368
    v_mfma_f32_16x16x32_bf16 v[224:227], a[100:103], a[20:23], v[224:227]
    v_cvt_pk_bf16_f32 v242, v196, v197
    v_cvt_pk_bf16_f32 v243, v198, v199
    v_mfma_f32_16x16x32_bf16 v[224:227], a[104:107], a[24:27], v[224:227]
    ds_read_b64_tr_b16 a[178:179], v247 offset:42880
    ds_read_b64_tr_b16 a[208:209], v247 offset:59264
    v_mfma_f32_16x16x32_bf16 v[224:227], a[108:111], a[28:31], v[224:227]
    v_exp_f32 v200, v200
    v_mfma_f32_16x16x32_bf16 v[228:231], a[124:127], a[28:31], 0
    ds_read_b64_tr_b16 a[210:211], v247 offset:59776
    ds_read_b64_tr_b16 a[180:181], v247 offset:42376
    v_mfma_f32_16x16x32_bf16 v[228:231], a[120:123], a[24:27], v[228:231]
    v_exp_f32 v201, v201
    v_mfma_f32_16x16x32_bf16 v[228:231], a[116:119], a[20:23], v[228:231]
    ds_read_b64_tr_b16 a[182:183], v247 offset:42888
    ds_read_b64_tr_b16 a[212:213], v247 offset:59272
    v_mfma_f32_16x16x32_bf16 v[228:231], a[112:115], a[16:19], v[228:231]
    v_exp_f32 v202, v202
    v_mfma_f32_16x16x32_bf16 v[192:195], a[128:131], a[16:19], 0
    ds_read_b128 a[252:255], v251 offset:19008
    ds_read_b64_tr_b16 a[214:215], v247 offset:59784
    v_mfma_f32_16x16x32_bf16 v[192:195], a[132:135], a[20:23], v[192:195]
    v_exp_f32 v203, v203
    v_mfma_f32_16x16x32_bf16 v[192:195], a[136:139], a[24:27], v[192:195]
    ds_read_b128 v[216:219], v251 offset:20064
    v_cvt_pk_bf16_f32 v252, v200, v201
    v_mfma_f32_16x16x32_bf16 v[192:195], a[140:143], a[28:31], v[192:195]
    v_exp_f32 v204, v204
    v_mfma_f32_16x16x32_bf16 v[196:199], a[156:159], a[28:31], 0
    v_exp_f32 v205, v205
    v_mfma_f32_16x16x32_bf16 v[196:199], a[152:155], a[24:27], v[196:199]
    v_exp_f32 v206, v206
    v_mfma_f32_16x16x32_bf16 v[196:199], a[148:151], a[20:23], v[196:199]
    v_exp_f32 v207, v207
    v_mfma_f32_16x16x32_bf16 v[196:199], a[144:147], a[16:19], v[196:199]
    s_waitcnt lgkmcnt(15)
    ds_read_b64_tr_b16 a[184:185], v247 offset:42432
    v_cvt_pk_bf16_f32 v253, v202, v203
    v_cvt_pk_bf16_f32 v254, v204, v205
    v_cvt_pk_bf16_f32 v255, v206, v207
    v_mfma_f32_16x16x32_bf16 a[228:231], a[224:227], v[240:243], a[228:231]
    ds_read_b64_tr_b16 a[186:187], v247 offset:42944
    v_fma_f32 v224, v224, s21, v233
    v_mfma_f32_16x16x32_bf16 a[228:231], a[224:227], v[252:255], a[228:231]
    s_waitcnt lgkmcnt(2)
    buffer_store_dwordx4 a[252:255], v248, s[16:19], s25 offen sc1
    ds_read_b64_tr_b16 a[216:217], v247 offset:59328
    v_fma_f32 v225, v225, s21, v233
    v_fma_f32 v226, v226, s21, v233
    v_fma_f32 v227, v227, s21, v233
    v_mfma_f32_16x16x32_bf16 v[0:3], a[192:195], v[252:255], v[0:3]
    ds_read_b64_tr_b16 a[218:219], v247 offset:59840
    v_fma_f32 v228, v228, s21, v233
    v_mfma_f32_16x16x32_bf16 v[0:3], a[160:163], v[240:243], v[0:3]
    s_waitcnt lgkmcnt(14)
    ds_read_b64_tr_b16 a[188:189], v247 offset:42440
    v_fma_f32 v229, v229, s21, v233
    v_mfma_f32_16x16x32_bf16 v[4:7], a[164:167], v[240:243], v[4:7]
    buffer_store_dwordx4 v[216:219], v248, s[16:19], s25 offen offset:1024 sc1
    ds_read_b64_tr_b16 a[190:191], v247 offset:42952
    v_exp_f32 v224, v224
    v_fma_f32 v230, v230, s21, v233
    v_mfma_f32_16x16x32_bf16 v[4:7], a[196:199], v[252:255], v[4:7]
    s_add_u32 s25, s25, 2048
    ds_read_b64_tr_b16 a[220:221], v247 offset:59336
    v_fma_f32 v231, v231, s21, v233
    v_mfma_f32_16x16x32_bf16 v[8:11], a[200:203], v[252:255], v[8:11]
    ds_read_b64_tr_b16 a[222:223], v247 offset:59848
    v_fma_f32 v192, v192, s21, v233
    v_mfma_f32_16x16x32_bf16 v[8:11], a[168:171], v[240:243], v[8:11]
    s_waitcnt lgkmcnt(9)
    v_exp_f32 v225, v225
    v_mfma_f32_16x16x32_bf16 v[12:15], a[172:175], v[240:243], v[12:15]
    v_exp_f32 v226, v226
    v_mfma_f32_16x16x32_bf16 v[12:15], a[204:207], v[252:255], v[12:15]
    v_exp_f32 v227, v227
    v_mfma_f32_16x16x32_bf16 v[16:19], a[208:211], v[252:255], v[16:19]
    v_cvt_pk_bf16_f32 v208, v224, v225
    v_cvt_pk_bf16_f32 v209, v226, v227
    v_mfma_f32_16x16x32_bf16 v[16:19], a[176:179], v[240:243], v[16:19]
    v_exp_f32 v228, v228
    v_mfma_f32_16x16x32_bf16 v[20:23], a[180:183], v[240:243], v[20:23]
    v_exp_f32 v229, v229
    v_mfma_f32_16x16x32_bf16 v[20:23], a[212:215], v[252:255], v[20:23]
    s_waitcnt lgkmcnt(0)
    v_exp_f32 v230, v230
    v_mfma_f32_16x16x32_bf16 v[24:27], a[216:219], v[252:255], v[24:27]
    v_exp_f32 v231, v231
    v_mfma_f32_16x16x32_bf16 v[24:27], a[184:187], v[240:243], v[24:27]
    v_cvt_pk_bf16_f32 v210, v228, v229
    v_cvt_pk_bf16_f32 v211, v230, v231
    v_mfma_f32_16x16x32_bf16 v[28:31], a[188:191], v[240:243], v[28:31]
    v_fma_f32 v193, v193, s21, v233
    v_fma_f32 v194, v194, s21, v233
    v_mfma_f32_16x16x32_bf16 v[28:31], a[220:223], v[252:255], v[28:31]
    v_fma_f32 v195, v195, s21, v233
    v_fma_f32 v196, v196, s21, v233
    v_mfma_f32_16x16x32_bf16 v[200:203], a[96:99], a[32:35], 0
    v_fma_f32 v197, v197, s21, v233
    v_fma_f32 v198, v198, s21, v233
    v_mfma_f32_16x16x32_bf16 v[200:203], a[100:103], a[36:39], v[200:203]
    v_exp_f32 v192, v192
    v_mfma_f32_16x16x32_bf16 v[200:203], a[104:107], a[40:43], v[200:203]
    v_exp_f32 v193, v193
    v_mfma_f32_16x16x32_bf16 v[200:203], a[108:111], a[44:47], v[200:203]
    v_fma_f32 v199, v199, s21, v233
    v_cvt_pk_bf16_f32 v212, v192, v193
    v_mfma_f32_16x16x32_bf16 v[204:207], a[124:127], a[44:47], 0
    v_exp_f32 v194, v194
    v_mfma_f32_16x16x32_bf16 v[204:207], a[120:123], a[40:43], v[204:207]
    v_exp_f32 v195, v195
    v_mfma_f32_16x16x32_bf16 v[204:207], a[116:119], a[36:39], v[204:207]
    v_exp_f32 v196, v196
    v_mfma_f32_16x16x32_bf16 v[204:207], a[112:115], a[32:35], v[204:207]
    v_exp_f32 v197, v197
    v_mfma_f32_16x16x32_bf16 v[224:227], a[128:131], a[32:35], 0
    ds_read_b128 v[220:223], v251 offset:33792
    v_cvt_pk_bf16_f32 v213, v194, v195
    v_mfma_f32_16x16x32_bf16 v[224:227], a[132:135], a[36:39], v[224:227]
    ds_read_b128 a[252:255], v251 offset:34848
    v_cvt_pk_bf16_f32 v214, v196, v197
    v_mfma_f32_16x16x32_bf16 v[224:227], a[136:139], a[40:43], v[224:227]
    v_exp_f32 v198, v198
    v_mfma_f32_16x16x32_bf16 v[224:227], a[140:143], a[44:47], v[224:227]
    v_exp_f32 v199, v199
    v_mfma_f32_16x16x32_bf16 v[228:231], a[156:159], a[44:47], 0
    v_cvt_pk_bf16_f32 v215, v198, v199
    v_fma_f32 v200, v200, s21, v234
    v_mfma_f32_16x16x32_bf16 v[228:231], a[152:155], a[40:43], v[228:231]
    v_fma_f32 v201, v201, s21, v234
    v_fma_f32 v202, v202, s21, v234
    v_mfma_f32_16x16x32_bf16 v[228:231], a[148:151], a[36:39], v[228:231]
    v_fma_f32 v203, v203, s21, v234
    v_fma_f32 v204, v204, s21, v234
    v_mfma_f32_16x16x32_bf16 v[228:231], a[144:147], a[32:35], v[228:231]
    v_exp_f32 v200, v200
    v_mfma_f32_16x16x32_bf16 a[232:235], a[224:227], v[208:211], a[232:235]
    v_exp_f32 v201, v201
    v_mfma_f32_16x16x32_bf16 a[232:235], a[224:227], v[212:215], a[232:235]
    s_waitcnt lgkmcnt(0)
    buffer_store_dwordx4 v[220:223], v248, s[16:19], s25 offen sc1
    v_exp_f32 v202, v202
    v_exp_f32 v203, v203
    v_mfma_f32_16x16x32_bf16 v[32:35], a[192:195], v[212:215], v[32:35]
    v_cvt_pk_bf16_f32 v240, v200, v201
    v_cvt_pk_bf16_f32 v241, v202, v203
    v_mfma_f32_16x16x32_bf16 v[32:35], a[160:163], v[208:211], v[32:35]
    v_fma_f32 v205, v205, s21, v234
    v_fma_f32 v206, v206, s21, v234
    v_mfma_f32_16x16x32_bf16 v[36:39], a[164:167], v[208:211], v[36:39]
    buffer_store_dwordx4 a[252:255], v248, s[16:19], s25 offen offset:1024 sc1
    v_fma_f32 v207, v207, s21, v234
    v_exp_f32 v204, v204
    v_fma_f32 v224, v224, s21, v234
    v_mfma_f32_16x16x32_bf16 v[36:39], a[196:199], v[212:215], v[36:39]
    s_add_u32 s25, s25, 2048
    v_exp_f32 v205, v205
    v_mfma_f32_16x16x32_bf16 v[40:43], a[200:203], v[212:215], v[40:43]
    v_exp_f32 v206, v206
    v_mfma_f32_16x16x32_bf16 v[40:43], a[168:171], v[208:211], v[40:43]
    v_exp_f32 v207, v207
    v_mfma_f32_16x16x32_bf16 v[44:47], a[172:175], v[208:211], v[44:47]
    v_cvt_pk_bf16_f32 v242, v204, v205
    v_cvt_pk_bf16_f32 v243, v206, v207
    v_mfma_f32_16x16x32_bf16 v[44:47], a[204:207], v[212:215], v[44:47]
    v_fma_f32 v225, v225, s21, v234
    v_fma_f32 v226, v226, s21, v234
    v_mfma_f32_16x16x32_bf16 v[48:51], a[208:211], v[212:215], v[48:51]
    v_fma_f32 v227, v227, s21, v234
    v_fma_f32 v228, v228, s21, v234
    v_mfma_f32_16x16x32_bf16 v[48:51], a[176:179], v[208:211], v[48:51]
    v_fma_f32 v229, v229, s21, v234
    v_fma_f32 v230, v230, s21, v234
    v_mfma_f32_16x16x32_bf16 v[52:55], a[180:183], v[208:211], v[52:55]
    v_exp_f32 v224, v224
    v_mfma_f32_16x16x32_bf16 v[52:55], a[212:215], v[212:215], v[52:55]
    v_exp_f32 v225, v225
    v_mfma_f32_16x16x32_bf16 v[56:59], a[216:219], v[212:215], v[56:59]
    v_fma_f32 v231, v231, s21, v234
    v_cvt_pk_bf16_f32 v252, v224, v225
    v_mfma_f32_16x16x32_bf16 v[56:59], a[184:187], v[208:211], v[56:59]
    v_exp_f32 v226, v226
    v_mfma_f32_16x16x32_bf16 v[60:63], a[188:191], v[208:211], v[60:63]
    v_exp_f32 v227, v227
    v_mfma_f32_16x16x32_bf16 v[60:63], a[220:223], v[212:215], v[60:63]
    v_exp_f32 v228, v228
    v_mfma_f32_16x16x32_bf16 v[192:195], a[96:99], a[48:51], 0
    v_exp_f32 v229, v229
    v_mfma_f32_16x16x32_bf16 v[192:195], a[100:103], a[52:55], v[192:195]
    v_exp_f32 v230, v230
    v_mfma_f32_16x16x32_bf16 v[192:195], a[104:107], a[56:59], v[192:195]
    v_exp_f32 v231, v231
    v_mfma_f32_16x16x32_bf16 v[192:195], a[108:111], a[60:63], v[192:195]
    v_cvt_pk_bf16_f32 v253, v226, v227
    v_cvt_pk_bf16_f32 v254, v228, v229
    v_mfma_f32_16x16x32_bf16 v[196:199], a[124:127], a[60:63], 0
    v_cvt_pk_bf16_f32 v255, v230, v231
    v_mfma_f32_16x16x32_bf16 v[196:199], a[120:123], a[56:59], v[196:199]
    v_mfma_f32_16x16x32_bf16 v[196:199], a[116:119], a[52:55], v[196:199]
    v_mfma_f32_16x16x32_bf16 v[196:199], a[112:115], a[48:51], v[196:199]
    v_mfma_f32_16x16x32_bf16 v[200:203], a[128:131], a[48:51], 0
    s_waitcnt vmcnt(10)
    ds_read_b128 v[216:219], v251 offset:35904
    v_fma_f32 v192, v192, s21, v235
    v_mfma_f32_16x16x32_bf16 v[200:203], a[132:135], a[52:55], v[200:203]
    s_barrier
    ds_read_b128 v[220:223], v251 offset:36960
    v_subrev_u32 v251, 84480, v251
    v_mfma_f32_16x16x32_bf16 v[200:203], a[136:139], a[56:59], v[200:203]
    ds_read_b128 a[96:99], v246 offset:0
    v_fma_f32 v193, v193, s21, v235
    v_mfma_f32_16x16x32_bf16 v[200:203], a[140:143], a[60:63], v[200:203]
    ds_read_b128 a[100:103], v246 offset:64
    v_fma_f32 v194, v194, s21, v235
    v_mfma_f32_16x16x32_bf16 v[204:207], a[156:159], a[60:63], 0
    ds_read_b128 a[104:107], v246 offset:128
    v_fma_f32 v195, v195, s21, v235
    v_mfma_f32_16x16x32_bf16 v[204:207], a[152:155], a[56:59], v[204:207]
    ds_read_b128 a[108:111], v246 offset:192
    v_fma_f32 v196, v196, s21, v235
    v_mfma_f32_16x16x32_bf16 v[204:207], a[148:151], a[52:55], v[204:207]
    ds_read_b128 a[124:127], v246 offset:704
    v_fma_f32 v197, v197, s21, v235
    v_mfma_f32_16x16x32_bf16 v[204:207], a[144:147], a[48:51], v[204:207]
    ds_read_b128 a[128:131], v246 offset:16896
    v_fma_f32 v198, v198, s21, v235
    v_mfma_f32_16x16x32_bf16 a[236:239], a[224:227], v[240:243], a[236:239]
    s_waitcnt lgkmcnt(6)
    buffer_store_dwordx4 v[216:219], v248, s[16:19], s25 offen sc1
    ds_read_b128 a[120:123], v246 offset:640
    v_exp_f32 v192, v192
    v_fma_f32 v199, v199, s21, v235
    v_mfma_f32_16x16x32_bf16 a[236:239], a[224:227], v[252:255], a[236:239]
    ds_read_b128 a[132:135], v246 offset:16960
    v_fma_f32 v200, v200, s21, v235
    v_mfma_f32_16x16x32_bf16 v[64:67], a[192:195], v[252:255], v[64:67]
    ds_read_b128 a[116:119], v246 offset:576
    v_fma_f32 v201, v201, s21, v235
    v_mfma_f32_16x16x32_bf16 v[64:67], a[160:163], v[240:243], v[64:67]
    buffer_store_dwordx4 v[220:223], v248, s[16:19], s25 offen offset:1024 sc1
    ds_read_b128 a[136:139], v246 offset:17024
    v_exp_f32 v193, v193
    v_fma_f32 v202, v202, s21, v235
    v_mfma_f32_16x16x32_bf16 v[68:71], a[164:167], v[240:243], v[68:71]
    s_add_u32 s25, s25, 2048
    ds_read_b128 a[112:115], v246 offset:512
    v_cvt_pk_bf16_f32 v208, v192, v193
    v_mfma_f32_16x16x32_bf16 v[68:71], a[196:199], v[252:255], v[68:71]
    ds_read_b128 a[140:143], v246 offset:17088
    v_fma_f32 v203, v203, s21, v235
    v_mfma_f32_16x16x32_bf16 v[72:75], a[200:203], v[252:255], v[72:75]
    ds_read_b128 a[156:159], v246 offset:17600
    v_fma_f32 v204, v204, s21, v235
    v_mfma_f32_16x16x32_bf16 v[72:75], a[168:171], v[240:243], v[72:75]
    ds_read_b128 a[152:155], v246 offset:17536
    v_fma_f32 v205, v205, s21, v235
    v_mfma_f32_16x16x32_bf16 v[76:79], a[172:175], v[240:243], v[76:79]
    ds_read_b128 a[148:151], v246 offset:17472
    v_fma_f32 v206, v206, s21, v235
    v_mfma_f32_16x16x32_bf16 v[76:79], a[204:207], v[252:255], v[76:79]
    ds_read_b128 a[144:147], v246 offset:17408
    v_fma_f32 v207, v207, s21, v235
    v_mfma_f32_16x16x32_bf16 v[80:83], a[208:211], v[252:255], v[80:83]
    v_exp_f32 v194, v194
    v_mfma_f32_16x16x32_bf16 v[80:83], a[176:179], v[240:243], v[80:83]
    v_exp_f32 v195, v195
    v_mfma_f32_16x16x32_bf16 v[84:87], a[180:183], v[240:243], v[84:87]
    v_exp_f32 v196, v196
    v_mfma_f32_16x16x32_bf16 v[84:87], a[212:215], v[252:255], v[84:87]
    v_exp_f32 v197, v197
    v_mfma_f32_16x16x32_bf16 v[88:91], a[216:219], v[252:255], v[88:91]
    v_cvt_pk_bf16_f32 v209, v194, v195
    v_cvt_pk_bf16_f32 v210, v196, v197
    v_mfma_f32_16x16x32_bf16 v[88:91], a[184:187], v[240:243], v[88:91]
    s_waitcnt lgkmcnt(5)
    v_exp_f32 v198, v198
    v_mfma_f32_16x16x32_bf16 v[92:95], a[188:191], v[240:243], v[92:95]
    v_exp_f32 v199, v199
    v_mfma_f32_16x16x32_bf16 v[92:95], a[220:223], v[252:255], v[92:95]
    v_exp_f32 v200, v200
    v_mfma_f32_16x16x32_bf16 v[224:227], a[96:99], a[0:3], 0
    v_exp_f32 v201, v201
    v_mfma_f32_16x16x32_bf16 v[224:227], a[100:103], a[4:7], v[224:227]
    v_cvt_pk_bf16_f32 v211, v198, v199
    v_cvt_pk_bf16_f32 v212, v200, v201
    v_mfma_f32_16x16x32_bf16 v[224:227], a[104:107], a[8:11], v[224:227]
    v_exp_f32 v202, v202
    v_mfma_f32_16x16x32_bf16 v[224:227], a[108:111], a[12:15], v[224:227]
    v_exp_f32 v203, v203
    v_mfma_f32_16x16x32_bf16 v[228:231], a[124:127], a[12:15], 0
    v_exp_f32 v204, v204
    v_mfma_f32_16x16x32_bf16 v[228:231], a[120:123], a[8:11], v[228:231]
    s_waitcnt lgkmcnt(0)
    v_exp_f32 v205, v205
    v_mfma_f32_16x16x32_bf16 v[228:231], a[116:119], a[4:7], v[228:231]
    v_exp_f32 v206, v206
    v_mfma_f32_16x16x32_bf16 v[228:231], a[112:115], a[0:3], v[228:231]
    v_exp_f32 v207, v207
    v_mfma_f32_16x16x32_bf16 v[192:195], a[128:131], a[0:3], 0
    ds_read_b128 a[252:255], v251 offset:0
    v_cvt_pk_bf16_f32 v213, v202, v203
    v_mfma_f32_16x16x32_bf16 v[192:195], a[132:135], a[4:7], v[192:195]
    ds_read_b128 v[216:219], v251 offset:1056
    v_cvt_pk_bf16_f32 v214, v204, v205
    v_mfma_f32_16x16x32_bf16 v[192:195], a[136:139], a[8:11], v[192:195]
    v_cvt_pk_bf16_f32 v215, v206, v207
    v_fma_f32 v224, v224, s21, v232
    v_mfma_f32_16x16x32_bf16 v[192:195], a[140:143], a[12:15], v[192:195]
    v_fma_f32 v225, v225, s21, v232
    v_fma_f32 v226, v226, s21, v232
    v_mfma_f32_16x16x32_bf16 v[196:199], a[156:159], a[12:15], 0
    v_fma_f32 v227, v227, s21, v232
    v_fma_f32 v228, v228, s21, v232
    v_mfma_f32_16x16x32_bf16 v[196:199], a[152:155], a[8:11], v[196:199]
    v_exp_f32 v224, v224
    v_mfma_f32_16x16x32_bf16 v[196:199], a[148:151], a[4:7], v[196:199]
    v_exp_f32 v225, v225
    v_mfma_f32_16x16x32_bf16 v[196:199], a[144:147], a[0:3], v[196:199]
    v_exp_f32 v226, v226
    v_mfma_f32_16x16x32_bf16 a[240:243], a[224:227], v[208:211], a[240:243]
    v_exp_f32 v227, v227
    v_mfma_f32_16x16x32_bf16 a[240:243], a[224:227], v[212:215], a[240:243]
    s_waitcnt lgkmcnt(0)
    buffer_store_dwordx4 a[252:255], v248, s[16:19], s25 offen sc1
    v_cvt_pk_bf16_f32 v240, v224, v225
    v_cvt_pk_bf16_f32 v241, v226, v227
    v_fma_f32 v229, v229, s21, v232
    v_fma_f32 v230, v230, s21, v232
    v_mfma_f32_16x16x32_bf16 v[96:99], a[192:195], v[212:215], v[96:99]
    ds_read_b64_tr_b16 a[192:193], v247 offset:25344
    ds_read_b64_tr_b16 a[194:195], v247 offset:25856
    v_mfma_f32_16x16x32_bf16 v[96:99], a[160:163], v[208:211], v[96:99]
    v_fma_f32 v231, v231, s21, v232
    v_fma_f32 v192, v192, s21, v232
    v_mfma_f32_16x16x32_bf16 v[100:103], a[164:167], v[208:211], v[100:103]
    buffer_store_dwordx4 v[216:219], v248, s[16:19], s25 offen offset:1024 sc1
    ds_read_b64_tr_b16 a[160:161], v247 offset:8448
    v_exp_f32 v228, v228
    v_fma_f32 v193, v193, s21, v232
    v_mfma_f32_16x16x32_bf16 v[100:103], a[196:199], v[212:215], v[100:103]
    s_add_u32 s25, s25, 2048
    ds_read_b64_tr_b16 a[162:163], v247 offset:8960
    v_fma_f32 v194, v194, s21, v232
    v_mfma_f32_16x16x32_bf16 v[104:107], a[200:203], v[212:215], v[104:107]
    ds_read_b64_tr_b16 a[164:165], v247 offset:8456
    v_fma_f32 v195, v195, s21, v232
    v_mfma_f32_16x16x32_bf16 v[104:107], a[168:171], v[208:211], v[104:107]
    ds_read_b64_tr_b16 a[166:167], v247 offset:8968
    v_fma_f32 v196, v196, s21, v232
    v_mfma_f32_16x16x32_bf16 v[108:111], a[172:175], v[208:211], v[108:111]
    ds_read_b64_tr_b16 a[196:197], v247 offset:25352
    v_fma_f32 v197, v197, s21, v232
    v_mfma_f32_16x16x32_bf16 v[108:111], a[204:207], v[212:215], v[108:111]
    ds_read_b64_tr_b16 a[198:199], v247 offset:25864
    v_fma_f32 v198, v198, s21, v232
    v_mfma_f32_16x16x32_bf16 v[112:115], a[208:211], v[212:215], v[112:115]
    ds_read_b64_tr_b16 a[168:169], v247 offset:8512
    v_fma_f32 v199, v199, s21, v232
    v_mfma_f32_16x16x32_bf16 v[112:115], a[176:179], v[208:211], v[112:115]
    v_exp_f32 v229, v229
    v_mfma_f32_16x16x32_bf16 v[116:119], a[180:183], v[208:211], v[116:119]
    ds_read_b64_tr_b16 a[170:171], v247 offset:9024
    ds_read_b64_tr_b16 a[200:201], v247 offset:25408
    v_mfma_f32_16x16x32_bf16 v[116:119], a[212:215], v[212:215], v[116:119]
    v_exp_f32 v230, v230
    v_mfma_f32_16x16x32_bf16 v[120:123], a[216:219], v[212:215], v[120:123]
    ds_read_b64_tr_b16 a[202:203], v247 offset:25920
    ds_read_b64_tr_b16 a[172:173], v247 offset:8520
    v_mfma_f32_16x16x32_bf16 v[120:123], a[184:187], v[208:211], v[120:123]
    v_exp_f32 v231, v231
    v_mfma_f32_16x16x32_bf16 v[124:127], a[188:191], v[208:211], v[124:127]
    ds_read_b64_tr_b16 a[174:175], v247 offset:9032
    ds_read_b64_tr_b16 a[204:205], v247 offset:25416
    v_mfma_f32_16x16x32_bf16 v[124:127], a[220:223], v[212:215], v[124:127]
    v_cvt_pk_bf16_f32 v242, v228, v229
    v_cvt_pk_bf16_f32 v243, v230, v231
    v_mfma_f32_16x16x32_bf16 v[200:203], a[96:99], a[16:19], 0
    ds_read_b64_tr_b16 a[206:207], v247 offset:25928
    ds_read_b64_tr_b16 a[176:177], v247 offset:8576
    v_mfma_f32_16x16x32_bf16 v[200:203], a[100:103], a[20:23], v[200:203]
    v_exp_f32 v192, v192
    v_mfma_f32_16x16x32_bf16 v[200:203], a[104:107], a[24:27], v[200:203]
    ds_read_b64_tr_b16 a[178:179], v247 offset:9088
    ds_read_b64_tr_b16 a[208:209], v247 offset:25472
    v_mfma_f32_16x16x32_bf16 v[200:203], a[108:111], a[28:31], v[200:203]
    v_exp_f32 v193, v193
    v_mfma_f32_16x16x32_bf16 v[204:207], a[124:127], a[28:31], 0
    ds_read_b64_tr_b16 a[210:211], v247 offset:25984
    ds_read_b64_tr_b16 a[180:181], v247 offset:8584
    v_mfma_f32_16x16x32_bf16 v[204:207], a[120:123], a[24:27], v[204:207]
    v_exp_f32 v194, v194
    v_mfma_f32_16x16x32_bf16 v[204:207], a[116:119], a[20:23], v[204:207]
    ds_read_b64_tr_b16 a[182:183], v247 offset:9096
    ds_read_b64_tr_b16 a[212:213], v247 offset:25480
    v_mfma_f32_16x16x32_bf16 v[204:207], a[112:115], a[16:19], v[204:207]
    v_exp_f32 v195, v195
    v_mfma_f32_16x16x32_bf16 v[224:227], a[128:131], a[16:19], 0
    ds_read_b128 v[220:223], v251 offset:2112
    ds_read_b64_tr_b16 a[214:215], v247 offset:25992
    v_mfma_f32_16x16x32_bf16 v[224:227], a[132:135], a[20:23], v[224:227]
    v_exp_f32 v196, v196
    v_mfma_f32_16x16x32_bf16 v[224:227], a[136:139], a[24:27], v[224:227]
    ds_read_b128 a[252:255], v251 offset:3168
    v_cvt_pk_bf16_f32 v252, v192, v193
    v_mfma_f32_16x16x32_bf16 v[224:227], a[140:143], a[28:31], v[224:227]
    v_exp_f32 v197, v197
    v_mfma_f32_16x16x32_bf16 v[228:231], a[156:159], a[28:31], 0
    v_exp_f32 v198, v198
    v_mfma_f32_16x16x32_bf16 v[228:231], a[152:155], a[24:27], v[228:231]
    v_exp_f32 v199, v199
    v_mfma_f32_16x16x32_bf16 v[228:231], a[148:151], a[20:23], v[228:231]
    v_cvt_pk_bf16_f32 v253, v194, v195
    v_cvt_pk_bf16_f32 v254, v196, v197
    v_mfma_f32_16x16x32_bf16 v[228:231], a[144:147], a[16:19], v[228:231]
    s_waitcnt lgkmcnt(15)
    ds_read_b64_tr_b16 a[184:185], v247 offset:8640
    v_cvt_pk_bf16_f32 v255, v198, v199
    v_mfma_f32_16x16x32_bf16 a[228:231], a[224:227], v[240:243], a[228:231]
    ds_read_b64_tr_b16 a[186:187], v247 offset:9152
    v_fma_f32 v200, v200, s21, v233
    v_mfma_f32_16x16x32_bf16 a[228:231], a[224:227], v[252:255], a[228:231]
    s_waitcnt lgkmcnt(2)
    buffer_store_dwordx4 v[220:223], v248, s[16:19], s25 offen sc1
    ds_read_b64_tr_b16 a[216:217], v247 offset:25536
    v_fma_f32 v201, v201, s21, v233
    v_fma_f32 v202, v202, s21, v233
    v_fma_f32 v203, v203, s21, v233
    v_mfma_f32_16x16x32_bf16 v[0:3], a[192:195], v[252:255], v[0:3]
    ds_read_b64_tr_b16 a[218:219], v247 offset:26048
    v_fma_f32 v204, v204, s21, v233
    v_mfma_f32_16x16x32_bf16 v[0:3], a[160:163], v[240:243], v[0:3]
    s_waitcnt lgkmcnt(14)
    ds_read_b64_tr_b16 a[188:189], v247 offset:8648
    v_fma_f32 v205, v205, s21, v233
    v_mfma_f32_16x16x32_bf16 v[4:7], a[164:167], v[240:243], v[4:7]
    buffer_store_dwordx4 a[252:255], v248, s[16:19], s25 offen offset:1024 sc1
    ds_read_b64_tr_b16 a[190:191], v247 offset:9160
    v_exp_f32 v200, v200
    v_fma_f32 v206, v206, s21, v233
    v_mfma_f32_16x16x32_bf16 v[4:7], a[196:199], v[252:255], v[4:7]
Lhop10:
    s_cbranch_execz Lret2
    s_add_u32 s25, s25, 2048
    ds_read_b64_tr_b16 a[220:221], v247 offset:25544
    v_fma_f32 v207, v207, s21, v233
    v_mfma_f32_16x16x32_bf16 v[8:11], a[200:203], v[252:255], v[8:11]
    ds_read_b64_tr_b16 a[222:223], v247 offset:26056
    v_fma_f32 v224, v224, s21, v233
    v_mfma_f32_16x16x32_bf16 v[8:11], a[168:171], v[240:243], v[8:11]
    s_waitcnt lgkmcnt(9)
    v_exp_f32 v201, v201
    v_mfma_f32_16x16x32_bf16 v[12:15], a[172:175], v[240:243], v[12:15]
    v_exp_f32 v202, v202
    v_mfma_f32_16x16x32_bf16 v[12:15], a[204:207], v[252:255], v[12:15]
    v_exp_f32 v203, v203
    v_mfma_f32_16x16x32_bf16 v[16:19], a[208:211], v[252:255], v[16:19]
    v_cvt_pk_bf16_f32 v208, v200, v201
    v_cvt_pk_bf16_f32 v209, v202, v203
    v_mfma_f32_16x16x32_bf16 v[16:19], a[176:179], v[240:243], v[16:19]
    v_exp_f32 v204, v204
    v_mfma_f32_16x16x32_bf16 v[20:23], a[180:183], v[240:243], v[20:23]
    v_exp_f32 v205, v205
    v_mfma_f32_16x16x32_bf16 v[20:23], a[212:215], v[252:255], v[20:23]
    s_waitcnt lgkmcnt(0)
    v_exp_f32 v206, v206
    v_mfma_f32_16x16x32_bf16 v[24:27], a[216:219], v[252:255], v[24:27]
    v_exp_f32 v207, v207
    v_mfma_f32_16x16x32_bf16 v[24:27], a[184:187], v[240:243], v[24:27]
    v_cvt_pk_bf16_f32 v210, v204, v205
    v_cvt_pk_bf16_f32 v211, v206, v207
    v_mfma_f32_16x16x32_bf16 v[28:31], a[188:191], v[240:243], v[28:31]
    v_fma_f32 v225, v225, s21, v233
    v_fma_f32 v226, v226, s21, v233
    v_mfma_f32_16x16x32_bf16 v[28:31], a[220:223], v[252:255], v[28:31]
    v_fma_f32 v227, v227, s21, v233
    v_fma_f32 v228, v228, s21, v233
    v_mfma_f32_16x16x32_bf16 v[192:195], a[96:99], a[32:35], 0
    v_fma_f32 v229, v229, s21, v233
    v_fma_f32 v230, v230, s21, v233
    v_mfma_f32_16x16x32_bf16 v[192:195], a[100:103], a[36:39], v[192:195]
    v_exp_f32 v224, v224
    v_mfma_f32_16x16x32_bf16 v[192:195], a[104:107], a[40:43], v[192:195]
    v_exp_f32 v225, v225
    v_accvgpr_read_b32 v239, a228
    v_rcp_f32 v238, v239
    v_cmp_ngt_f32 vcc, s34, v239
    v_pk_mul_f32 v[0:1], v[0:1], v[238:239] op_sel_hi:[1,0]
    v_pk_mul_f32 v[2:3], v[2:3], v[238:239] op_sel_hi:[1,0]
    v_pk_mul_f32 v[4:5], v[4:5], v[238:239] op_sel_hi:[1,0]
    v_pk_mul_f32 v[6:7], v[6:7], v[238:239] op_sel_hi:[1,0]
    v_pk_mul_f32 v[8:9], v[8:9], v[238:239] op_sel_hi:[1,0]
    v_pk_mul_f32 v[10:11], v[10:11], v[238:239] op_sel_hi:[1,0]
    v_pk_mul_f32 v[12:13], v[12:13], v[238:239] op_sel_hi:[1,0]
    v_pk_mul_f32 v[14:15], v[14:15], v[238:239] op_sel_hi:[1,0]
    v_pk_mul_f32 v[16:17], v[16:17], v[238:239] op_sel_hi:[1,0]
    v_pk_mul_f32 v[18:19], v[18:19], v[238:239] op_sel_hi:[1,0]
    v_pk_mul_f32 v[20:21], v[20:21], v[238:239] op_sel_hi:[1,0]
    v_pk_mul_f32 v[22:23], v[22:23], v[238:239] op_sel_hi:[1,0]
    v_pk_mul_f32 v[24:25], v[24:25], v[238:239] op_sel_hi:[1,0]
    v_pk_mul_f32 v[26:27], v[26:27], v[238:239] op_sel_hi:[1,0]
    v_pk_mul_f32 v[28:29], v[28:29], v[238:239] op_sel_hi:[1,0]
    v_pk_mul_f32 v[30:31], v[30:31], v[238:239] op_sel_hi:[1,0]
    v_cvt_pk_bf16_f32 v0, v0, v1
    v_cvt_pk_bf16_f32 v1, v2, v3
    v_cvt_pk_bf16_f32 v2, v4, v5
    v_cvt_pk_bf16_f32 v3, v6, v7
    v_cvt_pk_bf16_f32 v8, v8, v9
    v_cvt_pk_bf16_f32 v9, v10, v11
    v_cvt_pk_bf16_f32 v10, v12, v13
    v_cvt_pk_bf16_f32 v11, v14, v15
    v_cvt_pk_bf16_f32 v16, v16, v17
    v_cvt_pk_bf16_f32 v17, v18, v19
    v_cvt_pk_bf16_f32 v18, v20, v21
    v_cvt_pk_bf16_f32 v19, v22, v23
    v_cvt_pk_bf16_f32 v24, v24, v25
    v_cvt_pk_bf16_f32 v25, v26, v27
    v_cvt_pk_bf16_f32 v26, v28, v29
    v_cvt_pk_bf16_f32 v27, v30, v31
    v_mfma_f32_16x16x32_bf16 v[192:195], a[108:111], a[44:47], v[192:195]
    s_or_b64 s[78:79], s[78:79], vcc
    ds_write_b128 v250, v[0:3] offset:16896
    v_mfma_f32_16x16x32_bf16 v[196:199], a[124:127], a[44:47], 0
    v_fma_f32 v231, v231, s21, v233
    v_cvt_pk_bf16_f32 v212, v224, v225
    v_mfma_f32_16x16x32_bf16 v[196:199], a[120:123], a[40:43], v[196:199]
    v_exp_f32 v226, v226
    v_mfma_f32_16x16x32_bf16 v[196:199], a[116:119], a[36:39], v[196:199]
    v_exp_f32 v227, v227
    v_mfma_f32_16x16x32_bf16 v[196:199], a[112:115], a[32:35], v[196:199]
    ds_write_b128 v250, v[8:11] offset:16960
    v_mfma_f32_16x16x32_bf16 v[200:203], a[128:131], a[32:35], 0
    v_exp_f32 v228, v228
    v_mfma_f32_16x16x32_bf16 v[200:203], a[132:135], a[36:39], v[200:203]
    v_exp_f32 v229, v229
    v_mfma_f32_16x16x32_bf16 v[200:203], a[136:139], a[40:43], v[200:203]
    v_exp_f32 v230, v230
    v_mfma_f32_16x16x32_bf16 v[200:203], a[140:143], a[44:47], v[200:203]
    ds_write_b128 v250, v[16:19] offset:17024
    v_mfma_f32_16x16x32_bf16 v[204:207], a[156:159], a[44:47], 0
    v_exp_f32 v231, v231
    v_mfma_f32_16x16x32_bf16 v[204:207], a[152:155], a[40:43], v[204:207]
    v_cvt_pk_bf16_f32 v213, v226, v227
    v_cvt_pk_bf16_f32 v214, v228, v229
    v_mfma_f32_16x16x32_bf16 v[204:207], a[148:151], a[36:39], v[204:207]
    v_cvt_pk_bf16_f32 v215, v230, v231
    v_fma_f32 v192, v192, s21, v234
    v_mfma_f32_16x16x32_bf16 v[204:207], a[144:147], a[32:35], v[204:207]
    ds_write_b128 v250, v[24:27] offset:17088
    v_add_u32 v250, 84480, v250
    v_mfma_f32_16x16x32_bf16 a[232:235], a[224:227], v[208:211], a[232:235]
    v_fma_f32 v193, v193, s21, v234
    v_fma_f32 v194, v194, s21, v234
    v_mfma_f32_16x16x32_bf16 a[232:235], a[224:227], v[212:215], a[232:235]
    v_fma_f32 v195, v195, s21, v234
    v_fma_f32 v196, v196, s21, v234
    v_mfma_f32_16x16x32_bf16 v[32:35], a[192:195], v[212:215], v[32:35]
    ds_read_b128 a[0:3], v251 offset:16896
    v_fma_f32 v197, v197, s21, v234
    v_mfma_f32_16x16x32_bf16 v[32:35], a[160:163], v[208:211], v[32:35]
    ds_read_b128 a[4:7], v251 offset:17952
    v_fma_f32 v198, v198, s21, v234
    v_mfma_f32_16x16x32_bf16 v[36:39], a[164:167], v[208:211], v[36:39]
    ds_read_b128 a[8:11], v251 offset:19008
    v_fma_f32 v199, v199, s21, v234
    v_mfma_f32_16x16x32_bf16 v[36:39], a[196:199], v[212:215], v[36:39]
    ds_read_b128 a[12:15], v251 offset:20064
    v_add_u32 v251, 84480, v251
    v_mfma_f32_16x16x32_bf16 v[40:43], a[200:203], v[212:215], v[40:43]
    v_exp_f32 v192, v192
    v_mfma_f32_16x16x32_bf16 v[40:43], a[168:171], v[208:211], v[40:43]
    v_exp_f32 v193, v193
    v_mfma_f32_16x16x32_bf16 v[44:47], a[172:175], v[208:211], v[44:47]
    v_exp_f32 v194, v194
    v_mfma_f32_16x16x32_bf16 v[44:47], a[204:207], v[212:215], v[44:47]
    v_exp_f32 v195, v195
    v_mfma_f32_16x16x32_bf16 v[48:51], a[208:211], v[212:215], v[48:51]
    v_cvt_pk_bf16_f32 v240, v192, v193
    v_cvt_pk_bf16_f32 v241, v194, v195
    v_mfma_f32_16x16x32_bf16 v[48:51], a[176:179], v[208:211], v[48:51]
    v_exp_f32 v196, v196
    v_mfma_f32_16x16x32_bf16 v[52:55], a[180:183], v[208:211], v[52:55]
    v_exp_f32 v197, v197
    v_mfma_f32_16x16x32_bf16 v[52:55], a[212:215], v[212:215], v[52:55]
    v_exp_f32 v198, v198
    v_mfma_f32_16x16x32_bf16 v[56:59], a[216:219], v[212:215], v[56:59]
    s_waitcnt lgkmcnt(0)
    buffer_store_dwordx4 a[0:3], v248, s[16:19], s26 offen sc1
    v_exp_f32 v199, v199
    v_cvt_pk_bf16_f32 v242, v196, v197
    v_cvt_pk_bf16_f32 v243, v198, v199
    v_mfma_f32_16x16x32_bf16 v[56:59], a[184:187], v[208:211], v[56:59]
    v_fma_f32 v200, v200, s21, v234
    v_fma_f32 v201, v201, s21, v234
    v_mfma_f32_16x16x32_bf16 v[60:63], a[188:191], v[208:211], v[60:63]
    v_fma_f32 v202, v202, s21, v234
    v_fma_f32 v203, v203, s21, v234
    v_mfma_f32_16x16x32_bf16 v[60:63], a[220:223], v[212:215], v[60:63]
    v_fma_f32 v204, v204, s21, v234
    v_fma_f32 v205, v205, s21, v234
    v_mfma_f32_16x16x32_bf16 v[224:227], a[96:99], a[48:51], 0
    buffer_store_dwordx4 a[4:7], v248, s[16:19], s26 offen offset:1024 sc1
    v_fma_f32 v206, v206, s21, v234
    v_fma_f32 v207, v207, s21, v234
    v_exp_f32 v200, v200
    v_mfma_f32_16x16x32_bf16 v[224:227], a[100:103], a[52:55], v[224:227]
    v_exp_f32 v201, v201
    v_accvgpr_read_b32 v239, a232
    v_rcp_f32 v238, v239
    v_cmp_ngt_f32 vcc, s34, v239
    v_pk_mul_f32 v[32:33], v[32:33], v[238:239] op_sel_hi:[1,0]
    v_pk_mul_f32 v[34:35], v[34:35], v[238:239] op_sel_hi:[1,0]
    v_pk_mul_f32 v[36:37], v[36:37], v[238:239] op_sel_hi:[1,0]
    v_pk_mul_f32 v[38:39], v[38:39], v[238:239] op_sel_hi:[1,0]
    v_pk_mul_f32 v[40:41], v[40:41], v[238:239] op_sel_hi:[1,0]
    v_pk_mul_f32 v[42:43], v[42:43], v[238:239] op_sel_hi:[1,0]
    v_pk_mul_f32 v[44:45], v[44:45], v[238:239] op_sel_hi:[1,0]
    v_pk_mul_f32 v[46:47], v[46:47], v[238:239] op_sel_hi:[1,0]
    v_pk_mul_f32 v[48:49], v[48:49], v[238:239] op_sel_hi:[1,0]
    v_pk_mul_f32 v[50:51], v[50:51], v[238:239] op_sel_hi:[1,0]
    v_pk_mul_f32 v[52:53], v[52:53], v[238:239] op_sel_hi:[1,0]
    v_pk_mul_f32 v[54:55], v[54:55], v[238:239] op_sel_hi:[1,0]
    v_pk_mul_f32 v[56:57], v[56:57], v[238:239] op_sel_hi:[1,0]
    v_pk_mul_f32 v[58:59], v[58:59], v[238:239] op_sel_hi:[1,0]
    v_pk_mul_f32 v[60:61], v[60:61], v[238:239] op_sel_hi:[1,0]
    v_pk_mul_f32 v[62:63], v[62:63], v[238:239] op_sel_hi:[1,0]
    v_cvt_pk_bf16_f32 v32, v32, v33
    v_cvt_pk_bf16_f32 v33, v34, v35
    v_cvt_pk_bf16_f32 v34, v36, v37
    v_cvt_pk_bf16_f32 v35, v38, v39
    v_cvt_pk_bf16_f32 v40, v40, v41
    v_cvt_pk_bf16_f32 v41, v42, v43
    v_cvt_pk_bf16_f32 v42, v44, v45
    v_cvt_pk_bf16_f32 v43, v46, v47
    v_cvt_pk_bf16_f32 v48, v48, v49
    v_cvt_pk_bf16_f32 v49, v50, v51
    v_cvt_pk_bf16_f32 v50, v52, v53
    v_cvt_pk_bf16_f32 v51, v54, v55
    v_cvt_pk_bf16_f32 v56, v56, v57
    v_cvt_pk_bf16_f32 v57, v58, v59
    v_cvt_pk_bf16_f32 v58, v60, v61
    v_cvt_pk_bf16_f32 v59, v62, v63
    v_mfma_f32_16x16x32_bf16 v[224:227], a[104:107], a[56:59], v[224:227]
    s_or_b64 s[78:79], s[78:79], vcc
    ds_write_b128 v250, v[32:35] offset:50688
    v_mfma_f32_16x16x32_bf16 v[224:227], a[108:111], a[60:63], v[224:227]
    v_exp_f32 v202, v202
    v_mfma_f32_16x16x32_bf16 v[228:231], a[124:127], a[60:63], 0
    buffer_store_dwordx4 a[8:11], v248, s[16:19], s26 offen offset:2048 sc1
    v_exp_f32 v203, v203
    v_exp_f32 v204, v204
    v_mfma_f32_16x16x32_bf16 v[228:231], a[120:123], a[56:59], v[228:231]
    v_exp_f32 v205, v205
    v_mfma_f32_16x16x32_bf16 v[228:231], a[116:119], a[52:55], v[228:231]
    ds_write_b128 v250, v[40:43] offset:50752
    v_mfma_f32_16x16x32_bf16 v[228:231], a[112:115], a[48:51], v[228:231]
    v_exp_f32 v206, v206
    v_mfma_f32_16x16x32_bf16 v[192:195], a[128:131], a[48:51], 0
    buffer_store_dwordx4 a[12:15], v248, s[16:19], s26 offen offset:3072 sc1
    v_exp_f32 v207, v207
    v_cvt_pk_bf16_f32 v252, v200, v201
    v_cvt_pk_bf16_f32 v253, v202, v203
    v_mfma_f32_16x16x32_bf16 v[192:195], a[132:135], a[52:55], v[192:195]
    s_add_u32 s26, s26, 4096
    v_cvt_pk_bf16_f32 v254, v204, v205
    v_cvt_pk_bf16_f32 v255, v206, v207
    v_mfma_f32_16x16x32_bf16 v[192:195], a[136:139], a[56:59], v[192:195]
    ds_write_b128 v250, v[48:51] offset:50816
    v_mfma_f32_16x16x32_bf16 v[192:195], a[140:143], a[60:63], v[192:195]
    v_fma_f32 v224, v224, s21, v235
    v_fma_f32 v225, v225, s21, v235
    v_mfma_f32_16x16x32_bf16 v[196:199], a[156:159], a[60:63], 0
    v_fma_f32 v226, v226, s21, v235
    v_fma_f32 v227, v227, s21, v235
    v_mfma_f32_16x16x32_bf16 v[196:199], a[152:155], a[56:59], v[196:199]
    v_exp_f32 v224, v224
    v_mfma_f32_16x16x32_bf16 v[196:199], a[148:151], a[52:55], v[196:199]
    ds_write_b128 v250, v[56:59] offset:50880
    v_mfma_f32_16x16x32_bf16 v[196:199], a[144:147], a[48:51], v[196:199]
    v_exp_f32 v225, v225
    v_mfma_f32_16x16x32_bf16 a[236:239], a[224:227], v[240:243], a[236:239]
    v_exp_f32 v226, v226
    v_mfma_f32_16x16x32_bf16 a[236:239], a[224:227], v[252:255], a[236:239]
    ds_read_b128 a[16:19], v251 offset:50688
    v_cvt_pk_bf16_f32 v208, v224, v225
    v_mfma_f32_16x16x32_bf16 v[64:67], a[192:195], v[252:255], v[64:67]
    ds_read_b128 a[20:23], v251 offset:51744
    v_fma_f32 v228, v228, s21, v235
    v_mfma_f32_16x16x32_bf16 v[64:67], a[160:163], v[240:243], v[64:67]
    ds_read_b128 a[24:27], v251 offset:52800
    v_fma_f32 v229, v229, s21, v235
    v_mfma_f32_16x16x32_bf16 v[68:71], a[164:167], v[240:243], v[68:71]
    ds_read_b128 a[28:31], v251 offset:53856
    v_fma_f32 v230, v230, s21, v235
    v_mfma_f32_16x16x32_bf16 v[68:71], a[196:199], v[252:255], v[68:71]
    v_exp_f32 v227, v227
    v_mfma_f32_16x16x32_bf16 v[72:75], a[200:203], v[252:255], v[72:75]
    v_cvt_pk_bf16_f32 v209, v226, v227
    v_fma_f32 v231, v231, s21, v235
    v_mfma_f32_16x16x32_bf16 v[72:75], a[168:171], v[240:243], v[72:75]
    v_exp_f32 v228, v228
    v_mfma_f32_16x16x32_bf16 v[76:79], a[172:175], v[240:243], v[76:79]
    v_exp_f32 v229, v229
    v_mfma_f32_16x16x32_bf16 v[76:79], a[204:207], v[252:255], v[76:79]
    v_exp_f32 v230, v230
    v_mfma_f32_16x16x32_bf16 v[80:83], a[208:211], v[252:255], v[80:83]
    v_exp_f32 v231, v231
    v_mfma_f32_16x16x32_bf16 v[80:83], a[176:179], v[240:243], v[80:83]
    v_cvt_pk_bf16_f32 v210, v228, v229
    v_cvt_pk_bf16_f32 v211, v230, v231
    v_mfma_f32_16x16x32_bf16 v[84:87], a[180:183], v[240:243], v[84:87]
    s_waitcnt lgkmcnt(0)
    buffer_store_dwordx4 a[16:19], v248, s[16:19], s26 offen sc1
    v_fma_f32 v192, v192, s21, v235
    v_fma_f32 v193, v193, s21, v235
    v_fma_f32 v194, v194, s21, v235
    v_fma_f32 v195, v195, s21, v235
    v_mfma_f32_16x16x32_bf16 v[84:87], a[212:215], v[252:255], v[84:87]
    v_fma_f32 v196, v196, s21, v235
    v_fma_f32 v197, v197, s21, v235
    v_mfma_f32_16x16x32_bf16 v[88:91], a[216:219], v[252:255], v[88:91]
    v_fma_f32 v198, v198, s21, v235
    v_fma_f32 v199, v199, s21, v235
    v_mfma_f32_16x16x32_bf16 v[88:91], a[184:187], v[240:243], v[88:91]
    v_exp_f32 v192, v192
    v_mfma_f32_16x16x32_bf16 v[92:95], a[188:191], v[240:243], v[92:95]
    buffer_store_dwordx4 a[20:23], v248, s[16:19], s26 offen offset:1024 sc1
    v_exp_f32 v193, v193
    v_exp_f32 v194, v194
    v_mfma_f32_16x16x32_bf16 v[92:95], a[220:223], v[252:255], v[92:95]
    v_exp_f32 v195, v195
    v_mfma_f32_16x16x32_bf16 v[200:203], a[96:99], a[64:67], 0
    v_exp_f32 v196, v196
    v_mfma_f32_16x16x32_bf16 v[200:203], a[100:103], a[68:71], v[200:203]
    v_exp_f32 v197, v197
    v_mfma_f32_16x16x32_bf16 v[200:203], a[104:107], a[72:75], v[200:203]
    buffer_store_dwordx4 a[24:27], v248, s[16:19], s26 offen offset:2048 sc1
    v_exp_f32 v198, v198
    v_accvgpr_read_b32 v239, a236
    v_rcp_f32 v238, v239
    v_cmp_ngt_f32 vcc, s34, v239
    v_pk_mul_f32 v[64:65], v[64:65], v[238:239] op_sel_hi:[1,0]
    v_pk_mul_f32 v[66:67], v[66:67], v[238:239] op_sel_hi:[1,0]
    v_pk_mul_f32 v[68:69], v[68:69], v[238:239] op_sel_hi:[1,0]
    v_pk_mul_f32 v[70:71], v[70:71], v[238:239] op_sel_hi:[1,0]
    v_pk_mul_f32 v[72:73], v[72:73], v[238:239] op_sel_hi:[1,0]
    v_pk_mul_f32 v[74:75], v[74:75], v[238:239] op_sel_hi:[1,0]
    v_pk_mul_f32 v[76:77], v[76:77], v[238:239] op_sel_hi:[1,0]
    v_pk_mul_f32 v[78:79], v[78:79], v[238:239] op_sel_hi:[1,0]
    v_pk_mul_f32 v[80:81], v[80:81], v[238:239] op_sel_hi:[1,0]
    v_pk_mul_f32 v[82:83], v[82:83], v[238:239] op_sel_hi:[1,0]
    v_pk_mul_f32 v[84:85], v[84:85], v[238:239] op_sel_hi:[1,0]
    v_pk_mul_f32 v[86:87], v[86:87], v[238:239] op_sel_hi:[1,0]
    v_pk_mul_f32 v[88:89], v[88:89], v[238:239] op_sel_hi:[1,0]
    v_pk_mul_f32 v[90:91], v[90:91], v[238:239] op_sel_hi:[1,0]
    v_pk_mul_f32 v[92:93], v[92:93], v[238:239] op_sel_hi:[1,0]
    v_pk_mul_f32 v[94:95], v[94:95], v[238:239] op_sel_hi:[1,0]
    v_cvt_pk_bf16_f32 v64, v64, v65
    v_cvt_pk_bf16_f32 v65, v66, v67
    v_cvt_pk_bf16_f32 v66, v68, v69
    v_cvt_pk_bf16_f32 v67, v70, v71
    v_cvt_pk_bf16_f32 v72, v72, v73
    v_cvt_pk_bf16_f32 v73, v74, v75
    v_cvt_pk_bf16_f32 v74, v76, v77
    v_cvt_pk_bf16_f32 v75, v78, v79
    v_cvt_pk_bf16_f32 v80, v80, v81
    v_cvt_pk_bf16_f32 v81, v82, v83
    v_cvt_pk_bf16_f32 v82, v84, v85
    v_cvt_pk_bf16_f32 v83, v86, v87
    v_cvt_pk_bf16_f32 v88, v88, v89
    v_cvt_pk_bf16_f32 v89, v90, v91
    v_cvt_pk_bf16_f32 v90, v92, v93
    v_cvt_pk_bf16_f32 v91, v94, v95
    v_mfma_f32_16x16x32_bf16 v[200:203], a[108:111], a[76:79], v[200:203]
    s_or_b64 s[78:79], s[78:79], vcc
    ds_write_b128 v250, v[64:67] offset:16896
    v_mfma_f32_16x16x32_bf16 v[204:207], a[124:127], a[76:79], 0
    v_exp_f32 v199, v199
    v_mfma_f32_16x16x32_bf16 v[204:207], a[120:123], a[72:75], v[204:207]
    v_cvt_pk_bf16_f32 v212, v192, v193
    v_cvt_pk_bf16_f32 v213, v194, v195
    v_mfma_f32_16x16x32_bf16 v[204:207], a[116:119], a[68:71], v[204:207]
    buffer_store_dwordx4 a[28:31], v248, s[16:19], s26 offen offset:3072 sc1
    v_cvt_pk_bf16_f32 v214, v196, v197
    v_cvt_pk_bf16_f32 v215, v198, v199
    v_fma_f32 v200, v200, s21, v236
    v_fma_f32 v201, v201, s21, v236
    v_mfma_f32_16x16x32_bf16 v[204:207], a[112:115], a[64:67], v[204:207]
    s_add_u32 s26, s26, 4096
    ds_write_b128 v250, v[72:75] offset:16960
    v_mfma_f32_16x16x32_bf16 v[224:227], a[128:131], a[64:67], 0
    v_fma_f32 v202, v202, s21, v236
    v_fma_f32 v203, v203, s21, v236
    v_mfma_f32_16x16x32_bf16 v[224:227], a[132:135], a[68:71], v[224:227]
    v_exp_f32 v200, v200
    v_mfma_f32_16x16x32_bf16 v[224:227], a[136:139], a[72:75], v[224:227]
    v_exp_f32 v201, v201
    v_mfma_f32_16x16x32_bf16 v[224:227], a[140:143], a[76:79], v[224:227]
    ds_write_b128 v250, v[80:83] offset:17024
    v_mfma_f32_16x16x32_bf16 v[228:231], a[156:159], a[76:79], 0
    v_exp_f32 v202, v202
    v_mfma_f32_16x16x32_bf16 v[228:231], a[152:155], a[72:75], v[228:231]
    v_exp_f32 v203, v203
    v_mfma_f32_16x16x32_bf16 v[228:231], a[148:151], a[68:71], v[228:231]
    v_cvt_pk_bf16_f32 v240, v200, v201
    v_cvt_pk_bf16_f32 v241, v202, v203
    v_mfma_f32_16x16x32_bf16 v[228:231], a[144:147], a[64:67], v[228:231]
    ds_write_b128 v250, v[88:91] offset:17088
    v_mfma_f32_16x16x32_bf16 a[240:243], a[224:227], v[208:211], a[240:243]
    v_fma_f32 v204, v204, s21, v236
    v_fma_f32 v205, v205, s21, v236
    v_mfma_f32_16x16x32_bf16 a[240:243], a[224:227], v[212:215], a[240:243]
    v_fma_f32 v206, v206, s21, v236
    v_fma_f32 v207, v207, s21, v236
    v_mfma_f32_16x16x32_bf16 v[96:99], a[192:195], v[212:215], v[96:99]
    ds_read_b128 a[32:35], v251 offset:16896
    v_fma_f32 v224, v224, s21, v236
    v_mfma_f32_16x16x32_bf16 v[96:99], a[160:163], v[208:211], v[96:99]
    ds_read_b128 a[36:39], v251 offset:17952
    v_fma_f32 v225, v225, s21, v236
    v_mfma_f32_16x16x32_bf16 v[100:103], a[164:167], v[208:211], v[100:103]
    ds_read_b128 a[40:43], v251 offset:19008
    v_fma_f32 v226, v226, s21, v236
    v_mfma_f32_16x16x32_bf16 v[100:103], a[196:199], v[212:215], v[100:103]
    ds_read_b128 a[44:47], v251 offset:20064
    v_fma_f32 v227, v227, s21, v236
    v_mfma_f32_16x16x32_bf16 v[104:107], a[200:203], v[212:215], v[104:107]
    v_exp_f32 v204, v204
    v_mfma_f32_16x16x32_bf16 v[104:107], a[168:171], v[208:211], v[104:107]
    v_exp_f32 v205, v205
    v_mfma_f32_16x16x32_bf16 v[108:111], a[172:175], v[208:211], v[108:111]
    v_exp_f32 v206, v206
    v_mfma_f32_16x16x32_bf16 v[108:111], a[204:207], v[212:215], v[108:111]
    v_exp_f32 v207, v207
    v_mfma_f32_16x16x32_bf16 v[112:115], a[208:211], v[212:215], v[112:115]
    v_cvt_pk_bf16_f32 v242, v204, v205
    v_cvt_pk_bf16_f32 v243, v206, v207
    v_mfma_f32_16x16x32_bf16 v[112:115], a[176:179], v[208:211], v[112:115]
    v_fma_f32 v228, v228, s21, v236
    v_fma_f32 v229, v229, s21, v236
    v_mfma_f32_16x16x32_bf16 v[116:119], a[180:183], v[208:211], v[116:119]
    v_fma_f32 v230, v230, s21, v236
    v_fma_f32 v231, v231, s21, v236
    v_mfma_f32_16x16x32_bf16 v[116:119], a[212:215], v[212:215], v[116:119]
    s_waitcnt lgkmcnt(0)
    buffer_store_dwordx4 a[32:35], v248, s[16:19], s26 offen sc1
    v_exp_f32 v224, v224
    v_exp_f32 v225, v225
    v_mfma_f32_16x16x32_bf16 v[120:123], a[216:219], v[212:215], v[120:123]
    v_exp_f32 v226, v226
    v_mfma_f32_16x16x32_bf16 v[120:123], a[184:187], v[208:211], v[120:123]
    v_exp_f32 v227, v227
    v_mfma_f32_16x16x32_bf16 v[124:127], a[188:191], v[208:211], v[124:127]
    v_exp_f32 v228, v228
    v_mfma_f32_16x16x32_bf16 v[124:127], a[220:223], v[212:215], v[124:127]
    buffer_store_dwordx4 a[36:39], v248, s[16:19], s26 offen offset:1024 sc1
    v_exp_f32 v229, v229
    v_exp_f32 v230, v230
    v_mfma_f32_16x16x32_bf16 v[192:195], a[96:99], a[80:83], 0
    ds_read_b128 a[96:99], v246 offset:33792
    v_cvt_pk_bf16_f32 v252, v224, v225
    v_mfma_f32_16x16x32_bf16 v[192:195], a[100:103], a[84:87], v[192:195]
    v_exp_f32 v231, v231
    v_accvgpr_read_b32 v239, a240
    v_rcp_f32 v238, v239
    v_cmp_ngt_f32 vcc, s34, v239
    v_pk_mul_f32 v[96:97], v[96:97], v[238:239] op_sel_hi:[1,0]
    v_pk_mul_f32 v[98:99], v[98:99], v[238:239] op_sel_hi:[1,0]
    v_pk_mul_f32 v[100:101], v[100:101], v[238:239] op_sel_hi:[1,0]
    v_pk_mul_f32 v[102:103], v[102:103], v[238:239] op_sel_hi:[1,0]
    v_pk_mul_f32 v[104:105], v[104:105], v[238:239] op_sel_hi:[1,0]
    v_pk_mul_f32 v[106:107], v[106:107], v[238:239] op_sel_hi:[1,0]
    v_pk_mul_f32 v[108:109], v[108:109], v[238:239] op_sel_hi:[1,0]
    v_pk_mul_f32 v[110:111], v[110:111], v[238:239] op_sel_hi:[1,0]
    v_pk_mul_f32 v[112:113], v[112:113], v[238:239] op_sel_hi:[1,0]
    v_pk_mul_f32 v[114:115], v[114:115], v[238:239] op_sel_hi:[1,0]
    v_pk_mul_f32 v[116:117], v[116:117], v[238:239] op_sel_hi:[1,0]
    v_pk_mul_f32 v[118:119], v[118:119], v[238:239] op_sel_hi:[1,0]
    v_pk_mul_f32 v[120:121], v[120:121], v[238:239] op_sel_hi:[1,0]
    v_pk_mul_f32 v[122:123], v[122:123], v[238:239] op_sel_hi:[1,0]
    v_pk_mul_f32 v[124:125], v[124:125], v[238:239] op_sel_hi:[1,0]
    v_pk_mul_f32 v[126:127], v[126:127], v[238:239] op_sel_hi:[1,0]
    v_cvt_pk_bf16_f32 v96, v96, v97
    v_cvt_pk_bf16_f32 v97, v98, v99
    v_cvt_pk_bf16_f32 v98, v100, v101
    v_cvt_pk_bf16_f32 v99, v102, v103
    v_cvt_pk_bf16_f32 v104, v104, v105
    v_cvt_pk_bf16_f32 v105, v106, v107
    v_cvt_pk_bf16_f32 v106, v108, v109
    v_cvt_pk_bf16_f32 v107, v110, v111
    v_cvt_pk_bf16_f32 v112, v112, v113
    v_cvt_pk_bf16_f32 v113, v114, v115
    v_cvt_pk_bf16_f32 v114, v116, v117
    v_cvt_pk_bf16_f32 v115, v118, v119
    v_cvt_pk_bf16_f32 v120, v120, v121
    v_cvt_pk_bf16_f32 v121, v122, v123
    v_cvt_pk_bf16_f32 v122, v124, v125
    v_cvt_pk_bf16_f32 v123, v126, v127
    v_mfma_f32_16x16x32_bf16 v[192:195], a[104:107], a[88:91], v[192:195]
    s_or_b64 s[78:79], s[78:79], vcc
    ds_write_b128 v250, v[96:99] offset:33792
    v_mfma_f32_16x16x32_bf16 v[192:195], a[108:111], a[92:95], v[192:195]
    buffer_store_dwordx4 a[40:43], v248, s[16:19], s26 offen offset:2048 sc1
    v_cvt_pk_bf16_f32 v253, v226, v227
    v_cvt_pk_bf16_f32 v254, v228, v229
    v_cvt_pk_bf16_f32 v255, v230, v231
    v_mfma_f32_16x16x32_bf16 v[196:199], a[124:127], a[92:95], 0
    v_mfma_f32_16x16x32_bf16 v[196:199], a[120:123], a[88:91], v[196:199]
    ds_read_b128 a[100:103], v246 offset:33856
    ds_read_b128 a[104:107], v246 offset:33920
    v_mfma_f32_16x16x32_bf16 v[196:199], a[116:119], a[84:87], v[196:199]
    v_fma_f32 v192, v192, s21, v237
    v_fma_f32 v193, v193, s21, v237
    v_mfma_f32_16x16x32_bf16 v[196:199], a[112:115], a[80:83], v[196:199]
    ds_write_b128 v250, v[104:107] offset:33856
    v_mfma_f32_16x16x32_bf16 v[200:203], a[128:131], a[80:83], 0
    buffer_store_dwordx4 a[44:47], v248, s[16:19], s26 offen offset:3072 sc1
    v_fma_f32 v194, v194, s21, v237
    v_fma_f32 v195, v195, s21, v237
    v_exp_f32 v192, v192
    v_mfma_f32_16x16x32_bf16 v[200:203], a[132:135], a[84:87], v[200:203]
    s_add_u32 s26, s26, 4096
    v_exp_f32 v193, v193
    v_mfma_f32_16x16x32_bf16 v[200:203], a[136:139], a[88:91], v[200:203]
    ds_read_b128 a[108:111], v246 offset:33984
    ds_read_b128 a[124:127], v246 offset:34496
    v_mfma_f32_16x16x32_bf16 v[200:203], a[140:143], a[92:95], v[200:203]
    v_exp_f32 v194, v194
    v_mfma_f32_16x16x32_bf16 v[204:207], a[156:159], a[92:95], 0
    ds_write_b128 v250, v[112:115] offset:33920
    v_mfma_f32_16x16x32_bf16 v[204:207], a[152:155], a[88:91], v[204:207]
    v_exp_f32 v195, v195
    v_mfma_f32_16x16x32_bf16 v[204:207], a[148:151], a[84:87], v[204:207]
    v_cvt_pk_bf16_f32 v208, v192, v193
    v_cvt_pk_bf16_f32 v209, v194, v195
    v_mfma_f32_16x16x32_bf16 v[204:207], a[144:147], a[80:83], v[204:207]
    ds_read_b128 a[128:131], v246 offset:50688
    ds_read_b128 a[120:123], v246 offset:34432
    v_mfma_f32_16x16x32_bf16 a[244:247], a[224:227], v[240:243], a[244:247]
    v_fma_f32 v196, v196, s21, v237
    v_fma_f32 v197, v197, s21, v237
    v_mfma_f32_16x16x32_bf16 a[244:247], a[224:227], v[252:255], a[244:247]
    ds_write_b128 v250, v[120:123] offset:33984
    v_subrev_u32 v250, 84480, v250
    v_mfma_f32_16x16x32_bf16 v[128:131], a[192:195], v[252:255], v[128:131]
    v_fma_f32 v198, v198, s21, v237
    v_fma_f32 v199, v199, s21, v237
    v_mfma_f32_16x16x32_bf16 v[128:131], a[160:163], v[240:243], v[128:131]
    v_exp_f32 v196, v196
    v_mfma_f32_16x16x32_bf16 v[132:135], a[164:167], v[240:243], v[132:135]
    ds_read_b128 a[48:51], v251 offset:33792
    ds_read_b128 a[132:135], v246 offset:50752
    v_mfma_f32_16x16x32_bf16 v[132:135], a[196:199], v[252:255], v[132:135]
    v_exp_f32 v197, v197
    v_mfma_f32_16x16x32_bf16 v[136:139], a[200:203], v[252:255], v[136:139]
    ds_read_b128 a[52:55], v251 offset:34848
    ds_read_b128 a[116:119], v246 offset:34368
    v_mfma_f32_16x16x32_bf16 v[136:139], a[168:171], v[240:243], v[136:139]
    v_exp_f32 v198, v198
    v_mfma_f32_16x16x32_bf16 v[140:143], a[172:175], v[240:243], v[140:143]
    ds_read_b128 a[136:139], v246 offset:50816
    ds_read_b128 a[56:59], v251 offset:35904
    v_mfma_f32_16x16x32_bf16 v[140:143], a[204:207], v[252:255], v[140:143]
    v_exp_f32 v199, v199
    v_mfma_f32_16x16x32_bf16 v[144:147], a[208:211], v[252:255], v[144:147]
    ds_read_b128 a[112:115], v246 offset:34304
    ds_read_b128 a[140:143], v246 offset:50880
    v_mfma_f32_16x16x32_bf16 v[144:147], a[176:179], v[240:243], v[144:147]
    v_cvt_pk_bf16_f32 v210, v196, v197
    v_cvt_pk_bf16_f32 v211, v198, v199
    v_mfma_f32_16x16x32_bf16 v[148:151], a[180:183], v[240:243], v[148:151]
    ds_read_b128 a[156:159], v246 offset:51392
    ds_read_b128 a[60:63], v251 offset:36960
    v_subrev_u32 v251, 84480, v251
    v_mfma_f32_16x16x32_bf16 v[148:151], a[212:215], v[252:255], v[148:151]
    v_fma_f32 v200, v200, s21, v237
    v_fma_f32 v201, v201, s21, v237
    v_mfma_f32_16x16x32_bf16 v[152:155], a[216:219], v[252:255], v[152:155]
    ds_read_b128 a[152:155], v246 offset:51328
    ds_read_b128 a[148:151], v246 offset:51264
    v_mfma_f32_16x16x32_bf16 v[152:155], a[184:187], v[240:243], v[152:155]
    v_fma_f32 v202, v202, s21, v237
    v_fma_f32 v203, v203, s21, v237
    v_mfma_f32_16x16x32_bf16 v[156:159], a[188:191], v[240:243], v[156:159]
    s_waitcnt lgkmcnt(5)
    ds_read_b128 a[144:147], v246 offset:51200
    v_fma_f32 v204, v204, s21, v237
    v_mfma_f32_16x16x32_bf16 v[156:159], a[220:223], v[252:255], v[156:159]
    v_fma_f32 v205, v205, s21, v237
    v_fma_f32 v206, v206, s21, v237
    v_mfma_f32_16x16x32_bf16 v[224:227], a[96:99], a[64:67], 0
    s_waitcnt lgkmcnt(3)
    buffer_store_dwordx4 a[48:51], v248, s[16:19], s26 offen sc1
    v_fma_f32 v207, v207, s21, v237
    v_exp_f32 v200, v200
    v_mfma_f32_16x16x32_bf16 v[224:227], a[100:103], a[68:71], v[224:227]
    v_exp_f32 v201, v201
    v_mfma_f32_16x16x32_bf16 v[224:227], a[104:107], a[72:75], v[224:227]
Lhop11:
    s_cbranch_execz Lret2
    v_exp_f32 v202, v202
    v_mfma_f32_16x16x32_bf16 v[224:227], a[108:111], a[76:79], v[224:227]
    buffer_store_dwordx4 a[52:55], v248, s[16:19], s26 offen offset:1024 sc1
    v_exp_f32 v203, v203
    v_exp_f32 v204, v204
    v_mfma_f32_16x16x32_bf16 v[228:231], a[124:127], a[76:79], 0
    v_exp_f32 v205, v205
    v_mfma_f32_16x16x32_bf16 v[228:231], a[120:123], a[72:75], v[228:231]
    s_waitcnt lgkmcnt(0)
    v_exp_f32 v206, v206
    v_mfma_f32_16x16x32_bf16 v[228:231], a[116:119], a[68:71], v[228:231]
    buffer_store_dwordx4 a[56:59], v248, s[16:19], s26 offen offset:2048 sc1
    v_exp_f32 v207, v207
    v_cvt_pk_bf16_f32 v212, v200, v201
    v_cvt_pk_bf16_f32 v213, v202, v203
    v_mfma_f32_16x16x32_bf16 v[228:231], a[112:115], a[64:67], v[228:231]
    v_cvt_pk_bf16_f32 v214, v204, v205
    v_cvt_pk_bf16_f32 v215, v206, v207
    v_mfma_f32_16x16x32_bf16 v[192:195], a[128:131], a[64:67], 0
    v_fma_f32 v224, v224, s21, v236
    v_fma_f32 v225, v225, s21, v236
    v_mfma_f32_16x16x32_bf16 v[192:195], a[132:135], a[68:71], v[192:195]
    buffer_store_dwordx4 a[60:63], v248, s[16:19], s26 offen offset:3072 sc1
    v_fma_f32 v226, v226, s21, v236
    v_fma_f32 v227, v227, s21, v236
    v_exp_f32 v224, v224
    v_mfma_f32_16x16x32_bf16 v[192:195], a[136:139], a[72:75], v[192:195]
    s_add_u32 s26, s26, 4096
    v_exp_f32 v225, v225
    v_mfma_f32_16x16x32_bf16 v[192:195], a[140:143], a[76:79], v[192:195]
    v_exp_f32 v226, v226
    v_mfma_f32_16x16x32_bf16 v[196:199], a[156:159], a[76:79], 0
    v_exp_f32 v227, v227
    v_mfma_f32_16x16x32_bf16 v[196:199], a[152:155], a[72:75], v[196:199]
    v_cvt_pk_bf16_f32 v240, v224, v225
    v_cvt_pk_bf16_f32 v241, v226, v227
    v_mfma_f32_16x16x32_bf16 v[196:199], a[148:151], a[68:71], v[196:199]
    v_fma_f32 v228, v228, s21, v236
    v_fma_f32 v229, v229, s21, v236
    v_mfma_f32_16x16x32_bf16 v[196:199], a[144:147], a[64:67], v[196:199]
    v_fma_f32 v230, v230, s21, v236
    v_fma_f32 v231, v231, s21, v236
    v_mfma_f32_16x16x32_bf16 a[248:251], a[224:227], v[208:211], a[248:251]
    v_exp_f32 v228, v228
    v_mfma_f32_16x16x32_bf16 a[248:251], a[224:227], v[212:215], a[248:251]
    v_exp_f32 v229, v229
    v_mfma_f32_16x16x32_bf16 v[160:163], a[192:195], v[212:215], v[160:163]
    ds_read_b64_tr_b16 a[192:193], v247 offset:59136
    ds_read_b64_tr_b16 a[194:195], v247 offset:59648
    v_mfma_f32_16x16x32_bf16 v[160:163], a[160:163], v[208:211], v[160:163]
    v_exp_f32 v230, v230
    v_mfma_f32_16x16x32_bf16 v[164:167], a[164:167], v[208:211], v[164:167]
    ds_read_b64_tr_b16 a[160:161], v247 offset:42240
    ds_read_b64_tr_b16 a[162:163], v247 offset:42752
    v_mfma_f32_16x16x32_bf16 v[164:167], a[196:199], v[212:215], v[164:167]
    v_exp_f32 v231, v231
    v_mfma_f32_16x16x32_bf16 v[168:171], a[200:203], v[212:215], v[168:171]
    ds_read_b64_tr_b16 a[164:165], v247 offset:42248
    ds_read_b64_tr_b16 a[166:167], v247 offset:42760
    v_mfma_f32_16x16x32_bf16 v[168:171], a[168:171], v[208:211], v[168:171]
    v_cvt_pk_bf16_f32 v242, v228, v229
    v_cvt_pk_bf16_f32 v243, v230, v231
    v_mfma_f32_16x16x32_bf16 v[172:175], a[172:175], v[208:211], v[172:175]
    ds_read_b64_tr_b16 a[196:197], v247 offset:59144
    ds_read_b64_tr_b16 a[198:199], v247 offset:59656
    v_mfma_f32_16x16x32_bf16 v[172:175], a[204:207], v[212:215], v[172:175]
    v_fma_f32 v192, v192, s21, v236
    v_fma_f32 v193, v193, s21, v236
    v_mfma_f32_16x16x32_bf16 v[176:179], a[208:211], v[212:215], v[176:179]
    ds_read_b64_tr_b16 a[168:169], v247 offset:42304
    ds_read_b64_tr_b16 a[170:171], v247 offset:42816
    v_mfma_f32_16x16x32_bf16 v[176:179], a[176:179], v[208:211], v[176:179]
    v_fma_f32 v194, v194, s21, v236
    v_fma_f32 v195, v195, s21, v236
    v_mfma_f32_16x16x32_bf16 v[180:183], a[180:183], v[208:211], v[180:183]
    ds_read_b64_tr_b16 a[200:201], v247 offset:59200
    ds_read_b64_tr_b16 a[202:203], v247 offset:59712
    v_mfma_f32_16x16x32_bf16 v[180:183], a[212:215], v[212:215], v[180:183]
    v_fma_f32 v196, v196, s21, v236
    v_fma_f32 v197, v197, s21, v236
    v_mfma_f32_16x16x32_bf16 v[184:187], a[216:219], v[212:215], v[184:187]
    ds_read_b64_tr_b16 a[172:173], v247 offset:42312
    ds_read_b64_tr_b16 a[174:175], v247 offset:42824
    v_mfma_f32_16x16x32_bf16 v[184:187], a[184:187], v[208:211], v[184:187]
    v_fma_f32 v198, v198, s21, v236
    v_fma_f32 v199, v199, s21, v236
    v_mfma_f32_16x16x32_bf16 v[188:191], a[188:191], v[208:211], v[188:191]
    ds_read_b64_tr_b16 a[204:205], v247 offset:59208
    ds_read_b64_tr_b16 a[206:207], v247 offset:59720
    v_mfma_f32_16x16x32_bf16 v[188:191], a[220:223], v[212:215], v[188:191]
    v_exp_f32 v192, v192
    v_mfma_f32_16x16x32_bf16 v[200:203], a[96:99], a[80:83], 0
    ds_read_b64_tr_b16 a[176:177], v247 offset:42368
    ds_read_b64_tr_b16 a[178:179], v247 offset:42880
    v_mfma_f32_16x16x32_bf16 v[200:203], a[100:103], a[84:87], v[200:203]
    v_exp_f32 v193, v193
    v_mfma_f32_16x16x32_bf16 v[200:203], a[104:107], a[88:91], v[200:203]
    ds_read_b64_tr_b16 a[208:209], v247 offset:59264
    ds_read_b64_tr_b16 a[210:211], v247 offset:59776
    v_mfma_f32_16x16x32_bf16 v[200:203], a[108:111], a[92:95], v[200:203]
    v_exp_f32 v194, v194
    v_mfma_f32_16x16x32_bf16 v[204:207], a[124:127], a[92:95], 0
    ds_read_b64_tr_b16 a[180:181], v247 offset:42376
    ds_read_b64_tr_b16 a[182:183], v247 offset:42888
    v_mfma_f32_16x16x32_bf16 v[204:207], a[120:123], a[88:91], v[204:207]
    v_exp_f32 v195, v195
    v_mfma_f32_16x16x32_bf16 v[204:207], a[116:119], a[84:87], v[204:207]
    ds_read_b64_tr_b16 a[212:213], v247 offset:59272
    ds_read_b64_tr_b16 a[214:215], v247 offset:59784
    v_mfma_f32_16x16x32_bf16 v[204:207], a[112:115], a[80:83], v[204:207]
    v_exp_f32 v196, v196
    v_mfma_f32_16x16x32_bf16 v[224:227], a[128:131], a[80:83], 0
    v_exp_f32 v197, v197
    v_mfma_f32_16x16x32_bf16 v[224:227], a[132:135], a[84:87], v[224:227]
    v_exp_f32 v198, v198
    v_mfma_f32_16x16x32_bf16 v[224:227], a[136:139], a[88:91], v[224:227]
    v_exp_f32 v199, v199
    v_mfma_f32_16x16x32_bf16 v[224:227], a[140:143], a[92:95], v[224:227]
    v_cvt_pk_bf16_f32 v252, v192, v193
    v_cvt_pk_bf16_f32 v253, v194, v195
    v_mfma_f32_16x16x32_bf16 v[228:231], a[156:159], a[92:95], 0
    v_cvt_pk_bf16_f32 v254, v196, v197
    v_cvt_pk_bf16_f32 v255, v198, v199
    v_mfma_f32_16x16x32_bf16 v[228:231], a[152:155], a[88:91], v[228:231]
    ds_read_b64_tr_b16 a[184:185], v247 offset:42432
    ds_read_b64_tr_b16 a[186:187], v247 offset:42944
    v_mfma_f32_16x16x32_bf16 v[228:231], a[148:151], a[84:87], v[228:231]
    v_fma_f32 v200, v200, s21, v237
    v_fma_f32 v201, v201, s21, v237
    v_mfma_f32_16x16x32_bf16 v[228:231], a[144:147], a[80:83], v[228:231]
    s_waitcnt lgkmcnt(15)
    ds_read_b64_tr_b16 a[216:217], v247 offset:59328
    ds_read_b64_tr_b16 a[218:219], v247 offset:59840
    v_mfma_f32_16x16x32_bf16 a[244:247], a[224:227], v[240:243], a[244:247]
    v_fma_f32 v202, v202, s21, v237
    v_fma_f32 v203, v203, s21, v237
    v_mfma_f32_16x16x32_bf16 a[244:247], a[224:227], v[252:255], a[244:247]
    ds_read_b64_tr_b16 a[188:189], v247 offset:42440
    ds_read_b64_tr_b16 a[190:191], v247 offset:42952
    v_mfma_f32_16x16x32_bf16 v[128:131], a[192:195], v[252:255], v[128:131]
    v_fma_f32 v204, v204, s21, v237
    v_fma_f32 v205, v205, s21, v237
    v_mfma_f32_16x16x32_bf16 v[128:131], a[160:163], v[240:243], v[128:131]
    s_waitcnt lgkmcnt(14)
    ds_read_b64_tr_b16 a[220:221], v247 offset:59336
    ds_read_b64_tr_b16 a[222:223], v247 offset:59848
    v_mfma_f32_16x16x32_bf16 v[132:135], a[164:167], v[240:243], v[132:135]
    v_fma_f32 v206, v206, s21, v237
    v_fma_f32 v207, v207, s21, v237
    v_mfma_f32_16x16x32_bf16 v[132:135], a[196:199], v[252:255], v[132:135]
    v_exp_f32 v200, v200
    v_mfma_f32_16x16x32_bf16 v[136:139], a[200:203], v[252:255], v[136:139]
    v_exp_f32 v201, v201
    v_mfma_f32_16x16x32_bf16 v[136:139], a[168:171], v[240:243], v[136:139]
    s_waitcnt lgkmcnt(8)
    v_exp_f32 v202, v202
    v_mfma_f32_16x16x32_bf16 v[140:143], a[172:175], v[240:243], v[140:143]
    v_exp_f32 v203, v203
    v_mfma_f32_16x16x32_bf16 v[140:143], a[204:207], v[252:255], v[140:143]
    v_exp_f32 v204, v204
    v_mfma_f32_16x16x32_bf16 v[144:147], a[208:211], v[252:255], v[144:147]
    v_exp_f32 v205, v205
    v_mfma_f32_16x16x32_bf16 v[144:147], a[176:179], v[240:243], v[144:147]
    v_exp_f32 v206, v206
    v_mfma_f32_16x16x32_bf16 v[148:151], a[180:183], v[240:243], v[148:151]
    s_waitcnt lgkmcnt(0)
    v_exp_f32 v207, v207
    v_mfma_f32_16x16x32_bf16 v[148:151], a[212:215], v[252:255], v[148:151]
    v_fma_f32 v224, v224, s21, v237
    v_fma_f32 v225, v225, s21, v237
    v_mfma_f32_16x16x32_bf16 v[152:155], a[216:219], v[252:255], v[152:155]
    v_fma_f32 v226, v226, s21, v237
    v_fma_f32 v227, v227, s21, v237
    v_mfma_f32_16x16x32_bf16 v[152:155], a[184:187], v[240:243], v[152:155]
    v_fma_f32 v228, v228, s21, v237
    v_fma_f32 v229, v229, s21, v237
    v_fma_f32 v230, v230, s21, v237
    v_fma_f32 v231, v231, s21, v237
    v_mfma_f32_16x16x32_bf16 v[156:159], a[188:191], v[240:243], v[156:159]
    v_cvt_pk_bf16_f32 v208, v200, v201
    v_cvt_pk_bf16_f32 v209, v202, v203
    v_cvt_pk_bf16_f32 v210, v204, v205
    v_cvt_pk_bf16_f32 v211, v206, v207
    v_exp_f32 v224, v224
    v_exp_f32 v225, v225
    v_exp_f32 v226, v226
    v_exp_f32 v227, v227
    v_exp_f32 v228, v228
    v_exp_f32 v229, v229
    v_exp_f32 v230, v230
    v_exp_f32 v231, v231
    v_mfma_f32_16x16x32_bf16 v[156:159], a[220:223], v[252:255], v[156:159]
    v_cvt_pk_bf16_f32 v212, v224, v225
    v_cvt_pk_bf16_f32 v213, v226, v227
    v_cvt_pk_bf16_f32 v214, v228, v229
    v_cvt_pk_bf16_f32 v215, v230, v231
    v_mfma_f32_16x16x32_bf16 a[248:251], a[224:227], v[208:211], a[248:251]
    s_nop 0
    v_mfma_f32_16x16x32_bf16 a[248:251], a[224:227], v[212:215], a[248:251]
    v_mfma_f32_16x16x32_bf16 v[160:163], a[192:195], v[212:215], v[160:163]
    v_accvgpr_read_b32 v239, a244
    v_rcp_f32 v238, v239
    v_cmp_ngt_f32 vcc, s34, v239
    v_pk_mul_f32 v[128:129], v[128:129], v[238:239] op_sel_hi:[1,0]
    v_pk_mul_f32 v[130:131], v[130:131], v[238:239] op_sel_hi:[1,0]
    v_pk_mul_f32 v[132:133], v[132:133], v[238:239] op_sel_hi:[1,0]
    v_pk_mul_f32 v[134:135], v[134:135], v[238:239] op_sel_hi:[1,0]
    v_pk_mul_f32 v[136:137], v[136:137], v[238:239] op_sel_hi:[1,0]
    v_pk_mul_f32 v[138:139], v[138:139], v[238:239] op_sel_hi:[1,0]
    v_pk_mul_f32 v[140:141], v[140:141], v[238:239] op_sel_hi:[1,0]
    v_pk_mul_f32 v[142:143], v[142:143], v[238:239] op_sel_hi:[1,0]
    v_pk_mul_f32 v[144:145], v[144:145], v[238:239] op_sel_hi:[1,0]
    v_pk_mul_f32 v[146:147], v[146:147], v[238:239] op_sel_hi:[1,0]
    v_pk_mul_f32 v[148:149], v[148:149], v[238:239] op_sel_hi:[1,0]
    v_pk_mul_f32 v[150:151], v[150:151], v[238:239] op_sel_hi:[1,0]
    v_pk_mul_f32 v[152:153], v[152:153], v[238:239] op_sel_hi:[1,0]
    v_pk_mul_f32 v[154:155], v[154:155], v[238:239] op_sel_hi:[1,0]
    v_pk_mul_f32 v[156:157], v[156:157], v[238:239] op_sel_hi:[1,0]
    v_pk_mul_f32 v[158:159], v[158:159], v[238:239] op_sel_hi:[1,0]
    v_cvt_pk_bf16_f32 v128, v128, v129
    v_cvt_pk_bf16_f32 v129, v130, v131
    v_cvt_pk_bf16_f32 v130, v132, v133
    v_cvt_pk_bf16_f32 v131, v134, v135
    v_cvt_pk_bf16_f32 v136, v136, v137
    v_cvt_pk_bf16_f32 v137, v138, v139
    v_cvt_pk_bf16_f32 v138, v140, v141
    v_cvt_pk_bf16_f32 v139, v142, v143
    v_cvt_pk_bf16_f32 v144, v144, v145
    v_cvt_pk_bf16_f32 v145, v146, v147
    v_cvt_pk_bf16_f32 v146, v148, v149
    v_cvt_pk_bf16_f32 v147, v150, v151
    v_cvt_pk_bf16_f32 v152, v152, v153
    v_cvt_pk_bf16_f32 v153, v154, v155
    v_cvt_pk_bf16_f32 v154, v156, v157
    v_cvt_pk_bf16_f32 v155, v158, v159
    v_accvgpr_read_b32 v239, a248
    v_mfma_f32_16x16x32_bf16 v[160:163], a[160:163], v[208:211], v[160:163]
    s_or_b64 s[78:79], s[78:79], vcc
    ds_write_b128 v250, v[128:131] offset:0
    v_mfma_f32_16x16x32_bf16 v[164:167], a[164:167], v[208:211], v[164:167]
    v_rcp_f32 v238, v239
    v_mfma_f32_16x16x32_bf16 v[164:167], a[196:199], v[212:215], v[164:167]
    v_cmp_ngt_f32 vcc, s34, v239
    v_mfma_f32_16x16x32_bf16 v[168:171], a[200:203], v[212:215], v[168:171]
    s_or_b64 s[78:79], s[78:79], vcc
    v_mul_f32 v160, v160, v238
    v_mul_f32 v161, v161, v238
    v_mfma_f32_16x16x32_bf16 v[168:171], a[168:171], v[208:211], v[168:171]
    ds_write_b128 v250, v[136:139] offset:64
    v_mfma_f32_16x16x32_bf16 v[172:175], a[172:175], v[208:211], v[172:175]
    ds_write_b128 v250, v[144:147] offset:128
    ds_write_b128 v250, v[152:155] offset:192
    v_mfma_f32_16x16x32_bf16 v[172:175], a[204:207], v[212:215], v[172:175]
    ds_read_b128 a[64:67], v251 offset:0
    ds_read_b128 a[68:71], v251 offset:1056
    ds_read_b128 a[72:75], v251 offset:2112
    ds_read_b128 a[76:79], v251 offset:3168
    v_mfma_f32_16x16x32_bf16 v[176:179], a[208:211], v[212:215], v[176:179]
    v_mul_f32 v162, v162, v238
    v_mul_f32 v163, v163, v238
    v_mfma_f32_16x16x32_bf16 v[176:179], a[176:179], v[208:211], v[176:179]
    v_mul_f32 v164, v164, v238
    v_mul_f32 v165, v165, v238
    v_mfma_f32_16x16x32_bf16 v[180:183], a[180:183], v[208:211], v[180:183]
    v_mul_f32 v166, v166, v238
    v_mul_f32 v167, v167, v238
    v_mfma_f32_16x16x32_bf16 v[180:183], a[212:215], v[212:215], v[180:183]
    v_cvt_pk_bf16_f32 v160, v160, v161
    v_cvt_pk_bf16_f32 v161, v162, v163
    v_mfma_f32_16x16x32_bf16 v[184:187], a[216:219], v[212:215], v[184:187]
    v_cvt_pk_bf16_f32 v162, v164, v165
    v_cvt_pk_bf16_f32 v163, v166, v167
    v_mfma_f32_16x16x32_bf16 v[184:187], a[184:187], v[208:211], v[184:187]
    ds_write_b128 v250, v[160:163] offset:16896
    v_mfma_f32_16x16x32_bf16 v[188:191], a[188:191], v[208:211], v[188:191]
    s_waitcnt lgkmcnt(1)
    buffer_store_dwordx4 a[64:67], v248, s[16:19], s26 offen sc1
    buffer_store_dwordx4 a[68:71], v248, s[16:19], s26 offen offset:1024 sc1
    buffer_store_dwordx4 a[72:75], v248, s[16:19], s26 offen offset:2048 sc1
    buffer_store_dwordx4 a[76:79], v248, s[16:19], s26 offen offset:3072 sc1
    v_mul_f32 v168, v168, v238
    v_mul_f32 v169, v169, v238
    v_mul_f32 v170, v170, v238
    v_mul_f32 v171, v171, v238
    v_mul_f32 v172, v172, v238
    v_mul_f32 v173, v173, v238
    v_mul_f32 v174, v174, v238
    v_mul_f32 v175, v175, v238
    v_cvt_pk_bf16_f32 v168, v168, v169
    v_cvt_pk_bf16_f32 v169, v170, v171
    v_cvt_pk_bf16_f32 v170, v172, v173
    v_cvt_pk_bf16_f32 v171, v174, v175
    v_mul_f32 v176, v176, v238
    v_mul_f32 v177, v177, v238
    v_mul_f32 v178, v178, v238
    v_mul_f32 v179, v179, v238
    v_mul_f32 v180, v180, v238
    v_mul_f32 v181, v181, v238
    v_mul_f32 v182, v182, v238
    v_mul_f32 v183, v183, v238
    v_cvt_pk_bf16_f32 v176, v176, v177
    v_cvt_pk_bf16_f32 v177, v178, v179
    v_cvt_pk_bf16_f32 v178, v180, v181
    v_cvt_pk_bf16_f32 v179, v182, v183
    v_mul_f32 v184, v184, v238
    v_mul_f32 v185, v185, v238
    v_mul_f32 v186, v186, v238
    v_mul_f32 v187, v187, v238
    v_cvt_pk_bf16_f32 v184, v184, v185
    v_cvt_pk_bf16_f32 v185, v186, v187
    v_mfma_f32_16x16x32_bf16 v[188:191], a[220:223], v[212:215], v[188:191]
    s_add_u32 s26, s26, 4096
    ds_write_b128 v250, v[168:171] offset:16960
    ds_write_b128 v250, v[176:179] offset:17024
    s_nop 4
    v_mul_f32 v188, v188, v238
    v_mul_f32 v189, v189, v238
    v_mul_f32 v190, v190, v238
    v_mul_f32 v191, v191, v238
    v_cvt_pk_bf16_f32 v186, v188, v189
    v_cvt_pk_bf16_f32 v187, v190, v191
    ds_write_b128 v250, v[184:187] offset:17088
    ds_read_b128 a[80:83], v251 offset:16896
    ds_read_b128 a[84:87], v251 offset:17952
    ds_read_b128 a[88:91], v251 offset:19008
    ds_read_b128 a[92:95], v251 offset:20064
    s_waitcnt lgkmcnt(0)
    buffer_store_dwordx4 a[80:83], v248, s[16:19], s26 offen sc1
    buffer_store_dwordx4 a[84:87], v248, s[16:19], s26 offen offset:1024 sc1
    buffer_store_dwordx4 a[88:91], v248, s[16:19], s26 offen offset:2048 sc1
    buffer_store_dwordx4 a[92:95], v248, s[16:19], s26 offen offset:3072 sc1
    s_cmp_eq_u64 s[76:77], 0
    s_cbranch_scc1 Lok0
    s_mov_b32 s81, 0
    s_call_b64 s[30:31], Lslow
Lok0:
    s_cmp_eq_u64 s[78:79], 0
    s_cbranch_scc1 Lok1
    s_mov_b32 s81, 98304
    s_call_b64 s[30:31], Lslow
Lok1:
Lend:
    s_endpgm
Lslow:
    s_waitcnt vmcnt(0) lgkmcnt(0)
    v_lshrrev_b32 v2, 4, v248
    v_and_b32 v3, 15, v2
    v_lshrrev_b32 v4, 4, v2
    v_and_b32 v5, 7, v3
    v_lshrrev_b32 v6, 3, v3
    v_mul_u32_u24 v246, 1056, v5
    v_lshl_add_u32 v246, v6, 8, v246
    v_lshl_add_u32 v246, v4, 4, v246
    v_and_b32 v5, 1, v4
    v_lshrrev_b32 v6, 2, v3
    v_lshl_add_u32 v5, v5, 2, v6
    v_mul_u32_u24 v247, 1056, v5
    v_lshrrev_b32 v5, 1, v4
    v_lshl_add_u32 v247, v5, 8, v247
    v_lshlrev_b32 v249, 8, v6
    v_and_b32 v5, 1, v6
    v_xor_b32 v5, v5, v4
    v_and_b32 v6, 3, v3
    v_lshl_add_u32 v247, v6, 4, v247
    s_add_u32 s84, s27, 50688
    v_mul_u32_u24 v6, 1056, v6
    v_add3_u32 v249, v249, v6, s84
    v_lshl_add_u32 v250, v5, 4, v249
    v_lshl_add_u32 v249, v4, 4, v249
    v_and_b32 v5, 1, v4
    v_lshlrev_b32 v5, 4, v5
    v_xor_b32 v251, v5, v248
    v_add_u32 v251, s84, v251
    s_add_u32 s84, s27, 101376
    v_bfe_u32 v5, v3, 2, 1
    v_mul_u32_u24 v5, 12672, v5
    v_add3_u32 v246, v5, v246, s27
    v_and_b32 v5, 1, v4
    v_mul_u32_u24 v5, 12672, v5
    v_add3_u32 v247, v5, v247, s84
    s_mul_i32 s25, s20, 24576
    s_add_u32 s25, s25, s81
    s_add_u32 s8, s38, s73
    s_addc_u32 s9, s39, 0
    s_mov_b32 s82, s25
    s_add_u32 m0, s27, 101376
    s_nop 0
    buffer_load_dwordx4 v248, s[4:7], s82 offen nt lds
    s_add_u32 m0, s27, 101408
    s_nop 0
    buffer_load_dwordx4 v248, s[4:7], s82 offen offset:1024 nt lds
    s_add_u32 m0, s27, 101440
    s_nop 0
    buffer_load_dwordx4 v248, s[4:7], s82 offen offset:2048 nt lds
    s_add_u32 m0, s27, 101472
    s_nop 0
    buffer_load_dwordx4 v248, s[4:7], s82 offen offset:3072 nt lds
    s_add_u32 s82, s82, 4096
    s_waitcnt vmcnt(0)
    ds_read_b128 a[0:3], v249 offset:50688
    ds_read_b128 a[4:7], v249 offset:50752
    ds_read_b128 a[8:11], v249 offset:50816
    ds_read_b128 a[12:15], v249 offset:50880
    s_waitcnt lgkmcnt(0)
    s_add_u32 m0, s27, 101376
    s_nop 0
    buffer_load_dwordx4 v248, s[4:7], s82 offen nt lds
    s_add_u32 m0, s27, 101408
    s_nop 0
    buffer_load_dwordx4 v248, s[4:7], s82 offen offset:1024 nt lds
    s_add_u32 m0, s27, 101440
    s_nop 0
    buffer_load_dwordx4 v248, s[4:7], s82 offen offset:2048 nt lds
    s_add_u32 m0, s27, 101472
    s_nop 0
    buffer_load_dwordx4 v248, s[4:7], s82 offen offset:3072 nt lds
    s_add_u32 s82, s82, 4096
    s_waitcnt vmcnt(0)
    ds_read_b128 a[16:19], v249 offset:50688
    ds_read_b128 a[20:23], v249 offset:50752
    ds_read_b128 a[24:27], v249 offset:50816
    ds_read_b128 a[28:31], v249 offset:50880
    s_waitcnt lgkmcnt(0)
    s_add_u32 m0, s27, 101376
    s_nop 0
    buffer_load_dwordx4 v248, s[4:7], s82 offen nt lds
    s_add_u32 m0, s27, 101408
    s_nop 0
    buffer_load_dwordx4 v248, s[4:7], s82 offen offset:1024 nt lds
    s_add_u32 m0, s27, 101440
    s_nop 0
    buffer_load_dwordx4 v248, s[4:7], s82 offen offset:2048 nt lds
    s_add_u32 m0, s27, 101472
    s_nop 0
    buffer_load_dwordx4 v248, s[4:7], s82 offen offset:3072 nt lds
    s_add_u32 s82, s82, 4096
    s_waitcnt vmcnt(0)
    ds_read_b128 a[32:35], v249 offset:50688
    ds_read_b128 a[36:39], v249 offset:50752
    ds_read_b128 a[40:43], v249 offset:50816
    ds_read_b128 a[44:47], v249 offset:50880
    s_waitcnt lgkmcnt(0)
    s_add_u32 m0, s27, 101376
    s_nop 0
    buffer_load_dwordx4 v248, s[4:7], s82 offen nt lds
    s_add_u32 m0, s27, 101408
    s_nop 0
    buffer_load_dwordx4 v248, s[4:7], s82 offen offset:1024 nt lds
    s_add_u32 m0, s27, 101440
    s_nop 0
    buffer_load_dwordx4 v248, s[4:7], s82 offen offset:2048 nt lds
    s_add_u32 m0, s27, 101472
    s_nop 0
    buffer_load_dwordx4 v248, s[4:7], s82 offen offset:3072 nt lds
    s_add_u32 s82, s82, 4096
    s_waitcnt vmcnt(0)
    ds_read_b128 a[48:51], v249 offset:50688
    ds_read_b128 a[52:55], v249 offset:50752
    ds_read_b128 a[56:59], v249 offset:50816
    ds_read_b128 a[60:63], v249 offset:50880
    s_waitcnt lgkmcnt(0)
    s_add_u32 m0, s27, 101376
    s_nop 0
    buffer_load_dwordx4 v248, s[4:7], s82 offen nt lds
    s_add_u32 m0, s27, 101408
    s_nop 0
    buffer_load_dwordx4 v248, s[4:7], s82 offen offset:1024 nt lds
    s_add_u32 m0, s27, 101440
    s_nop 0
    buffer_load_dwordx4 v248, s[4:7], s82 offen offset:2048 nt lds
    s_add_u32 m0, s27, 101472
    s_nop 0
    buffer_load_dwordx4 v248, s[4:7], s82 offen offset:3072 nt lds
    s_add_u32 s82, s82, 4096
    s_waitcnt vmcnt(0)
    ds_read_b128 a[64:67], v249 offset:50688
    ds_read_b128 a[68:71], v249 offset:50752
    ds_read_b128 a[72:75], v249 offset:50816
    ds_read_b128 a[76:79], v249 offset:50880
    s_waitcnt lgkmcnt(0)
    s_add_u32 m0, s27, 101376
    s_nop 0
    buffer_load_dwordx4 v248, s[4:7], s82 offen nt lds
    s_add_u32 m0, s27, 101408
    s_nop 0
    buffer_load_dwordx4 v248, s[4:7], s82 offen offset:1024 nt lds
    s_add_u32 m0, s27, 101440
    s_nop 0
    buffer_load_dwordx4 v248, s[4:7], s82 offen offset:2048 nt lds
    s_add_u32 m0, s27, 101472
    s_nop 0
    buffer_load_dwordx4 v248, s[4:7], s82 offen offset:3072 nt lds
    s_add_u32 s82, s82, 4096
    s_waitcnt vmcnt(0)
    ds_read_b128 a[80:83], v249 offset:50688
    ds_read_b128 a[84:87], v249 offset:50752
    ds_read_b128 a[88:91], v249 offset:50816
    ds_read_b128 a[92:95], v249 offset:50880
    s_waitcnt lgkmcnt(0)
    v_mov_b32 v0, 0
    v_mov_b32 v1, 0
    v_mov_b32 v2, 0
    v_mov_b32 v3, 0
    v_mov_b32 v4, 0
    v_mov_b32 v5, 0
    v_mov_b32 v6, 0
    v_mov_b32 v7, 0
    v_mov_b32 v8, 0
    v_mov_b32 v9, 0
    v_mov_b32 v10, 0
    v_mov_b32 v11, 0
    v_mov_b32 v12, 0
    v_mov_b32 v13, 0
    v_mov_b32 v14, 0
    v_mov_b32 v15, 0
    v_mov_b32 v16, 0
    v_mov_b32 v17, 0
    v_mov_b32 v18, 0
    v_mov_b32 v19, 0
    v_mov_b32 v20, 0
    v_mov_b32 v21, 0
    v_mov_b32 v22, 0
    v_mov_b32 v23, 0
    v_mov_b32 v24, 0
    v_mov_b32 v25, 0
    v_mov_b32 v26, 0
    v_mov_b32 v27, 0
    v_mov_b32 v28, 0
    v_mov_b32 v29, 0
    v_mov_b32 v30, 0
    v_mov_b32 v31, 0
    v_mov_b32 v32, 0
    v_mov_b32 v33, 0
    v_mov_b32 v34, 0
    v_mov_b32 v35, 0
    v_mov_b32 v36, 0
    v_mov_b32 v37, 0
    v_mov_b32 v38, 0
    v_mov_b32 v39, 0
    v_mov_b32 v40, 0
    v_mov_b32 v41, 0
    v_mov_b32 v42, 0
    v_mov_b32 v43, 0
    v_mov_b32 v44, 0
    v_mov_b32 v45, 0
    v_mov_b32 v46, 0
    v_mov_b32 v47, 0
    v_mov_b32 v48, 0
    v_mov_b32 v49, 0
    v_mov_b32 v50, 0
    v_mov_b32 v51, 0
    v_mov_b32 v52, 0
    v_mov_b32 v53, 0
    v_mov_b32 v54, 0
    v_mov_b32 v55, 0
    v_mov_b32 v56, 0
    v_mov_b32 v57, 0
    v_mov_b32 v58, 0
    v_mov_b32 v59, 0
    v_mov_b32 v60, 0
    v_mov_b32 v61, 0
    v_mov_b32 v62, 0
    v_mov_b32 v63, 0
    v_mov_b32 v64, 0
    v_mov_b32 v65, 0
    v_mov_b32 v66, 0
    v_mov_b32 v67, 0
    v_mov_b32 v68, 0
    v_mov_b32 v69, 0
    v_mov_b32 v70, 0
    v_mov_b32 v71, 0
    v_mov_b32 v72, 0
    v_mov_b32 v73, 0
    v_mov_b32 v74, 0
    v_mov_b32 v75, 0
    v_mov_b32 v76, 0
    v_mov_b32 v77, 0
    v_mov_b32 v78, 0
    v_mov_b32 v79, 0
    v_mov_b32 v80, 0
    v_mov_b32 v81, 0
    v_mov_b32 v82, 0
    v_mov_b32 v83, 0
    v_mov_b32 v84, 0
    v_mov_b32 v85, 0
    v_mov_b32 v86, 0
    v_mov_b32 v87, 0
    v_mov_b32 v88, 0
    v_mov_b32 v89, 0
    v_mov_b32 v90, 0
    v_mov_b32 v91, 0
    v_mov_b32 v92, 0
    v_mov_b32 v93, 0
    v_mov_b32 v94, 0
    v_mov_b32 v95, 0
    v_mov_b32 v96, 0
    v_mov_b32 v97, 0
    v_mov_b32 v98, 0
    v_mov_b32 v99, 0
    v_mov_b32 v100, 0
    v_mov_b32 v101, 0
    v_mov_b32 v102, 0
    v_mov_b32 v103, 0
    v_mov_b32 v104, 0
    v_mov_b32 v105, 0
    v_mov_b32 v106, 0
    v_mov_b32 v107, 0
    v_mov_b32 v108, 0
    v_mov_b32 v109, 0
    v_mov_b32 v110, 0
    v_mov_b32 v111, 0
    v_mov_b32 v112, 0
    v_mov_b32 v113, 0
    v_mov_b32 v114, 0
    v_mov_b32 v115, 0
    v_mov_b32 v116, 0
    v_mov_b32 v117, 0
    v_mov_b32 v118, 0
    v_mov_b32 v119, 0
    v_mov_b32 v120, 0
    v_mov_b32 v121, 0
    v_mov_b32 v122, 0
    v_mov_b32 v123, 0
    v_mov_b32 v124, 0
    v_mov_b32 v125, 0
    v_mov_b32 v126, 0
    v_mov_b32 v127, 0
    v_mov_b32 v128, 0
    v_mov_b32 v129, 0
    v_mov_b32 v130, 0
    v_mov_b32 v131, 0
    v_mov_b32 v132, 0
    v_mov_b32 v133, 0
    v_mov_b32 v134, 0
    v_mov_b32 v135, 0
    v_mov_b32 v136, 0
    v_mov_b32 v137, 0
    v_mov_b32 v138, 0
    v_mov_b32 v139, 0
    v_mov_b32 v140, 0
    v_mov_b32 v141, 0
    v_mov_b32 v142, 0
    v_mov_b32 v143, 0
    v_mov_b32 v144, 0
    v_mov_b32 v145, 0
    v_mov_b32 v146, 0
    v_mov_b32 v147, 0
    v_mov_b32 v148, 0
    v_mov_b32 v149, 0
    v_mov_b32 v150, 0
    v_mov_b32 v151, 0
    v_mov_b32 v152, 0
    v_mov_b32 v153, 0
    v_mov_b32 v154, 0
    v_mov_b32 v155, 0
    v_mov_b32 v156, 0
    v_mov_b32 v157, 0
    v_mov_b32 v158, 0
    v_mov_b32 v159, 0
    v_mov_b32 v160, 0
    v_mov_b32 v161, 0
    v_mov_b32 v162, 0
    v_mov_b32 v163, 0
    v_mov_b32 v164, 0
    v_mov_b32 v165, 0
    v_mov_b32 v166, 0
    v_mov_b32 v167, 0
    v_mov_b32 v168, 0
    v_mov_b32 v169, 0
    v_mov_b32 v170, 0
    v_mov_b32 v171, 0
    v_mov_b32 v172, 0
    v_mov_b32 v173, 0
    v_mov_b32 v174, 0
    v_mov_b32 v175, 0
    v_mov_b32 v176, 0
    v_mov_b32 v177, 0
    v_mov_b32 v178, 0
    v_mov_b32 v179, 0
    v_mov_b32 v180, 0
    v_mov_b32 v181, 0
    v_mov_b32 v182, 0
    v_mov_b32 v183, 0
    v_mov_b32 v184, 0
    v_mov_b32 v185, 0
    v_mov_b32 v186, 0
    v_mov_b32 v187, 0
    v_mov_b32 v188, 0
    v_mov_b32 v189, 0
    v_mov_b32 v190, 0
    v_mov_b32 v191, 0
    v_mov_b32 v216, 0
    v_mov_b32 v217, 0
    v_mov_b32 v218, 0
    v_mov_b32 v219, 0
    v_mov_b32 v220, 0
    v_mov_b32 v221, 0
    v_mov_b32 v222, 0
    v_mov_b32 v223, 0
    v_mov_b32 v224, 0
    v_mov_b32 v225, 0
    v_mov_b32 v226, 0
    v_mov_b32 v227, 0
    v_mov_b32 v228, 0
    v_mov_b32 v229, 0
    v_mov_b32 v230, 0
    v_mov_b32 v231, 0
    v_mov_b32 v232, 0
    v_mov_b32 v233, 0
    v_mov_b32 v234, 0
    v_mov_b32 v235, 0
    v_mov_b32 v236, 0
    v_mov_b32 v237, 0
    v_mov_b32 v238, 0
    v_mov_b32 v239, 0
    v_mov_b32 v240, 0xff800000
    v_mov_b32 v241, 0xff800000
    v_mov_b32 v242, 0xff800000
    v_mov_b32 v243, 0xff800000
    v_mov_b32 v244, 0xff800000
    v_mov_b32 v245, 0xff800000
    s_mov_b32 s82, s81
    s_mov_b32 s83, s81
    s_mov_b32 s23, 12
Lslowloop:
    s_mov_b32 m0, s27
    s_nop 0
    buffer_load_dwordx4 v248, s[8:11], s82 offen nt lds
    s_add_u32 m0, s27, 32
    s_nop 0
    buffer_load_dwordx4 v248, s[8:11], s82 offen offset:1024 nt lds
    s_add_u32 m0, s27, 64
    s_nop 0
    buffer_load_dwordx4 v248, s[8:11], s82 offen offset:2048 nt lds
    s_add_u32 m0, s27, 96
    s_nop 0
    buffer_load_dwordx4 v248, s[8:11], s82 offen offset:3072 nt lds
    s_add_u32 s82, s82, 4096
    s_add_u32 m0, s27, 16896
    s_nop 0
    buffer_load_dwordx4 v248, s[8:11], s82 offen nt lds
    s_add_u32 m0, s27, 16928
    s_nop 0
    buffer_load_dwordx4 v248, s[8:11], s82 offen offset:1024 nt lds
    s_add_u32 m0, s27, 16960
    s_nop 0
    buffer_load_dwordx4 v248, s[8:11], s82 offen offset:2048 nt lds
    s_add_u32 m0, s27, 16992
    s_nop 0
    buffer_load_dwordx4 v248, s[8:11], s82 offen offset:3072 nt lds
    s_add_u32 s82, s82, 4096
    s_add_u32 m0, s27, 101376
    s_nop 0
    buffer_load_dwordx4 v248, s[12:15], s83 offen nt lds
    s_add_u32 m0, s27, 101408
    s_nop 0
    buffer_load_dwordx4 v248, s[12:15], s83 offen offset:1024 nt lds
    s_add_u32 m0, s27, 101440
    s_nop 0
    buffer_load_dwordx4 v248, s[12:15], s83 offen offset:2048 nt lds
    s_add_u32 m0, s27, 101472
    s_nop 0
    buffer_load_dwordx4 v248, s[12:15], s83 offen offset:3072 nt lds
    s_add_u32 s83, s83, 4096
    s_add_u32 m0, s27, 118272
    s_nop 0
    buffer_load_dwordx4 v248, s[12:15], s83 offen nt lds
    s_add_u32 m0, s27, 118304
    s_nop 0
    buffer_load_dwordx4 v248, s[12:15], s83 offen offset:1024 nt lds
    s_add_u32 m0, s27, 118336
    s_nop 0
    buffer_load_dwordx4 v248, s[12:15], s83 offen offset:2048 nt lds
    s_add_u32 m0, s27, 118368
    s_nop 0
    buffer_load_dwordx4 v248, s[12:15], s83 offen offset:3072 nt lds
    s_add_u32 s83, s83, 4096
    s_waitcnt vmcnt(0)
    ds_read_b128 a[96:99], v246 offset:0
    ds_read_b128 a[100:103], v246 offset:64
    ds_read_b128 a[104:107], v246 offset:128
    ds_read_b128 a[108:111], v246 offset:192
    ds_read_b128 a[112:115], v246 offset:512
    ds_read_b128 a[116:119], v246 offset:576
    ds_read_b128 a[120:123], v246 offset:640
    ds_read_b128 a[124:127], v246 offset:704
    ds_read_b64_tr_b16 a[160:161], v247 offset:0
    ds_read_b64_tr_b16 a[162:163], v247 offset:512
    ds_read_b64_tr_b16 a[164:165], v247 offset:8
    ds_read_b64_tr_b16 a[166:167], v247 offset:520
    ds_read_b64_tr_b16 a[168:169], v247 offset:64
    ds_read_b64_tr_b16 a[170:171], v247 offset:576
    ds_read_b64_tr_b16 a[172:173], v247 offset:72
    ds_read_b64_tr_b16 a[174:175], v247 offset:584
    ds_read_b64_tr_b16 a[176:177], v247 offset:128
    ds_read_b64_tr_b16 a[178:179], v247 offset:640
    ds_read_b64_tr_b16 a[180:181], v247 offset:136
    ds_read_b64_tr_b16 a[182:183], v247 offset:648
    ds_read_b64_tr_b16 a[184:185], v247 offset:192
    ds_read_b64_tr_b16 a[186:187], v247 offset:704
    ds_read_b64_tr_b16 a[188:189], v247 offset:200
    ds_read_b64_tr_b16 a[190:191], v247 offset:712
    s_waitcnt lgkmcnt(0)
    v_mfma_f32_16x16x32_bf16 v[192:195], a[96:99], a[0:3], 0
    v_mfma_f32_16x16x32_bf16 v[192:195], a[100:103], a[4:7], v[192:195]
    v_mfma_f32_16x16x32_bf16 v[192:195], a[104:107], a[8:11], v[192:195]
    v_mfma_f32_16x16x32_bf16 v[192:195], a[108:111], a[12:15], v[192:195]
    v_mfma_f32_16x16x32_bf16 v[196:199], a[124:127], a[12:15], 0
    v_mfma_f32_16x16x32_bf16 v[196:199], a[120:123], a[8:11], v[196:199]
    v_mfma_f32_16x16x32_bf16 v[196:199], a[116:119], a[4:7], v[196:199]
    v_mfma_f32_16x16x32_bf16 v[196:199], a[112:115], a[0:3], v[196:199]
    s_nop 3
    v_max3_f32 v252, v192, v193, v194
    s_nop 2
    v_max3_f32 v252, v252, v195, v196
    v_max3_f32 v252, v252, v197, v198
    v_max_f32 v253, v252, v199
    v_max_f32 v252, v252, v199
    s_nop 1
    v_permlane16_swap_b32 v252, v253
    v_max_f32 v252, v252, v253
    v_mov_b32 v253, v252
    s_nop 1
    v_permlane32_swap_b32 v252, v253
    v_max_f32 v252, v252, v253
    v_max_f32 v252, v252, v240
    v_sub_f32 v253, v240, v252
    v_mul_f32 v253, s21, v253
    v_exp_f32 v253, v253
    v_mov_b32 v240, v252
    v_mul_f32 v252, s35, v252
    v_fma_f32 v192, v192, s21, v252
    v_fma_f32 v193, v193, s21, v252
    v_fma_f32 v194, v194, s21, v252
    v_fma_f32 v195, v195, s21, v252
    v_fma_f32 v196, v196, s21, v252
    v_fma_f32 v197, v197, s21, v252
    v_fma_f32 v198, v198, s21, v252
    v_fma_f32 v199, v199, s21, v252
    v_exp_f32 v192, v192
    v_exp_f32 v193, v193
    v_exp_f32 v194, v194
    v_exp_f32 v195, v195
    v_exp_f32 v196, v196
    v_exp_f32 v197, v197
    v_exp_f32 v198, v198
    v_exp_f32 v199, v199
    v_cvt_pk_bf16_f32 v208, v192, v193
    v_cvt_pk_bf16_f32 v209, v194, v195
    v_cvt_pk_bf16_f32 v210, v196, v197
    v_cvt_pk_bf16_f32 v211, v198, v199
    v_mul_f32 v0, v0, v253
    v_mul_f32 v1, v1, v253
    v_mul_f32 v2, v2, v253
    v_mul_f32 v3, v3, v253
    v_mul_f32 v4, v4, v253
    v_mul_f32 v5, v5, v253
    v_mul_f32 v6, v6, v253
    v_mul_f32 v7, v7, v253
    v_mul_f32 v8, v8, v253
    v_mul_f32 v9, v9, v253
    v_mul_f32 v10, v10, v253
    v_mul_f32 v11, v11, v253
    v_mul_f32 v12, v12, v253
    v_mul_f32 v13, v13, v253
    v_mul_f32 v14, v14, v253
    v_mul_f32 v15, v15, v253
    v_mul_f32 v16, v16, v253
    v_mul_f32 v17, v17, v253
    v_mul_f32 v18, v18, v253
    v_mul_f32 v19, v19, v253
    v_mul_f32 v20, v20, v253
    v_mul_f32 v21, v21, v253
    v_mul_f32 v22, v22, v253
    v_mul_f32 v23, v23, v253
    v_mul_f32 v24, v24, v253
    v_mul_f32 v25, v25, v253
    v_mul_f32 v26, v26, v253
    v_mul_f32 v27, v27, v253
    v_mul_f32 v28, v28, v253
    v_mul_f32 v29, v29, v253
    v_mul_f32 v30, v30, v253
    v_mul_f32 v31, v31, v253
    v_mul_f32 v216, v216, v253
    v_mul_f32 v217, v217, v253
    v_mul_f32 v218, v218, v253
    v_mul_f32 v219, v219, v253
    s_nop 1
    v_mfma_f32_16x16x32_bf16 v[216:219], a[224:227], v[208:211], v[216:219]
    v_mfma_f32_16x16x32_bf16 v[0:3], a[160:163], v[208:211], v[0:3]
    v_mfma_f32_16x16x32_bf16 v[4:7], a[164:167], v[208:211], v[4:7]
    v_mfma_f32_16x16x32_bf16 v[8:11], a[168:171], v[208:211], v[8:11]
    v_mfma_f32_16x16x32_bf16 v[12:15], a[172:175], v[208:211], v[12:15]
    v_mfma_f32_16x16x32_bf16 v[16:19], a[176:179], v[208:211], v[16:19]
    v_mfma_f32_16x16x32_bf16 v[20:23], a[180:183], v[208:211], v[20:23]
    v_mfma_f32_16x16x32_bf16 v[24:27], a[184:187], v[208:211], v[24:27]
    v_mfma_f32_16x16x32_bf16 v[28:31], a[188:191], v[208:211], v[28:31]
    v_mfma_f32_16x16x32_bf16 v[192:195], a[96:99], a[16:19], 0
    v_mfma_f32_16x16x32_bf16 v[192:195], a[100:103], a[20:23], v[192:195]
    v_mfma_f32_16x16x32_bf16 v[192:195], a[104:107], a[24:27], v[192:195]
    v_mfma_f32_16x16x32_bf16 v[192:195], a[108:111], a[28:31], v[192:195]
    v_mfma_f32_16x16x32_bf16 v[196:199], a[124:127], a[28:31], 0
    v_mfma_f32_16x16x32_bf16 v[196:199], a[120:123], a[24:27], v[196:199]
    v_mfma_f32_16x16x32_bf16 v[196:199], a[116:119], a[20:23], v[196:199]
    v_mfma_f32_16x16x32_bf16 v[196:199], a[112:115], a[16:19], v[196:199]
    s_nop 3
    v_max3_f32 v252, v192, v193, v194
    s_nop 2
    v_max3_f32 v252, v252, v195, v196
    v_max3_f32 v252, v252, v197, v198
    v_max_f32 v253, v252, v199
    v_max_f32 v252, v252, v199
    s_nop 1
    v_permlane16_swap_b32 v252, v253
    v_max_f32 v252, v252, v253
    v_mov_b32 v253, v252
    s_nop 1
    v_permlane32_swap_b32 v252, v253
    v_max_f32 v252, v252, v253
    v_max_f32 v252, v252, v241
    v_sub_f32 v253, v241, v252
    v_mul_f32 v253, s21, v253
    v_exp_f32 v253, v253
    v_mov_b32 v241, v252
    v_mul_f32 v252, s35, v252
    v_fma_f32 v192, v192, s21, v252
    v_fma_f32 v193, v193, s21, v252
    v_fma_f32 v194, v194, s21, v252
    v_fma_f32 v195, v195, s21, v252
    v_fma_f32 v196, v196, s21, v252
    v_fma_f32 v197, v197, s21, v252
    v_fma_f32 v198, v198, s21, v252
    v_fma_f32 v199, v199, s21, v252
    v_exp_f32 v192, v192
    v_exp_f32 v193, v193
    v_exp_f32 v194, v194
    v_exp_f32 v195, v195
    v_exp_f32 v196, v196
    v_exp_f32 v197, v197
    v_exp_f32 v198, v198
    v_exp_f32 v199, v199
    v_cvt_pk_bf16_f32 v208, v192, v193
    v_cvt_pk_bf16_f32 v209, v194, v195
    v_cvt_pk_bf16_f32 v210, v196, v197
    v_cvt_pk_bf16_f32 v211, v198, v199
    v_mul_f32 v32, v32, v253
    v_mul_f32 v33, v33, v253
    v_mul_f32 v34, v34, v253
    v_mul_f32 v35, v35, v253
    v_mul_f32 v36, v36, v253
    v_mul_f32 v37, v37, v253
    v_mul_f32 v38, v38, v253
    v_mul_f32 v39, v39, v253
    v_mul_f32 v40, v40, v253
    v_mul_f32 v41, v41, v253
    v_mul_f32 v42, v42, v253
    v_mul_f32 v43, v43, v253
    v_mul_f32 v44, v44, v253
    v_mul_f32 v45, v45, v253
    v_mul_f32 v46, v46, v253
    v_mul_f32 v47, v47, v253
    v_mul_f32 v48, v48, v253
    v_mul_f32 v49, v49, v253
    v_mul_f32 v50, v50, v253
    v_mul_f32 v51, v51, v253
    v_mul_f32 v52, v52, v253
    v_mul_f32 v53, v53, v253
    v_mul_f32 v54, v54, v253
    v_mul_f32 v55, v55, v253
    v_mul_f32 v56, v56, v253
    v_mul_f32 v57, v57, v253
    v_mul_f32 v58, v58, v253
    v_mul_f32 v59, v59, v253
    v_mul_f32 v60, v60, v253
    v_mul_f32 v61, v61, v253
    v_mul_f32 v62, v62, v253
    v_mul_f32 v63, v63, v253
    v_mul_f32 v220, v220, v253
    v_mul_f32 v221, v221, v253
    v_mul_f32 v222, v222, v253
    v_mul_f32 v223, v223, v253
    s_nop 1
    v_mfma_f32_16x16x32_bf16 v[220:223], a[224:227], v[208:211], v[220:223]
    v_mfma_f32_16x16x32_bf16 v[32:35], a[160:163], v[208:211], v[32:35]
    v_mfma_f32_16x16x32_bf16 v[36:39], a[164:167], v[208:211], v[36:39]
    v_mfma_f32_16x16x32_bf16 v[40:43], a[168:171], v[208:211], v[40:43]
    v_mfma_f32_16x16x32_bf16 v[44:47], a[172:175], v[208:211], v[44:47]
    v_mfma_f32_16x16x32_bf16 v[48:51], a[176:179], v[208:211], v[48:51]
    v_mfma_f32_16x16x32_bf16 v[52:55], a[180:183], v[208:211], v[52:55]
    v_mfma_f32_16x16x32_bf16 v[56:59], a[184:187], v[208:211], v[56:59]
    v_mfma_f32_16x16x32_bf16 v[60:63], a[188:191], v[208:211], v[60:63]
    v_mfma_f32_16x16x32_bf16 v[192:195], a[96:99], a[32:35], 0
    v_mfma_f32_16x16x32_bf16 v[192:195], a[100:103], a[36:39], v[192:195]
    v_mfma_f32_16x16x32_bf16 v[192:195], a[104:107], a[40:43], v[192:195]
    v_mfma_f32_16x16x32_bf16 v[192:195], a[108:111], a[44:47], v[192:195]
    v_mfma_f32_16x16x32_bf16 v[196:199], a[124:127], a[44:47], 0
    v_mfma_f32_16x16x32_bf16 v[196:199], a[120:123], a[40:43], v[196:199]
    v_mfma_f32_16x16x32_bf16 v[196:199], a[116:119], a[36:39], v[196:199]
    v_mfma_f32_16x16x32_bf16 v[196:199], a[112:115], a[32:35], v[196:199]
    s_nop 3
    v_max3_f32 v252, v192, v193, v194
    s_nop 2
    v_max3_f32 v252, v252, v195, v196
    v_max3_f32 v252, v252, v197, v198
    v_max_f32 v253, v252, v199
    v_max_f32 v252, v252, v199
    s_nop 1
    v_permlane16_swap_b32 v252, v253
    v_max_f32 v252, v252, v253
    v_mov_b32 v253, v252
    s_nop 1
    v_permlane32_swap_b32 v252, v253
    v_max_f32 v252, v252, v253
    v_max_f32 v252, v252, v242
    v_sub_f32 v253, v242, v252
    v_mul_f32 v253, s21, v253
    v_exp_f32 v253, v253
    v_mov_b32 v242, v252
    v_mul_f32 v252, s35, v252
    v_fma_f32 v192, v192, s21, v252
    v_fma_f32 v193, v193, s21, v252
    v_fma_f32 v194, v194, s21, v252
    v_fma_f32 v195, v195, s21, v252
    v_fma_f32 v196, v196, s21, v252
    v_fma_f32 v197, v197, s21, v252
    v_fma_f32 v198, v198, s21, v252
    v_fma_f32 v199, v199, s21, v252
    v_exp_f32 v192, v192
    v_exp_f32 v193, v193
    v_exp_f32 v194, v194
    v_exp_f32 v195, v195
    v_exp_f32 v196, v196
    v_exp_f32 v197, v197
    v_exp_f32 v198, v198
    v_exp_f32 v199, v199
    v_cvt_pk_bf16_f32 v208, v192, v193
    v_cvt_pk_bf16_f32 v209, v194, v195
    v_cvt_pk_bf16_f32 v210, v196, v197
    v_cvt_pk_bf16_f32 v211, v198, v199
    v_mul_f32 v64, v64, v253
    v_mul_f32 v65, v65, v253
    v_mul_f32 v66, v66, v253
    v_mul_f32 v67, v67, v253
    v_mul_f32 v68, v68, v253
    v_mul_f32 v69, v69, v253
    v_mul_f32 v70, v70, v253
    v_mul_f32 v71, v71, v253
    v_mul_f32 v72, v72, v253
    v_mul_f32 v73, v73, v253
    v_mul_f32 v74, v74, v253
    v_mul_f32 v75, v75, v253
    v_mul_f32 v76, v76, v253
    v_mul_f32 v77, v77, v253
    v_mul_f32 v78, v78, v253
    v_mul_f32 v79, v79, v253
    v_mul_f32 v80, v80, v253
    v_mul_f32 v81, v81, v253
    v_mul_f32 v82, v82, v253
    v_mul_f32 v83, v83, v253
    v_mul_f32 v84, v84, v253
    v_mul_f32 v85, v85, v253
    v_mul_f32 v86, v86, v253
    v_mul_f32 v87, v87, v253
    v_mul_f32 v88, v88, v253
    v_mul_f32 v89, v89, v253
    v_mul_f32 v90, v90, v253
    v_mul_f32 v91, v91, v253
    v_mul_f32 v92, v92, v253
    v_mul_f32 v93, v93, v253
    v_mul_f32 v94, v94, v253
    v_mul_f32 v95, v95, v253
    v_mul_f32 v224, v224, v253
    v_mul_f32 v225, v225, v253
    v_mul_f32 v226, v226, v253
    v_mul_f32 v227, v227, v253
    s_nop 1
    v_mfma_f32_16x16x32_bf16 v[224:227], a[224:227], v[208:211], v[224:227]
    v_mfma_f32_16x16x32_bf16 v[64:67], a[160:163], v[208:211], v[64:67]
    v_mfma_f32_16x16x32_bf16 v[68:71], a[164:167], v[208:211], v[68:71]
    v_mfma_f32_16x16x32_bf16 v[72:75], a[168:171], v[208:211], v[72:75]
    v_mfma_f32_16x16x32_bf16 v[76:79], a[172:175], v[208:211], v[76:79]
    v_mfma_f32_16x16x32_bf16 v[80:83], a[176:179], v[208:211], v[80:83]
    v_mfma_f32_16x16x32_bf16 v[84:87], a[180:183], v[208:211], v[84:87]
    v_mfma_f32_16x16x32_bf16 v[88:91], a[184:187], v[208:211], v[88:91]
    v_mfma_f32_16x16x32_bf16 v[92:95], a[188:191], v[208:211], v[92:95]
    v_mfma_f32_16x16x32_bf16 v[192:195], a[96:99], a[48:51], 0
    v_mfma_f32_16x16x32_bf16 v[192:195], a[100:103], a[52:55], v[192:195]
    v_mfma_f32_16x16x32_bf16 v[192:195], a[104:107], a[56:59], v[192:195]
    v_mfma_f32_16x16x32_bf16 v[192:195], a[108:111], a[60:63], v[192:195]
    v_mfma_f32_16x16x32_bf16 v[196:199], a[124:127], a[60:63], 0
    v_mfma_f32_16x16x32_bf16 v[196:199], a[120:123], a[56:59], v[196:199]
    v_mfma_f32_16x16x32_bf16 v[196:199], a[116:119], a[52:55], v[196:199]
    v_mfma_f32_16x16x32_bf16 v[196:199], a[112:115], a[48:51], v[196:199]
    s_nop 3
    v_max3_f32 v252, v192, v193, v194
    s_nop 2
    v_max3_f32 v252, v252, v195, v196
    v_max3_f32 v252, v252, v197, v198
    v_max_f32 v253, v252, v199
    v_max_f32 v252, v252, v199
    s_nop 1
    v_permlane16_swap_b32 v252, v253
    v_max_f32 v252, v252, v253
    v_mov_b32 v253, v252
    s_nop 1
    v_permlane32_swap_b32 v252, v253
    v_max_f32 v252, v252, v253
    v_max_f32 v252, v252, v243
    v_sub_f32 v253, v243, v252
    v_mul_f32 v253, s21, v253
    v_exp_f32 v253, v253
    v_mov_b32 v243, v252
    v_mul_f32 v252, s35, v252
    v_fma_f32 v192, v192, s21, v252
    v_fma_f32 v193, v193, s21, v252
    v_fma_f32 v194, v194, s21, v252
    v_fma_f32 v195, v195, s21, v252
    v_fma_f32 v196, v196, s21, v252
    v_fma_f32 v197, v197, s21, v252
    v_fma_f32 v198, v198, s21, v252
    v_fma_f32 v199, v199, s21, v252
    v_exp_f32 v192, v192
    v_exp_f32 v193, v193
    v_exp_f32 v194, v194
    v_exp_f32 v195, v195
    v_exp_f32 v196, v196
    v_exp_f32 v197, v197
    v_exp_f32 v198, v198
    v_exp_f32 v199, v199
    v_cvt_pk_bf16_f32 v208, v192, v193
    v_cvt_pk_bf16_f32 v209, v194, v195
    v_cvt_pk_bf16_f32 v210, v196, v197
    v_cvt_pk_bf16_f32 v211, v198, v199
    v_mul_f32 v96, v96, v253
    v_mul_f32 v97, v97, v253
    v_mul_f32 v98, v98, v253
    v_mul_f32 v99, v99, v253
    v_mul_f32 v100, v100, v253
    v_mul_f32 v101, v101, v253
    v_mul_f32 v102, v102, v253
    v_mul_f32 v103, v103, v253
    v_mul_f32 v104, v104, v253
    v_mul_f32 v105, v105, v253
    v_mul_f32 v106, v106, v253
    v_mul_f32 v107, v107, v253
    v_mul_f32 v108, v108, v253
    v_mul_f32 v109, v109, v253
    v_mul_f32 v110, v110, v253
    v_mul_f32 v111, v111, v253
    v_mul_f32 v112, v112, v253
    v_mul_f32 v113, v113, v253
    v_mul_f32 v114, v114, v253
    v_mul_f32 v115, v115, v253
    v_mul_f32 v116, v116, v253
    v_mul_f32 v117, v117, v253
    v_mul_f32 v118, v118, v253
    v_mul_f32 v119, v119, v253
    v_mul_f32 v120, v120, v253
    v_mul_f32 v121, v121, v253
    v_mul_f32 v122, v122, v253
    v_mul_f32 v123, v123, v253
    v_mul_f32 v124, v124, v253
    v_mul_f32 v125, v125, v253
    v_mul_f32 v126, v126, v253
    v_mul_f32 v127, v127, v253
    v_mul_f32 v228, v228, v253
    v_mul_f32 v229, v229, v253
    v_mul_f32 v230, v230, v253
    v_mul_f32 v231, v231, v253
    s_nop 1
    v_mfma_f32_16x16x32_bf16 v[228:231], a[224:227], v[208:211], v[228:231]
    v_mfma_f32_16x16x32_bf16 v[96:99], a[160:163], v[208:211], v[96:99]
    v_mfma_f32_16x16x32_bf16 v[100:103], a[164:167], v[208:211], v[100:103]
    v_mfma_f32_16x16x32_bf16 v[104:107], a[168:171], v[208:211], v[104:107]
    v_mfma_f32_16x16x32_bf16 v[108:111], a[172:175], v[208:211], v[108:111]
    v_mfma_f32_16x16x32_bf16 v[112:115], a[176:179], v[208:211], v[112:115]
    v_mfma_f32_16x16x32_bf16 v[116:119], a[180:183], v[208:211], v[116:119]
    v_mfma_f32_16x16x32_bf16 v[120:123], a[184:187], v[208:211], v[120:123]
    v_mfma_f32_16x16x32_bf16 v[124:127], a[188:191], v[208:211], v[124:127]
    v_mfma_f32_16x16x32_bf16 v[192:195], a[96:99], a[64:67], 0
    v_mfma_f32_16x16x32_bf16 v[192:195], a[100:103], a[68:71], v[192:195]
    v_mfma_f32_16x16x32_bf16 v[192:195], a[104:107], a[72:75], v[192:195]
    v_mfma_f32_16x16x32_bf16 v[192:195], a[108:111], a[76:79], v[192:195]
    v_mfma_f32_16x16x32_bf16 v[196:199], a[124:127], a[76:79], 0
    v_mfma_f32_16x16x32_bf16 v[196:199], a[120:123], a[72:75], v[196:199]
    v_mfma_f32_16x16x32_bf16 v[196:199], a[116:119], a[68:71], v[196:199]
    v_mfma_f32_16x16x32_bf16 v[196:199], a[112:115], a[64:67], v[196:199]
    s_nop 3
    v_max3_f32 v252, v192, v193, v194
    s_nop 2
    v_max3_f32 v252, v252, v195, v196
    v_max3_f32 v252, v252, v197, v198
    v_max_f32 v253, v252, v199
    v_max_f32 v252, v252, v199
    s_nop 1
    v_permlane16_swap_b32 v252, v253
    v_max_f32 v252, v252, v253
    v_mov_b32 v253, v252
    s_nop 1
    v_permlane32_swap_b32 v252, v253
    v_max_f32 v252, v252, v253
    v_max_f32 v252, v252, v244
    v_sub_f32 v253, v244, v252
    v_mul_f32 v253, s21, v253
    v_exp_f32 v253, v253
    v_mov_b32 v244, v252
    v_mul_f32 v252, s35, v252
    v_fma_f32 v192, v192, s21, v252
    v_fma_f32 v193, v193, s21, v252
    v_fma_f32 v194, v194, s21, v252
    v_fma_f32 v195, v195, s21, v252
    v_fma_f32 v196, v196, s21, v252
    v_fma_f32 v197, v197, s21, v252
    v_fma_f32 v198, v198, s21, v252
    v_fma_f32 v199, v199, s21, v252
    v_exp_f32 v192, v192
    v_exp_f32 v193, v193
    v_exp_f32 v194, v194
    v_exp_f32 v195, v195
    v_exp_f32 v196, v196
    v_exp_f32 v197, v197
    v_exp_f32 v198, v198
    v_exp_f32 v199, v199
    v_cvt_pk_bf16_f32 v208, v192, v193
    v_cvt_pk_bf16_f32 v209, v194, v195
    v_cvt_pk_bf16_f32 v210, v196, v197
    v_cvt_pk_bf16_f32 v211, v198, v199
    v_mul_f32 v128, v128, v253
    v_mul_f32 v129, v129, v253
    v_mul_f32 v130, v130, v253
    v_mul_f32 v131, v131, v253
    v_mul_f32 v132, v132, v253
    v_mul_f32 v133, v133, v253
    v_mul_f32 v134, v134, v253
    v_mul_f32 v135, v135, v253
    v_mul_f32 v136, v136, v253
    v_mul_f32 v137, v137, v253
    v_mul_f32 v138, v138, v253
    v_mul_f32 v139, v139, v253
    v_mul_f32 v140, v140, v253
    v_mul_f32 v141, v141, v253
    v_mul_f32 v142, v142, v253
    v_mul_f32 v143, v143, v253
    v_mul_f32 v144, v144, v253
    v_mul_f32 v145, v145, v253
    v_mul_f32 v146, v146, v253
    v_mul_f32 v147, v147, v253
    v_mul_f32 v148, v148, v253
    v_mul_f32 v149, v149, v253
    v_mul_f32 v150, v150, v253
    v_mul_f32 v151, v151, v253
    v_mul_f32 v152, v152, v253
    v_mul_f32 v153, v153, v253
    v_mul_f32 v154, v154, v253
    v_mul_f32 v155, v155, v253
    v_mul_f32 v156, v156, v253
    v_mul_f32 v157, v157, v253
    v_mul_f32 v158, v158, v253
    v_mul_f32 v159, v159, v253
    v_mul_f32 v232, v232, v253
    v_mul_f32 v233, v233, v253
    v_mul_f32 v234, v234, v253
    v_mul_f32 v235, v235, v253
    s_nop 1
    v_mfma_f32_16x16x32_bf16 v[232:235], a[224:227], v[208:211], v[232:235]
    v_mfma_f32_16x16x32_bf16 v[128:131], a[160:163], v[208:211], v[128:131]
    v_mfma_f32_16x16x32_bf16 v[132:135], a[164:167], v[208:211], v[132:135]
    v_mfma_f32_16x16x32_bf16 v[136:139], a[168:171], v[208:211], v[136:139]
    v_mfma_f32_16x16x32_bf16 v[140:143], a[172:175], v[208:211], v[140:143]
    v_mfma_f32_16x16x32_bf16 v[144:147], a[176:179], v[208:211], v[144:147]
    v_mfma_f32_16x16x32_bf16 v[148:151], a[180:183], v[208:211], v[148:151]
    v_mfma_f32_16x16x32_bf16 v[152:155], a[184:187], v[208:211], v[152:155]
    v_mfma_f32_16x16x32_bf16 v[156:159], a[188:191], v[208:211], v[156:159]
    v_mfma_f32_16x16x32_bf16 v[192:195], a[96:99], a[80:83], 0
    v_mfma_f32_16x16x32_bf16 v[192:195], a[100:103], a[84:87], v[192:195]
    v_mfma_f32_16x16x32_bf16 v[192:195], a[104:107], a[88:91], v[192:195]
    v_mfma_f32_16x16x32_bf16 v[192:195], a[108:111], a[92:95], v[192:195]
    v_mfma_f32_16x16x32_bf16 v[196:199], a[124:127], a[92:95], 0
    v_mfma_f32_16x16x32_bf16 v[196:199], a[120:123], a[88:91], v[196:199]
    v_mfma_f32_16x16x32_bf16 v[196:199], a[116:119], a[84:87], v[196:199]
    v_mfma_f32_16x16x32_bf16 v[196:199], a[112:115], a[80:83], v[196:199]
    s_nop 3
    v_max3_f32 v252, v192, v193, v194
    s_nop 2
    v_max3_f32 v252, v252, v195, v196
    v_max3_f32 v252, v252, v197, v198
    v_max_f32 v253, v252, v199
    v_max_f32 v252, v252, v199
    s_nop 1
    v_permlane16_swap_b32 v252, v253
    v_max_f32 v252, v252, v253
    v_mov_b32 v253, v252
    s_nop 1
    v_permlane32_swap_b32 v252, v253
    v_max_f32 v252, v252, v253
    v_max_f32 v252, v252, v245
    v_sub_f32 v253, v245, v252
    v_mul_f32 v253, s21, v253
    v_exp_f32 v253, v253
    v_mov_b32 v245, v252
    v_mul_f32 v252, s35, v252
    v_fma_f32 v192, v192, s21, v252
    v_fma_f32 v193, v193, s21, v252
    v_fma_f32 v194, v194, s21, v252
    v_fma_f32 v195, v195, s21, v252
    v_fma_f32 v196, v196, s21, v252
    v_fma_f32 v197, v197, s21, v252
    v_fma_f32 v198, v198, s21, v252
    v_fma_f32 v199, v199, s21, v252
    v_exp_f32 v192, v192
    v_exp_f32 v193, v193
    v_exp_f32 v194, v194
    v_exp_f32 v195, v195
    v_exp_f32 v196, v196
    v_exp_f32 v197, v197
    v_exp_f32 v198, v198
    v_exp_f32 v199, v199
    v_cvt_pk_bf16_f32 v208, v192, v193
    v_cvt_pk_bf16_f32 v209, v194, v195
    v_cvt_pk_bf16_f32 v210, v196, v197
    v_cvt_pk_bf16_f32 v211, v198, v199
    v_mul_f32 v160, v160, v253
    v_mul_f32 v161, v161, v253
    v_mul_f32 v162, v162, v253
    v_mul_f32 v163, v163, v253
    v_mul_f32 v164, v164, v253
    v_mul_f32 v165, v165, v253
    v_mul_f32 v166, v166, v253
    v_mul_f32 v167, v167, v253
    v_mul_f32 v168, v168, v253
    v_mul_f32 v169, v169, v253
    v_mul_f32 v170, v170, v253
    v_mul_f32 v171, v171, v253
    v_mul_f32 v172, v172, v253
    v_mul_f32 v173, v173, v253
    v_mul_f32 v174, v174, v253
    v_mul_f32 v175, v175, v253
    v_mul_f32 v176, v176, v253
    v_mul_f32 v177, v177, v253
    v_mul_f32 v178, v178, v253
    v_mul_f32 v179, v179, v253
    v_mul_f32 v180, v180, v253
    v_mul_f32 v181, v181, v253
    v_mul_f32 v182, v182, v253
    v_mul_f32 v183, v183, v253
    v_mul_f32 v184, v184, v253
    v_mul_f32 v185, v185, v253
    v_mul_f32 v186, v186, v253
    v_mul_f32 v187, v187, v253
    v_mul_f32 v188, v188, v253
    v_mul_f32 v189, v189, v253
    v_mul_f32 v190, v190, v253
    v_mul_f32 v191, v191, v253
    v_mul_f32 v236, v236, v253
    v_mul_f32 v237, v237, v253
    v_mul_f32 v238, v238, v253
    v_mul_f32 v239, v239, v253
    s_nop 1
    v_mfma_f32_16x16x32_bf16 v[236:239], a[224:227], v[208:211], v[236:239]
    v_mfma_f32_16x16x32_bf16 v[160:163], a[160:163], v[208:211], v[160:163]
    v_mfma_f32_16x16x32_bf16 v[164:167], a[164:167], v[208:211], v[164:167]
    v_mfma_f32_16x16x32_bf16 v[168:171], a[168:171], v[208:211], v[168:171]
    v_mfma_f32_16x16x32_bf16 v[172:175], a[172:175], v[208:211], v[172:175]
    v_mfma_f32_16x16x32_bf16 v[176:179], a[176:179], v[208:211], v[176:179]
    v_mfma_f32_16x16x32_bf16 v[180:183], a[180:183], v[208:211], v[180:183]
    v_mfma_f32_16x16x32_bf16 v[184:187], a[184:187], v[208:211], v[184:187]
    v_mfma_f32_16x16x32_bf16 v[188:191], a[188:191], v[208:211], v[188:191]
    s_nop 11
    s_sub_u32 s23, s23, 1
    s_cmp_lg_u32 s23, 0
    s_cbranch_scc1 Lslowloop
    v_rcp_f32 v218, v216
    v_cmp_ngt_f32 vcc, s22, v216
    v_pk_mul_f32 v[0:1], v[0:1], v[218:219] op_sel_hi:[1,0]
    v_pk_mul_f32 v[2:3], v[2:3], v[218:219] op_sel_hi:[1,0]
    v_pk_mul_f32 v[4:5], v[4:5], v[218:219] op_sel_hi:[1,0]
    v_pk_mul_f32 v[6:7], v[6:7], v[218:219] op_sel_hi:[1,0]
    v_pk_mul_f32 v[8:9], v[8:9], v[218:219] op_sel_hi:[1,0]
    v_pk_mul_f32 v[10:11], v[10:11], v[218:219] op_sel_hi:[1,0]
    v_pk_mul_f32 v[12:13], v[12:13], v[218:219] op_sel_hi:[1,0]
    v_pk_mul_f32 v[14:15], v[14:15], v[218:219] op_sel_hi:[1,0]
    v_pk_mul_f32 v[16:17], v[16:17], v[218:219] op_sel_hi:[1,0]
    v_pk_mul_f32 v[18:19], v[18:19], v[218:219] op_sel_hi:[1,0]
    v_pk_mul_f32 v[20:21], v[20:21], v[218:219] op_sel_hi:[1,0]
    v_pk_mul_f32 v[22:23], v[22:23], v[218:219] op_sel_hi:[1,0]
    v_pk_mul_f32 v[24:25], v[24:25], v[218:219] op_sel_hi:[1,0]
    v_pk_mul_f32 v[26:27], v[26:27], v[218:219] op_sel_hi:[1,0]
    v_pk_mul_f32 v[28:29], v[28:29], v[218:219] op_sel_hi:[1,0]
    v_pk_mul_f32 v[30:31], v[30:31], v[218:219] op_sel_hi:[1,0]
    v_cvt_pk_bf16_f32 v0, v0, v1
    v_cvt_pk_bf16_f32 v1, v2, v3
    v_cvt_pk_bf16_f32 v2, v4, v5
    v_cvt_pk_bf16_f32 v3, v6, v7
    v_cvt_pk_bf16_f32 v8, v8, v9
    v_cvt_pk_bf16_f32 v9, v10, v11
    v_cvt_pk_bf16_f32 v10, v12, v13
    v_cvt_pk_bf16_f32 v11, v14, v15
    v_cvt_pk_bf16_f32 v16, v16, v17
    v_cvt_pk_bf16_f32 v17, v18, v19
    v_cvt_pk_bf16_f32 v18, v20, v21
    v_cvt_pk_bf16_f32 v19, v22, v23
    v_cvt_pk_bf16_f32 v24, v24, v25
    v_cvt_pk_bf16_f32 v25, v26, v27
    v_cvt_pk_bf16_f32 v26, v28, v29
    v_cvt_pk_bf16_f32 v27, v30, v31
    ds_write_b128 v250, v[0:3] offset:50688
    ds_write_b128 v250, v[8:11] offset:50752
    ds_write_b128 v250, v[16:19] offset:50816
    ds_write_b128 v250, v[24:27] offset:50880
    ds_read_b128 a[228:231], v251 offset:50688
    ds_read_b128 a[232:235], v251 offset:51744
    ds_read_b128 a[236:239], v251 offset:52800
    ds_read_b128 a[240:243], v251 offset:53856
    s_waitcnt lgkmcnt(0)
    buffer_store_dwordx4 a[228:231], v248, s[16:19], s25 offen sc1
    buffer_store_dwordx4 a[232:235], v248, s[16:19], s25 offen offset:1024 sc1
    buffer_store_dwordx4 a[236:239], v248, s[16:19], s25 offen offset:2048 sc1
    buffer_store_dwordx4 a[240:243], v248, s[16:19], s25 offen offset:3072 sc1
    s_add_u32 s25, s25, 4096
    v_rcp_f32 v222, v220
    v_cmp_ngt_f32 vcc, s22, v220
    v_pk_mul_f32 v[32:33], v[32:33], v[222:223] op_sel_hi:[1,0]
    v_pk_mul_f32 v[34:35], v[34:35], v[222:223] op_sel_hi:[1,0]
    v_pk_mul_f32 v[36:37], v[36:37], v[222:223] op_sel_hi:[1,0]
    v_pk_mul_f32 v[38:39], v[38:39], v[222:223] op_sel_hi:[1,0]
    v_pk_mul_f32 v[40:41], v[40:41], v[222:223] op_sel_hi:[1,0]
    v_pk_mul_f32 v[42:43], v[42:43], v[222:223] op_sel_hi:[1,0]
    v_pk_mul_f32 v[44:45], v[44:45], v[222:223] op_sel_hi:[1,0]
    v_pk_mul_f32 v[46:47], v[46:47], v[222:223] op_sel_hi:[1,0]
    v_pk_mul_f32 v[48:49], v[48:49], v[222:223] op_sel_hi:[1,0]
    v_pk_mul_f32 v[50:51], v[50:51], v[222:223] op_sel_hi:[1,0]
    v_pk_mul_f32 v[52:53], v[52:53], v[222:223] op_sel_hi:[1,0]
    v_pk_mul_f32 v[54:55], v[54:55], v[222:223] op_sel_hi:[1,0]
    v_pk_mul_f32 v[56:57], v[56:57], v[222:223] op_sel_hi:[1,0]
    v_pk_mul_f32 v[58:59], v[58:59], v[222:223] op_sel_hi:[1,0]
    v_pk_mul_f32 v[60:61], v[60:61], v[222:223] op_sel_hi:[1,0]
    v_pk_mul_f32 v[62:63], v[62:63], v[222:223] op_sel_hi:[1,0]
    v_cvt_pk_bf16_f32 v32, v32, v33
    v_cvt_pk_bf16_f32 v33, v34, v35
    v_cvt_pk_bf16_f32 v34, v36, v37
    v_cvt_pk_bf16_f32 v35, v38, v39
    v_cvt_pk_bf16_f32 v40, v40, v41
    v_cvt_pk_bf16_f32 v41, v42, v43
    v_cvt_pk_bf16_f32 v42, v44, v45
    v_cvt_pk_bf16_f32 v43, v46, v47
    v_cvt_pk_bf16_f32 v48, v48, v49
    v_cvt_pk_bf16_f32 v49, v50, v51
    v_cvt_pk_bf16_f32 v50, v52, v53
    v_cvt_pk_bf16_f32 v51, v54, v55
    v_cvt_pk_bf16_f32 v56, v56, v57
    v_cvt_pk_bf16_f32 v57, v58, v59
    v_cvt_pk_bf16_f32 v58, v60, v61
    v_cvt_pk_bf16_f32 v59, v62, v63
    v_add_u32 v250, 33792, v250
    ds_write_b128 v250, v[32:35] offset:33792
    ds_write_b128 v250, v[40:43] offset:33856
    ds_write_b128 v250, v[48:51] offset:33920
    ds_write_b128 v250, v[56:59] offset:33984
    v_add_u32 v251, 33792, v251
    ds_read_b128 a[228:231], v251 offset:33792
    ds_read_b128 a[232:235], v251 offset:34848
    ds_read_b128 a[236:239], v251 offset:35904
    ds_read_b128 a[240:243], v251 offset:36960
    s_waitcnt lgkmcnt(0)
    buffer_store_dwordx4 a[228:231], v248, s[16:19], s25 offen sc1
    buffer_store_dwordx4 a[232:235], v248, s[16:19], s25 offen offset:1024 sc1
    buffer_store_dwordx4 a[236:239], v248, s[16:19], s25 offen offset:2048 sc1
    buffer_store_dwordx4 a[240:243], v248, s[16:19], s25 offen offset:3072 sc1
    s_add_u32 s25, s25, 4096
    v_rcp_f32 v226, v224
    v_cmp_ngt_f32 vcc, s22, v224
    v_pk_mul_f32 v[64:65], v[64:65], v[226:227] op_sel_hi:[1,0]
    v_pk_mul_f32 v[66:67], v[66:67], v[226:227] op_sel_hi:[1,0]
    v_pk_mul_f32 v[68:69], v[68:69], v[226:227] op_sel_hi:[1,0]
    v_pk_mul_f32 v[70:71], v[70:71], v[226:227] op_sel_hi:[1,0]
    v_pk_mul_f32 v[72:73], v[72:73], v[226:227] op_sel_hi:[1,0]
    v_pk_mul_f32 v[74:75], v[74:75], v[226:227] op_sel_hi:[1,0]
    v_pk_mul_f32 v[76:77], v[76:77], v[226:227] op_sel_hi:[1,0]
    v_pk_mul_f32 v[78:79], v[78:79], v[226:227] op_sel_hi:[1,0]
    v_pk_mul_f32 v[80:81], v[80:81], v[226:227] op_sel_hi:[1,0]
    v_pk_mul_f32 v[82:83], v[82:83], v[226:227] op_sel_hi:[1,0]
    v_pk_mul_f32 v[84:85], v[84:85], v[226:227] op_sel_hi:[1,0]
    v_pk_mul_f32 v[86:87], v[86:87], v[226:227] op_sel_hi:[1,0]
    v_pk_mul_f32 v[88:89], v[88:89], v[226:227] op_sel_hi:[1,0]
    v_pk_mul_f32 v[90:91], v[90:91], v[226:227] op_sel_hi:[1,0]
    v_pk_mul_f32 v[92:93], v[92:93], v[226:227] op_sel_hi:[1,0]
    v_pk_mul_f32 v[94:95], v[94:95], v[226:227] op_sel_hi:[1,0]
    v_cvt_pk_bf16_f32 v64, v64, v65
    v_cvt_pk_bf16_f32 v65, v66, v67
    v_cvt_pk_bf16_f32 v66, v68, v69
    v_cvt_pk_bf16_f32 v67, v70, v71
    v_cvt_pk_bf16_f32 v72, v72, v73
    v_cvt_pk_bf16_f32 v73, v74, v75
    v_cvt_pk_bf16_f32 v74, v76, v77
    v_cvt_pk_bf16_f32 v75, v78, v79
    v_cvt_pk_bf16_f32 v80, v80, v81
    v_cvt_pk_bf16_f32 v81, v82, v83
    v_cvt_pk_bf16_f32 v82, v84, v85
    v_cvt_pk_bf16_f32 v83, v86, v87
    v_cvt_pk_bf16_f32 v88, v88, v89
    v_cvt_pk_bf16_f32 v89, v90, v91
    v_cvt_pk_bf16_f32 v90, v92, v93
    v_cvt_pk_bf16_f32 v91, v94, v95
    ds_write_b128 v250, v[64:67] offset:50688
    ds_write_b128 v250, v[72:75] offset:50752
    ds_write_b128 v250, v[80:83] offset:50816
    ds_write_b128 v250, v[88:91] offset:50880
    ds_read_b128 a[228:231], v251 offset:50688
    ds_read_b128 a[232:235], v251 offset:51744
    ds_read_b128 a[236:239], v251 offset:52800
    ds_read_b128 a[240:243], v251 offset:53856
    s_waitcnt lgkmcnt(0)
    buffer_store_dwordx4 a[228:231], v248, s[16:19], s25 offen sc1
    buffer_store_dwordx4 a[232:235], v248, s[16:19], s25 offen offset:1024 sc1
    buffer_store_dwordx4 a[236:239], v248, s[16:19], s25 offen offset:2048 sc1
    buffer_store_dwordx4 a[240:243], v248, s[16:19], s25 offen offset:3072 sc1
    s_add_u32 s25, s25, 4096
    v_rcp_f32 v230, v228
    v_cmp_ngt_f32 vcc, s22, v228
    v_pk_mul_f32 v[96:97], v[96:97], v[230:231] op_sel_hi:[1,0]
    v_pk_mul_f32 v[98:99], v[98:99], v[230:231] op_sel_hi:[1,0]
    v_pk_mul_f32 v[100:101], v[100:101], v[230:231] op_sel_hi:[1,0]
    v_pk_mul_f32 v[102:103], v[102:103], v[230:231] op_sel_hi:[1,0]
    v_pk_mul_f32 v[104:105], v[104:105], v[230:231] op_sel_hi:[1,0]
    v_pk_mul_f32 v[106:107], v[106:107], v[230:231] op_sel_hi:[1,0]
    v_pk_mul_f32 v[108:109], v[108:109], v[230:231] op_sel_hi:[1,0]
    v_pk_mul_f32 v[110:111], v[110:111], v[230:231] op_sel_hi:[1,0]
    v_pk_mul_f32 v[112:113], v[112:113], v[230:231] op_sel_hi:[1,0]
    v_pk_mul_f32 v[114:115], v[114:115], v[230:231] op_sel_hi:[1,0]
    v_pk_mul_f32 v[116:117], v[116:117], v[230:231] op_sel_hi:[1,0]
    v_pk_mul_f32 v[118:119], v[118:119], v[230:231] op_sel_hi:[1,0]
    v_pk_mul_f32 v[120:121], v[120:121], v[230:231] op_sel_hi:[1,0]
    v_pk_mul_f32 v[122:123], v[122:123], v[230:231] op_sel_hi:[1,0]
    v_pk_mul_f32 v[124:125], v[124:125], v[230:231] op_sel_hi:[1,0]
    v_pk_mul_f32 v[126:127], v[126:127], v[230:231] op_sel_hi:[1,0]
    v_cvt_pk_bf16_f32 v96, v96, v97
    v_cvt_pk_bf16_f32 v97, v98, v99
    v_cvt_pk_bf16_f32 v98, v100, v101
    v_cvt_pk_bf16_f32 v99, v102, v103
    v_cvt_pk_bf16_f32 v104, v104, v105
    v_cvt_pk_bf16_f32 v105, v106, v107
    v_cvt_pk_bf16_f32 v106, v108, v109
    v_cvt_pk_bf16_f32 v107, v110, v111
    v_cvt_pk_bf16_f32 v112, v112, v113
    v_cvt_pk_bf16_f32 v113, v114, v115
    v_cvt_pk_bf16_f32 v114, v116, v117
    v_cvt_pk_bf16_f32 v115, v118, v119
    v_cvt_pk_bf16_f32 v120, v120, v121
    v_cvt_pk_bf16_f32 v121, v122, v123
    v_cvt_pk_bf16_f32 v122, v124, v125
    v_cvt_pk_bf16_f32 v123, v126, v127
    ds_write_b128 v250, v[96:99] offset:16896
    ds_write_b128 v250, v[104:107] offset:16960
    ds_write_b128 v250, v[112:115] offset:17024
    ds_write_b128 v250, v[120:123] offset:17088
    ds_read_b128 a[228:231], v251 offset:16896
    ds_read_b128 a[232:235], v251 offset:17952
    ds_read_b128 a[236:239], v251 offset:19008
    ds_read_b128 a[240:243], v251 offset:20064
    s_waitcnt lgkmcnt(0)
    buffer_store_dwordx4 a[228:231], v248, s[16:19], s25 offen sc1
    buffer_store_dwordx4 a[232:235], v248, s[16:19], s25 offen offset:1024 sc1
    buffer_store_dwordx4 a[236:239], v248, s[16:19], s25 offen offset:2048 sc1
    buffer_store_dwordx4 a[240:243], v248, s[16:19], s25 offen offset:3072 sc1
    s_add_u32 s25, s25, 4096
    v_rcp_f32 v234, v232
    v_cmp_ngt_f32 vcc, s22, v232
    v_pk_mul_f32 v[128:129], v[128:129], v[234:235] op_sel_hi:[1,0]
    v_pk_mul_f32 v[130:131], v[130:131], v[234:235] op_sel_hi:[1,0]
    v_pk_mul_f32 v[132:133], v[132:133], v[234:235] op_sel_hi:[1,0]
    v_pk_mul_f32 v[134:135], v[134:135], v[234:235] op_sel_hi:[1,0]
    v_pk_mul_f32 v[136:137], v[136:137], v[234:235] op_sel_hi:[1,0]
    v_pk_mul_f32 v[138:139], v[138:139], v[234:235] op_sel_hi:[1,0]
    v_pk_mul_f32 v[140:141], v[140:141], v[234:235] op_sel_hi:[1,0]
    v_pk_mul_f32 v[142:143], v[142:143], v[234:235] op_sel_hi:[1,0]
    v_pk_mul_f32 v[144:145], v[144:145], v[234:235] op_sel_hi:[1,0]
    v_pk_mul_f32 v[146:147], v[146:147], v[234:235] op_sel_hi:[1,0]
    v_pk_mul_f32 v[148:149], v[148:149], v[234:235] op_sel_hi:[1,0]
    v_pk_mul_f32 v[150:151], v[150:151], v[234:235] op_sel_hi:[1,0]
    v_pk_mul_f32 v[152:153], v[152:153], v[234:235] op_sel_hi:[1,0]
    v_pk_mul_f32 v[154:155], v[154:155], v[234:235] op_sel_hi:[1,0]
    v_pk_mul_f32 v[156:157], v[156:157], v[234:235] op_sel_hi:[1,0]
    v_pk_mul_f32 v[158:159], v[158:159], v[234:235] op_sel_hi:[1,0]
    v_cvt_pk_bf16_f32 v128, v128, v129
    v_cvt_pk_bf16_f32 v129, v130, v131
    v_cvt_pk_bf16_f32 v130, v132, v133
    v_cvt_pk_bf16_f32 v131, v134, v135
    v_cvt_pk_bf16_f32 v136, v136, v137
    v_cvt_pk_bf16_f32 v137, v138, v139
    v_cvt_pk_bf16_f32 v138, v140, v141
    v_cvt_pk_bf16_f32 v139, v142, v143
    v_cvt_pk_bf16_f32 v144, v144, v145
    v_cvt_pk_bf16_f32 v145, v146, v147
    v_cvt_pk_bf16_f32 v146, v148, v149
    v_cvt_pk_bf16_f32 v147, v150, v151
    v_cvt_pk_bf16_f32 v152, v152, v153
    v_cvt_pk_bf16_f32 v153, v154, v155
    v_cvt_pk_bf16_f32 v154, v156, v157
    v_cvt_pk_bf16_f32 v155, v158, v159
    ds_write_b128 v250, v[128:131] offset:33792
    ds_write_b128 v250, v[136:139] offset:33856
    ds_write_b128 v250, v[144:147] offset:33920
    ds_write_b128 v250, v[152:155] offset:33984
    ds_read_b128 a[228:231], v251 offset:33792
    ds_read_b128 a[232:235], v251 offset:34848
    ds_read_b128 a[236:239], v251 offset:35904
    ds_read_b128 a[240:243], v251 offset:36960
    s_waitcnt lgkmcnt(0)
    buffer_store_dwordx4 a[228:231], v248, s[16:19], s25 offen sc1
    buffer_store_dwordx4 a[232:235], v248, s[16:19], s25 offen offset:1024 sc1
    buffer_store_dwordx4 a[236:239], v248, s[16:19], s25 offen offset:2048 sc1
    buffer_store_dwordx4 a[240:243], v248, s[16:19], s25 offen offset:3072 sc1
    s_add_u32 s25, s25, 4096
    v_rcp_f32 v238, v236
    v_cmp_ngt_f32 vcc, s22, v236
    v_pk_mul_f32 v[160:161], v[160:161], v[238:239] op_sel_hi:[1,0]
    v_pk_mul_f32 v[162:163], v[162:163], v[238:239] op_sel_hi:[1,0]
    v_pk_mul_f32 v[164:165], v[164:165], v[238:239] op_sel_hi:[1,0]
    v_pk_mul_f32 v[166:167], v[166:167], v[238:239] op_sel_hi:[1,0]
    v_pk_mul_f32 v[168:169], v[168:169], v[238:239] op_sel_hi:[1,0]
    v_pk_mul_f32 v[170:171], v[170:171], v[238:239] op_sel_hi:[1,0]
    v_pk_mul_f32 v[172:173], v[172:173], v[238:239] op_sel_hi:[1,0]
    v_pk_mul_f32 v[174:175], v[174:175], v[238:239] op_sel_hi:[1,0]
    v_pk_mul_f32 v[176:177], v[176:177], v[238:239] op_sel_hi:[1,0]
    v_pk_mul_f32 v[178:179], v[178:179], v[238:239] op_sel_hi:[1,0]
    v_pk_mul_f32 v[180:181], v[180:181], v[238:239] op_sel_hi:[1,0]
    v_pk_mul_f32 v[182:183], v[182:183], v[238:239] op_sel_hi:[1,0]
    v_pk_mul_f32 v[184:185], v[184:185], v[238:239] op_sel_hi:[1,0]
    v_pk_mul_f32 v[186:187], v[186:187], v[238:239] op_sel_hi:[1,0]
    v_pk_mul_f32 v[188:189], v[188:189], v[238:239] op_sel_hi:[1,0]
    v_pk_mul_f32 v[190:191], v[190:191], v[238:239] op_sel_hi:[1,0]
    v_cvt_pk_bf16_f32 v160, v160, v161
    v_cvt_pk_bf16_f32 v161, v162, v163
    v_cvt_pk_bf16_f32 v162, v164, v165
    v_cvt_pk_bf16_f32 v163, v166, v167
    v_cvt_pk_bf16_f32 v168, v168, v169
    v_cvt_pk_bf16_f32 v169, v170, v171
    v_cvt_pk_bf16_f32 v170, v172, v173
    v_cvt_pk_bf16_f32 v171, v174, v175
    v_cvt_pk_bf16_f32 v176, v176, v177
    v_cvt_pk_bf16_f32 v177, v178, v179
    v_cvt_pk_bf16_f32 v178, v180, v181
    v_cvt_pk_bf16_f32 v179, v182, v183
    v_cvt_pk_bf16_f32 v184, v184, v185
    v_cvt_pk_bf16_f32 v185, v186, v187
    v_cvt_pk_bf16_f32 v186, v188, v189
    v_cvt_pk_bf16_f32 v187, v190, v191
    ds_write_b128 v250, v[160:163] offset:50688
    ds_write_b128 v250, v[168:171] offset:50752
    ds_write_b128 v250, v[176:179] offset:50816
    ds_write_b128 v250, v[184:187] offset:50880
    ds_read_b128 a[228:231], v251 offset:50688
    ds_read_b128 a[232:235], v251 offset:51744
    ds_read_b128 a[236:239], v251 offset:52800
    ds_read_b128 a[240:243], v251 offset:53856
    s_waitcnt lgkmcnt(0)
    buffer_store_dwordx4 a[228:231], v248, s[16:19], s25 offen sc1
    buffer_store_dwordx4 a[232:235], v248, s[16:19], s25 offen offset:1024 sc1
    buffer_store_dwordx4 a[236:239], v248, s[16:19], s25 offen offset:2048 sc1
    buffer_store_dwordx4 a[240:243], v248, s[16:19], s25 offen offset:3072 sc1
    s_add_u32 s25, s25, 4096
    s_waitcnt vmcnt(0) lgkmcnt(0)
    s_setpc_b64 s[30:31]
    s_endpgm
.section .rodata,"a"
.p2align 6
.amdhsa_kernel standalone__gqa_softmax__near_ridge_kernel
  .amdhsa_next_free_vgpr 512
  .amdhsa_next_free_sgpr 102
  .amdhsa_accum_offset 256
  .amdhsa_group_segment_fixed_size 0
  .amdhsa_kernarg_size 48
  .amdhsa_user_sgpr_count 2
  .amdhsa_user_sgpr_kernarg_segment_ptr 1
  .amdhsa_system_sgpr_workgroup_id_x 1
  .amdhsa_float_denorm_mode_32 3
.end_amdhsa_kernel
```
